```python
import torch

def _softmax(x, axis=-1):
    return torch.softmax(x, dim=axis)

def _gelu(x):
    return torch.nn.functional.gelu(x, approximate='tanh')

def _silu(x):
    return torch.nn.functional.silu(x)

def _sigmoid(x):
    return torch.sigmoid(x)

def _layernorm(x, axis=-1, eps=1e-05):
    m = x.mean(dim=axis, keepdim=True)
    v = x.var(dim=axis, keepdim=True, unbiased=False)
    return (x - m) / torch.sqrt(v + eps)

def _scatter_add(tgt, idx, src, axis=0):
    return tgt.clone().index_add_(axis, idx, src)

def _segment_sum(src, seg, n):
    out = torch.zeros((n,) + src.shape[1:], dtype=src.dtype)
    return out.index_add_(0, seg, src)

def _pad(x, pw):
    flat = tuple((v for pair in reversed(pw) for v in pair))
    return torch.nn.functional.pad(x, flat)
kernel_name = 'concat_heads__memory_aug_recurrent_mem_tr__sliding_block__prompt'

def setup_inputs():

    _w = lambda a: (lambda t: t.to(torch.bfloat16) if t.is_floating_point() else t)(torch.as_tensor(a))

    def _A_setup():
        B, S, Dm = (1, 2048, 640)
        H, Dh = (32, 128)
        M, seg = (8, 32)
        seg = min(seg, S)
        S = S // seg * seg
        return {'x': _w((lambda *s: torch.randn(*s, dtype=torch.bfloat16) * 0.05)(B, S, Dm)), 'mem0': _w((lambda *s: torch.randn(*s, dtype=torch.bfloat16) * 1.6)(B, M, Dm)), 'Wq': _w((lambda *s: torch.randn(*s, dtype=torch.bfloat16) * 0.8)(Dm, H, Dh) * Dm ** (-0.5)), 'Wk': _w((lambda *s: torch.randn(*s, dtype=torch.bfloat16) * 0.8)(Dm, H, Dh) * Dm ** (-0.5)), 'Wv': _w((lambda *s: torch.randn(*s, dtype=torch.bfloat16) * 1.6)(Dm, H, Dh) * Dm ** (-0.5)), 'Wo': _w((lambda *s: torch.randn(*s, dtype=torch.bfloat16) * 1.6)(H, Dh, Dm) * (H * Dh) ** (-0.5)), 'seg_len': seg}
    _A_in = _A_setup()

    def _B_setup():
        B, S, D = (1, 2048, 640)
        return {'x': _w((lambda *s: torch.randn(*s, dtype=torch.bfloat16) * 0.2)(B, S, D)), 'wqkv': _w((lambda *s: torch.randn(*s, dtype=torch.bfloat16) * 0.2)(D, 3 * D)), 'wo': _w((lambda *s: torch.randn(*s, dtype=torch.bfloat16) * 0.05)(D, D))}
    _B_in = _B_setup()
    return {'A_x': _A_in['x'], 'A_mem0': _A_in['mem0'], 'A_Wq': _A_in['Wq'], 'A_Wk': _A_in['Wk'], 'A_Wv': _A_in['Wv'], 'A_Wo': _A_in['Wo'], 'A_seg_len': _A_in['seg_len'], 'B_x': _B_in['x'], 'B_wqkv': _B_in['wqkv'], 'B_wo': _B_in['wo']}

def reference(A_x, A_mem0, A_Wq, A_Wk, A_Wv, A_Wo, A_seg_len, B_x, B_wqkv, B_wo):

    def _A_ref(x, mem0, Wq, Wk, Wv, Wo, seg_len):
        B, S, Dm = x.shape
        H, Dh = (Wq.shape[1], Wq.shape[2])
        M = mem0.shape[1]
        scale = Dh ** (-0.5)
        n_seg = S // seg_len
        L = M + seg_len
        idx = torch.arange(L)
        mask = (idx[:, None] < M) | (idx[:, None] >= idx[None, :])
        mem = mem0
        outs = []
        for s in range(n_seg):
            xs = x[:, s * seg_len:(s + 1) * seg_len, :].clone()
            h = torch.concatenate([mem, xs], axis=1)
            q = torch.einsum('btd,dhe->bhte', h, Wq)
            k = torch.einsum('btd,dhe->bhte', h, Wk)
            v = torch.einsum('btd,dhe->bhte', h, Wv)
            scores = torch.einsum('bhqe,bhke->bhqk', q, k) * scale
            scores = torch.where(mask[None, None], scores, -1000000000.0)
            p = _softmax(scores, axis=-1)
            o = torch.einsum('bhqk,bhke->bhqe', p, v)
            o = torch.einsum('bhte,hed->btd', o, Wo)
            mem = o[:, :M, :].clone()
            outs.append(o[:, M:, :])
        return torch.concatenate(outs, axis=1)

    def _B_ref(x, wqkv, wo):
        B, S, D = x.shape
        H = 32
        Dh = D // H
        W = 256
        qkv = (lambda x, *d: x.permute(*d))((x @ wqkv).reshape(B, S, 3, H, Dh), 2, 0, 3, 1, 4)
        q, k, v = (qkv[0], qkv[1], qkv[2])
        scores = torch.einsum('bhqd,bhkd->bhqk', q, k) * Dh ** (-0.5)
        idx = torch.arange(S)
        mask = (idx[:, None] - idx[None, :] >= 0) & (idx[:, None] - idx[None, :] < W)
        scores = torch.where(mask[None, None], scores, -1000000000.0)
        p = _softmax(scores, axis=-1)
        o = torch.einsum('bhqk,bhkd->bhqd', p, v)
        return (lambda x, *d: x.permute(*d))(o, 0, 2, 1, 3).reshape(B, S, D) @ wo
    a = _A_ref(A_x, A_mem0, A_Wq, A_Wk, A_Wv, A_Wo, A_seg_len)
    b = _B_ref(B_x, B_wqkv, B_wo)
    return torch.concatenate([a, b], axis=-1)
```

```asm
; @launch grid=(256,1,1) block=(256,1,1) lds=163840
.amdgcn_target "amdgcn-amd-amdhsa--gfx950"
.text
.globl concat_heads__memory_aug_recurrent_mem_tr__sliding_block__prompt_kernel
.p2align 8
.type concat_heads__memory_aug_recurrent_mem_tr__sliding_block__prompt_kernel,@function
concat_heads__memory_aug_recurrent_mem_tr__sliding_block__prompt_kernel:
    s_cmp_ge_u32 s2, 256
    s_cbranch_scc1 L_exit0
    s_load_dwordx2 s[16:17], s[0:1], 88
    s_load_dwordx2 s[4:5], s[0:1], 96
    s_load_dwordx2 s[8:9], s[0:1], 16
    s_load_dwordx2 s[12:13], s[0:1], 24
    s_mov_b32 s10, 5242880
    s_mov_b32 s11, 0x20000
    s_mov_b32 s14, 5242880
    s_mov_b32 s15, 0x20000
    s_mov_b32 s18, 256
    s_mov_b32 s19, 0x20000
    s_mov_b32 s6, 268435456
    s_mov_b32 s7, 0x20000
    s_getreg_b32 s20, hwreg(HW_REG_XCC_ID, 0, 3)
    s_lshl_b32 s20, s20, 2
    s_lshr_b32 s20, 0x76543120, s20
    s_and_b32 s20, s20, 7
    v_lshrrev_b32 v1, 6, v0
    s_nop 0
    v_readfirstlane_b32 s3, v1
    s_lshl_b32 s33, s20, 6
    s_lshl_b32 s34, s20, 2
    s_add_u32 s34, s34, 120
    s_cmp_lt_u32 s20, 2
    s_cselect_b32 s33, s33, s34
    v_cmp_eq_u32 vcc, 0, v0
    v_mov_b32 v2, 0x1000
    v_mov_b32 v3, s33
    v_cndmask_b32 v2, v2, v3, vcc
    v_mov_b32 v3, 1
    s_waitcnt lgkmcnt(0)
    s_cmp_eq_u32 s3, 0
    s_cbranch_scc0 L_notick
    buffer_atomic_add v3, v2, s[16:19], 0 offen sc0
    v_mov_b32 v5, 0
    s_waitcnt vmcnt(0)
    v_readfirstlane_b32 s33, v3
    s_nop 1
    v_mov_b32 v3, s33
    ds_write_b32 v5, v3 offset:15872
    s_waitcnt lgkmcnt(0)
L_notick:
    s_barrier
    v_mov_b32 v5, 0
    ds_read_b32 v3, v5 offset:15872
    v_and_b32 v0, 63, v0
    s_waitcnt lgkmcnt(0)
    v_readfirstlane_b32 s21, v3
    s_mov_b32 s22, 0
    s_cmp_lt_u32 s21, 32
    s_cbranch_scc0 L_recheck
    s_cmp_lt_u32 s20, 2
    s_cbranch_scc0 L_bulk
    s_load_dwordx2 s[8:9], s[0:1], 16
    s_load_dwordx2 s[12:13], s[0:1], 24
    s_load_dwordx2 s[24:25], s[0:1], 32
    s_load_dwordx2 s[28:29], s[0:1], 40
    s_mov_b32 s10, 5242880
    s_mov_b32 s11, 0x20000
    s_mov_b32 s14, 5242880
    s_mov_b32 s15, 0x20000
    s_mov_b32 s26, 5242880
    s_mov_b32 s27, 0x20000
    s_mov_b32 s30, 5242880
    s_mov_b32 s31, 0x20000
    v_mov_b32 v95, v0
    v_lshrrev_b32 v94, 4, v95
    v_and_b32 v93, 15, v95
    v_and_b32 v86, 1, v94
    v_lshlrev_b32 v86, 1, v86
    v_xor_b32 v86, v86, v93
    v_lshlrev_b32 v86, 4, v86
    v_lshl_add_u32 v80, v94, 13, v86
    v_xor_b32 v81, 64, v80
    v_xor_b32 v82, 128, v80
    v_xor_b32 v83, 192, v80
    s_mul_i32 s36, s3, 36864
    s_add_u32 s36, s36, 16384
    s_lshl_b32 s68, s21, 8
    s_lshl_b32 s33, s3, 17
    s_add_u32 s68, s68, s33
    s_mul_i32 s33, s20, 2621440
    s_add_u32 s69, s68, s33
    s_sub_u32 s70, 2621440, s33
    s_add_u32 s70, s70, s68
    s_waitcnt lgkmcnt(0)
    s_add_u32 m0, s36, 0
    s_add_u32 s33, s69, 0
    buffer_load_dwordx4 v80, s[8:11], s33 offen lds
    s_add_u32 m0, s36, 1024
    s_add_u32 s33, s69, 32768
    buffer_load_dwordx4 v81, s[8:11], s33 offen lds
    s_add_u32 m0, s36, 2048
    s_add_u32 s33, s69, 65536
    buffer_load_dwordx4 v82, s[8:11], s33 offen lds
    s_add_u32 m0, s36, 3072
    s_add_u32 s33, s69, 98304
    buffer_load_dwordx4 v83, s[8:11], s33 offen lds
    s_add_u32 m0, s36, 4096
    s_add_u32 s33, s69, 524288
    buffer_load_dwordx4 v80, s[8:11], s33 offen lds
    s_add_u32 m0, s36, 5120
    s_add_u32 s33, s69, 557056
    buffer_load_dwordx4 v81, s[8:11], s33 offen lds
    s_add_u32 m0, s36, 6144
    s_add_u32 s33, s69, 589824
    buffer_load_dwordx4 v82, s[8:11], s33 offen lds
    s_add_u32 m0, s36, 7168
    s_add_u32 s33, s69, 622592
    buffer_load_dwordx4 v83, s[8:11], s33 offen lds
    s_add_u32 m0, s36, 8192
    s_add_u32 s33, s69, 1048576
    buffer_load_dwordx4 v80, s[8:11], s33 offen lds
    s_add_u32 m0, s36, 9216
    s_add_u32 s33, s69, 1081344
    buffer_load_dwordx4 v81, s[8:11], s33 offen lds
    s_add_u32 m0, s36, 10240
    s_add_u32 s33, s69, 1114112
    buffer_load_dwordx4 v82, s[8:11], s33 offen lds
    s_add_u32 m0, s36, 11264
    s_add_u32 s33, s69, 1146880
    buffer_load_dwordx4 v83, s[8:11], s33 offen lds
    s_mul_i32 s71, s21, 163840
    s_mul_i32 s33, s20, 640
    s_add_u32 s71, s71, s33
    s_mul_i32 s33, s3, 40960
    s_add_u32 s71, s71, s33
    v_add_u32 v86, 0, v95
    v_mul_u32_u24 v85, 1639, v86
    v_lshrrev_b32 v85, 16, v85
    v_mul_u32_u24 v85, 640, v85
    v_lshl_add_u32 v70, v86, 4, v85
    v_add_u32 v86, 64, v95
    v_mul_u32_u24 v85, 1639, v86
    v_lshrrev_b32 v85, 16, v85
    v_mul_u32_u24 v85, 640, v85
    v_lshl_add_u32 v71, v86, 4, v85
    v_add_u32 v86, 128, v95
    v_mul_u32_u24 v85, 1639, v86
    v_lshrrev_b32 v85, 16, v85
    v_mul_u32_u24 v85, 640, v85
    v_lshl_add_u32 v72, v86, 4, v85
    v_add_u32 v86, 192, v95
    v_mul_u32_u24 v85, 1639, v86
    v_lshrrev_b32 v85, 16, v85
    v_mul_u32_u24 v85, 640, v85
    v_lshl_add_u32 v73, v86, 4, v85
    v_add_u32 v86, 256, v95
    v_mul_u32_u24 v85, 1639, v86
    v_lshrrev_b32 v85, 16, v85
    v_mul_u32_u24 v85, 640, v85
    v_lshl_add_u32 v74, v86, 4, v85
    s_xor_b32 s33, s3, 0
    s_lshl_b32 s64, s33, 12
    s_mul_i32 s33, s33, 36864
    s_mul_i32 s34, s3, 160
    s_add_u32 s33, s33, s34
    s_add_u32 s72, s33, 32768
    s_xor_b32 s33, s3, 1
    s_lshl_b32 s65, s33, 12
    s_mul_i32 s33, s33, 36864
    s_mul_i32 s34, s3, 160
    s_add_u32 s33, s33, s34
    s_add_u32 s73, s33, 32768
    s_xor_b32 s33, s3, 2
    s_lshl_b32 s66, s33, 12
    s_mul_i32 s33, s33, 36864
    s_mul_i32 s34, s3, 160
    s_add_u32 s33, s33, s34
    s_add_u32 s74, s33, 32768
    s_xor_b32 s33, s3, 3
    s_lshl_b32 s67, s33, 12
    s_mul_i32 s33, s33, 36864
    s_mul_i32 s34, s3, 160
    s_add_u32 s33, s33, s34
    s_add_u32 s75, s33, 32768
    v_lshrrev_b32 v86, 3, v95
    v_and_b32 v85, 7, v95
    v_lshlrev_b32 v85, 4, v85
    v_mul_u32_u24 v4, 4224, v86
    v_add_u32 v4, v4, v85
    v_lshlrev_b32 v0, 4, v95
    v_add_u32 v1, s36, v0
    s_lshl_b32 s33, s3, 10
    v_add_u32 v2, s33, v0
    v_xor_b32 v9, 1024, v2
    v_xor_b32 v10, 2048, v2
    v_xor_b32 v11, 3072, v2
    v_lshrrev_b32 v7, 2, v2
    v_add_u32 v7, 4096, v7
    v_lshrrev_b32 v86, 1, v94
    v_bfe_u32 v85, v93, 2, 1
    v_lshl_add_u32 v86, v86, 1, v85
    v_and_b32 v85, 1, v94
    v_lshl_add_u32 v86, v86, 1, v85
    v_and_b32 v85, 3, v93
    v_lshl_add_u32 v86, v86, 2, v85
    v_lshlrev_b32 v5, 2, v86
    v_lshrrev_b32 v86, 3, v93
    v_bfe_u32 v85, v93, 1, 1
    v_lshl_add_u32 v86, v85, 16, v86
    s_mov_b32 s33, 0xaaaa
    v_mul_lo_u32 v86, v86, s33
    v_add_u32 v6, 0x44444444, v86
    v_and_b32 v86, 1, v94
    v_lshrrev_b32 v85, 3, v93
    v_lshl_add_u32 v86, v85, 1, v86
    v_bfe_u32 v85, v93, 2, 1
    v_lshl_add_u32 v84, v86, 1, v85
    v_lshl_add_u32 v86, v86, 2, v85
    v_lshlrev_b32 v86, 8, v86
    v_lshrrev_b32 v85, 1, v94
    v_mul_u32_u24 v85, 36864, v85
    v_add_u32 v86, v86, v85
    s_lshl_b32 s33, s3, 1
    v_xor_b32 v84, s33, v84
    v_lshl_add_u32 v86, v84, 5, v86
    v_and_b32 v84, 3, v93
    v_lshlrev_b32 v84, 3, v84
    v_add_u32 v86, v86, v84
    v_add_u32 v76, 16384, v86
    v_xor_b32 v77, 32, v76
    v_add_u32 v78, 73728, v76
    v_add_u32 v79, 73728, v77
    v_and_b32 v86, 1, v94
    v_lshrrev_b32 v85, 1, v94
    v_lshl_add_u32 v86, v86, 2, v85
    v_mul_u32_u24 v86, 2560, v86
    v_lshl_add_u32 v88, v93, 2, v86
    v_lshrrev_b32 v86, 2, v95
    v_mul_u32_u24 v86, 640, v86
    v_and_b32 v85, 3, v95
    v_lshl_add_u32 v87, v85, 3, v86
    v_and_b32 v86, 1, v94
    v_lshlrev_b32 v86, 2, v86
    v_sub_u32 v86, v93, v86
    v_and_b32 v85, 2, v94
    v_sub_u32 v86, v86, v85
    v_lshlrev_b32 v85, 1, v94
    v_sub_u32 v85, v93, v85
    v_mov_b32 v20, 0x3f80
    v_mov_b32 v21, 0x3f800000
    v_cmp_eq_u32 vcc, 0, v85
    s_nop 1
    v_cndmask_b32 v16, 0, v20, vcc
    v_cmp_eq_u32 vcc, 1, v85
    s_nop 1
    v_cndmask_b32 v16, v16, v21, vcc
    v_cmp_eq_u32 vcc, 0, v85
    s_nop 1
    v_cndmask_b32 v17, 0, v20, vcc
    v_cmp_eq_u32 vcc, 1, v85
    s_nop 1
    v_cndmask_b32 v17, v17, v21, vcc
    v_cmp_eq_u32 vcc, 8, v86
    s_nop 1
    v_cndmask_b32 v18, 0, v20, vcc
    v_cmp_eq_u32 vcc, 9, v86
    s_nop 1
    v_cndmask_b32 v18, v18, v21, vcc
    v_cmp_eq_u32 vcc, 8, v86
    s_nop 1
    v_cndmask_b32 v19, 0, v20, vcc
    v_cmp_eq_u32 vcc, 9, v86
    s_nop 1
    v_cndmask_b32 v19, v19, v21, vcc
    ds_write_b128 v0, v[16:19] offset:13312
    v_and_b32 v86, 7, v93
    v_cmp_eq_u32 vcc, 0, v86
    s_nop 1
    v_cndmask_b32 v24, 0, v20, vcc
    v_cmp_eq_u32 vcc, 4, v86
    s_nop 1
    v_cndmask_b32 v24, v24, v21, vcc
    v_cmp_eq_u32 vcc, 1, v86
    s_nop 1
    v_cndmask_b32 v25, 0, v20, vcc
    v_cmp_eq_u32 vcc, 5, v86
    s_nop 1
    v_cndmask_b32 v25, v25, v21, vcc
    v_mov_b32 v26, v24
    v_mov_b32 v27, v25
    ds_write_b128 v0, v[24:27] offset:14336
    s_lshl_b32 s33, s3, 5
    s_add_u32 s33, s33, s21
    s_cmp_lt_u32 s33, 40
    s_cselect_b32 s61, 1, 0
    s_cselect_b32 s35, 0, 0x10000000
    s_mul_i32 s49, s33, 4224
    s_mul_i32 s76, s33, 26
    s_lshr_b32 s76, s76, 8
    s_mul_i32 s76, s76, 10
    s_sub_u32 s77, s33, s76
    s_and_b32 s78, s77, 1
    s_lshl_b32 s78, s78, 1
    s_bfe_u32 s79, s77, 0x10001
    s_or_b32 s78, s78, s79
    s_and_b32 s79, s77, 4
    s_or_b32 s78, s78, s79
    s_cmp_lt_u32 s77, 8
    s_cselect_b32 s77, s78, s77
    s_add_u32 s33, s76, s77
    s_lshl_b32 s33, s33, 7
    s_add_u32 s33, s33, s35
    s_lshl_b32 s37, s20, 15
    s_add_u32 s37, s37, s22
    s_add_u32 s37, s37, 2228224
    s_add_u32 s39, s37, s33
    s_mul_i32 s44, s20, 4194304
    s_add_u32 s44, s44, s33
    s_xor_b32 s42, s20, 1
    s_mul_i32 s42, s42, 4194304
    s_add_u32 s42, s42, 71303168
    s_add_u32 s44, s44, 71303168
    s_mul_i32 s34, s20, 506880
    s_add_u32 s34, s34, s22
    s_add_u32 s34, s34, 2293760
    s_add_u32 s49, s49, s34
    s_mov_b32 s40, s49
    s_mul_i32 s47, s3, 42240
    s_add_u32 s47, s47, s34
    s_lshl_b32 s34, s21, 7
    s_add_u32 s47, s47, s34
    s_mul_i32 s33, s21, 24576
    s_lshl_b32 s34, s3, 11
    s_add_u32 s33, s33, s34
    s_add_u32 s55, s33, 16785408
    s_add_u32 s56, s33, 16793600
    s_lshl_b32 s33, s21, 7
    s_add_u32 s59, s33, 69210240
    s_mov_b32 s62, 0x3e0293ee
    s_mov_b32 s23, 0
    s_mov_b32 s60, 0
    s_mov_b32 s38, s47
    s_mov_b32 s50, 168960
    s_mov_b32 s46, 0x41800000
    s_mov_b32 s63, s62
    s_mov_b32 s78, 0x05040100
    s_mov_b32 s79, 0x07060302
    s_lshl_b32 s33, s3, 11
    v_lshl_add_u32 v90, v0, 3, s33
    v_lshlrev_b32 v91, 2, v95
    s_mov_b32 s57, s55
    s_waitcnt lgkmcnt(0)
    s_waitcnt vmcnt(8)
    s_add_u32 m0, s36, 12288
    s_add_u32 s33, s69, 1572864
    buffer_load_dwordx4 v80, s[8:11], s33 offen lds
    s_add_u32 m0, s36, 13312
    s_add_u32 s33, s69, 1605632
    buffer_load_dwordx4 v81, s[8:11], s33 offen lds
    s_add_u32 m0, s36, 14336
    s_add_u32 s33, s69, 1638400
    buffer_load_dwordx4 v82, s[8:11], s33 offen lds
    s_add_u32 m0, s36, 15360
    s_add_u32 s33, s69, 1671168
    buffer_load_dwordx4 v83, s[8:11], s33 offen lds
    s_waitcnt vmcnt(8)
    s_add_u32 m0, s36, 32768
    s_add_u32 s33, s69, 2097152
    buffer_load_dwordx4 v80, s[8:11], s33 offen lds
    s_add_u32 m0, s36, 33792
    s_add_u32 s33, s69, 2129920
    buffer_load_dwordx4 v81, s[8:11], s33 offen lds
    s_add_u32 m0, s36, 34816
    s_add_u32 s33, s69, 2162688
    buffer_load_dwordx4 v82, s[8:11], s33 offen lds
    s_add_u32 m0, s36, 35840
    s_add_u32 s33, s69, 2195456
    buffer_load_dwordx4 v83, s[8:11], s33 offen lds
    s_waitcnt vmcnt(8)
    s_add_u32 m0, s36, 16384
    s_add_u32 s33, s69, 0
    buffer_load_dwordx4 v80, s[12:15], s33 offen lds
    s_add_u32 m0, s36, 17408
    s_add_u32 s33, s69, 32768
    buffer_load_dwordx4 v81, s[12:15], s33 offen lds
    s_add_u32 m0, s36, 18432
    s_add_u32 s33, s69, 65536
    buffer_load_dwordx4 v82, s[12:15], s33 offen lds
    s_add_u32 m0, s36, 19456
    s_add_u32 s33, s69, 98304
    buffer_load_dwordx4 v83, s[12:15], s33 offen lds
    s_waitcnt vmcnt(8)
    s_add_u32 m0, s36, 20480
    s_add_u32 s33, s69, 524288
    buffer_load_dwordx4 v80, s[12:15], s33 offen lds
    s_add_u32 m0, s36, 21504
    s_add_u32 s33, s69, 557056
    buffer_load_dwordx4 v81, s[12:15], s33 offen lds
    s_add_u32 m0, s36, 22528
    s_add_u32 s33, s69, 589824
    buffer_load_dwordx4 v82, s[12:15], s33 offen lds
    s_add_u32 m0, s36, 23552
    s_add_u32 s33, s69, 622592
    buffer_load_dwordx4 v83, s[12:15], s33 offen lds
    s_barrier
    v_add_u32 v86, s64, v76
    v_add_u32 v85, s64, v77
    v_add_u32 v84, s64, v78
    v_add_u32 v93, s64, v79
    ds_read_b64_tr_b16 v[176:177], v86 offset:0
    ds_read_b64_tr_b16 v[178:179], v86 offset:512
    ds_read_b64_tr_b16 v[180:181], v84 offset:0
    ds_read_b64_tr_b16 v[182:183], v84 offset:512
    ds_read_b64_tr_b16 v[184:185], v85 offset:0
    ds_read_b64_tr_b16 v[186:187], v85 offset:512
    ds_read_b64_tr_b16 v[188:189], v93 offset:0
    ds_read_b64_tr_b16 v[190:191], v93 offset:512
    v_add_u32 v86, s65, v76
    v_add_u32 v85, s65, v77
    v_add_u32 v84, s65, v78
    v_add_u32 v93, s65, v79
    ds_read_b64_tr_b16 v[208:209], v86 offset:0
    ds_read_b64_tr_b16 v[210:211], v86 offset:512
    ds_read_b64_tr_b16 v[212:213], v84 offset:0
    ds_read_b64_tr_b16 v[214:215], v84 offset:512
    ds_read_b64_tr_b16 v[216:217], v85 offset:0
    ds_read_b64_tr_b16 v[218:219], v85 offset:512
    ds_read_b64_tr_b16 v[220:221], v93 offset:0
    ds_read_b64_tr_b16 v[222:223], v93 offset:512
    v_add_u32 v86, s66, v76
    v_add_u32 v85, s66, v77
    v_add_u32 v84, s66, v78
    v_add_u32 v93, s66, v79
    ds_read_b64_tr_b16 v[240:241], v86 offset:0
    ds_read_b64_tr_b16 v[242:243], v86 offset:512
    ds_read_b64_tr_b16 v[244:245], v84 offset:0
    ds_read_b64_tr_b16 v[246:247], v84 offset:512
    ds_read_b64_tr_b16 v[248:249], v85 offset:0
    ds_read_b64_tr_b16 v[250:251], v85 offset:512
    ds_read_b64_tr_b16 v[252:253], v93 offset:0
    ds_read_b64_tr_b16 v[254:255], v93 offset:512
    v_add_u32 v86, s67, v76
    v_add_u32 v85, s67, v77
    v_add_u32 v84, s67, v78
    v_add_u32 v93, s67, v79
    ds_read_b64_tr_b16 a[16:17], v86 offset:0
    ds_read_b64_tr_b16 a[18:19], v86 offset:512
    ds_read_b64_tr_b16 a[20:21], v84 offset:0
    ds_read_b64_tr_b16 a[22:23], v84 offset:512
    ds_read_b64_tr_b16 a[24:25], v85 offset:0
    ds_read_b64_tr_b16 a[26:27], v85 offset:512
    ds_read_b64_tr_b16 a[28:29], v93 offset:0
    ds_read_b64_tr_b16 a[30:31], v93 offset:512
    s_waitcnt lgkmcnt(0)
    s_barrier
    s_waitcnt vmcnt(8)
    s_add_u32 m0, s36, 24576
    s_add_u32 s33, s69, 1048576
    buffer_load_dwordx4 v80, s[12:15], s33 offen lds
    s_add_u32 m0, s36, 25600
    s_add_u32 s33, s69, 1081344
    buffer_load_dwordx4 v81, s[12:15], s33 offen lds
    s_add_u32 m0, s36, 26624
    s_add_u32 s33, s69, 1114112
    buffer_load_dwordx4 v82, s[12:15], s33 offen lds
    s_add_u32 m0, s36, 27648
    s_add_u32 s33, s69, 1146880
    buffer_load_dwordx4 v83, s[12:15], s33 offen lds
    s_barrier
    ds_read_b64_tr_b16 a[48:49], v76 offset:32768
    ds_read_b64_tr_b16 a[50:51], v76 offset:33280
    ds_read_b64_tr_b16 a[52:53], v78 offset:32768
    ds_read_b64_tr_b16 a[54:55], v78 offset:33280
    ds_read_b64_tr_b16 a[56:57], v77 offset:32768
    ds_read_b64_tr_b16 a[58:59], v77 offset:33280
    ds_read_b64_tr_b16 a[60:61], v79 offset:32768
    ds_read_b64_tr_b16 a[62:63], v79 offset:33280
    s_waitcnt lgkmcnt(0)
    s_barrier
    s_waitcnt vmcnt(8)
    s_add_u32 m0, s36, 28672
    s_add_u32 s33, s69, 1572864
    buffer_load_dwordx4 v80, s[12:15], s33 offen lds
    s_add_u32 m0, s36, 29696
    s_add_u32 s33, s69, 1605632
    buffer_load_dwordx4 v81, s[12:15], s33 offen lds
    s_add_u32 m0, s36, 30720
    s_add_u32 s33, s69, 1638400
    buffer_load_dwordx4 v82, s[12:15], s33 offen lds
    s_add_u32 m0, s36, 31744
    s_add_u32 s33, s69, 1671168
    buffer_load_dwordx4 v83, s[12:15], s33 offen lds
    s_waitcnt vmcnt(8)
    s_add_u32 m0, s36, 0
    s_add_u32 s33, s70, 0
    buffer_load_dwordx4 v80, s[8:11], s33 offen lds
    s_add_u32 m0, s36, 1024
    s_add_u32 s33, s70, 32768
    buffer_load_dwordx4 v81, s[8:11], s33 offen lds
    s_add_u32 m0, s36, 2048
    s_add_u32 s33, s70, 65536
    buffer_load_dwordx4 v82, s[8:11], s33 offen lds
    s_add_u32 m0, s36, 3072
    s_add_u32 s33, s70, 98304
    buffer_load_dwordx4 v83, s[8:11], s33 offen lds
    s_waitcnt vmcnt(8)
    s_add_u32 m0, s36, 4096
    s_add_u32 s33, s70, 524288
    buffer_load_dwordx4 v80, s[8:11], s33 offen lds
    s_add_u32 m0, s36, 5120
    s_add_u32 s33, s70, 557056
    buffer_load_dwordx4 v81, s[8:11], s33 offen lds
    s_add_u32 m0, s36, 6144
    s_add_u32 s33, s70, 589824
    buffer_load_dwordx4 v82, s[8:11], s33 offen lds
    s_add_u32 m0, s36, 7168
    s_add_u32 s33, s70, 622592
    buffer_load_dwordx4 v83, s[8:11], s33 offen lds
    s_waitcnt vmcnt(8)
    s_add_u32 m0, s36, 8192
    s_add_u32 s33, s70, 1048576
    buffer_load_dwordx4 v80, s[8:11], s33 offen lds
    s_add_u32 m0, s36, 9216
    s_add_u32 s33, s70, 1081344
    buffer_load_dwordx4 v81, s[8:11], s33 offen lds
    s_add_u32 m0, s36, 10240
    s_add_u32 s33, s70, 1114112
    buffer_load_dwordx4 v82, s[8:11], s33 offen lds
    s_add_u32 m0, s36, 11264
    s_add_u32 s33, s70, 1146880
    buffer_load_dwordx4 v83, s[8:11], s33 offen lds
    s_barrier
    v_add_u32 v86, s64, v76
    v_add_u32 v85, s64, v77
    v_add_u32 v84, s64, v78
    v_add_u32 v93, s64, v79
    ds_read_b64_tr_b16 v[192:193], v86 offset:16384
    ds_read_b64_tr_b16 v[194:195], v86 offset:16896
    ds_read_b64_tr_b16 v[196:197], v84 offset:16384
    ds_read_b64_tr_b16 v[198:199], v84 offset:16896
    ds_read_b64_tr_b16 v[200:201], v85 offset:16384
    ds_read_b64_tr_b16 v[202:203], v85 offset:16896
    ds_read_b64_tr_b16 v[204:205], v93 offset:16384
    ds_read_b64_tr_b16 v[206:207], v93 offset:16896
    v_add_u32 v86, s65, v76
    v_add_u32 v85, s65, v77
    v_add_u32 v84, s65, v78
    v_add_u32 v93, s65, v79
    ds_read_b64_tr_b16 v[224:225], v86 offset:16384
    ds_read_b64_tr_b16 v[226:227], v86 offset:16896
    ds_read_b64_tr_b16 v[228:229], v84 offset:16384
    ds_read_b64_tr_b16 v[230:231], v84 offset:16896
    ds_read_b64_tr_b16 v[232:233], v85 offset:16384
    ds_read_b64_tr_b16 v[234:235], v85 offset:16896
    ds_read_b64_tr_b16 v[236:237], v93 offset:16384
    ds_read_b64_tr_b16 v[238:239], v93 offset:16896
    v_add_u32 v86, s66, v76
    v_add_u32 v85, s66, v77
    v_add_u32 v84, s66, v78
    v_add_u32 v93, s66, v79
    ds_read_b64_tr_b16 a[0:1], v86 offset:16384
    ds_read_b64_tr_b16 a[2:3], v86 offset:16896
    ds_read_b64_tr_b16 a[4:5], v84 offset:16384
    ds_read_b64_tr_b16 a[6:7], v84 offset:16896
    ds_read_b64_tr_b16 a[8:9], v85 offset:16384
    ds_read_b64_tr_b16 a[10:11], v85 offset:16896
    ds_read_b64_tr_b16 a[12:13], v93 offset:16384
    ds_read_b64_tr_b16 a[14:15], v93 offset:16896
    v_add_u32 v86, s67, v76
    v_add_u32 v85, s67, v77
    v_add_u32 v84, s67, v78
    v_add_u32 v93, s67, v79
    ds_read_b64_tr_b16 a[32:33], v86 offset:16384
    ds_read_b64_tr_b16 a[34:35], v86 offset:16896
    ds_read_b64_tr_b16 a[36:37], v84 offset:16384
    ds_read_b64_tr_b16 a[38:39], v84 offset:16896
    ds_read_b64_tr_b16 a[40:41], v85 offset:16384
    ds_read_b64_tr_b16 a[42:43], v85 offset:16896
    ds_read_b64_tr_b16 a[44:45], v93 offset:16384
    ds_read_b64_tr_b16 a[46:47], v93 offset:16896
    s_waitcnt lgkmcnt(0)
    s_barrier
    s_waitcnt vmcnt(8)
    s_add_u32 m0, s36, 12288
    s_add_u32 s33, s70, 1572864
    buffer_load_dwordx4 v80, s[8:11], s33 offen lds
    s_add_u32 m0, s36, 13312
    s_add_u32 s33, s70, 1605632
    buffer_load_dwordx4 v81, s[8:11], s33 offen lds
    s_add_u32 m0, s36, 14336
    s_add_u32 s33, s70, 1638400
    buffer_load_dwordx4 v82, s[8:11], s33 offen lds
    s_add_u32 m0, s36, 15360
    s_add_u32 s33, s70, 1671168
    buffer_load_dwordx4 v83, s[8:11], s33 offen lds
    s_waitcnt vmcnt(8)
    s_add_u32 m0, s36, 32768
    s_add_u32 s33, s69, 2097152
    buffer_load_dwordx4 v80, s[12:15], s33 offen lds
    s_add_u32 m0, s36, 33792
    s_add_u32 s33, s69, 2129920
    buffer_load_dwordx4 v81, s[12:15], s33 offen lds
    s_add_u32 m0, s36, 34816
    s_add_u32 s33, s69, 2162688
    buffer_load_dwordx4 v82, s[12:15], s33 offen lds
    s_add_u32 m0, s36, 35840
    s_add_u32 s33, s69, 2195456
    buffer_load_dwordx4 v83, s[12:15], s33 offen lds
    s_waitcnt vmcnt(8)
    s_add_u32 m0, s36, 16384
    s_add_u32 s33, s71, 0
    buffer_load_dwordx4 v70, s[28:31], s33 offen lds
    s_add_u32 m0, s36, 17408
    s_add_u32 s33, s71, 0
    buffer_load_dwordx4 v71, s[28:31], s33 offen lds
    s_add_u32 m0, s36, 18432
    s_add_u32 s33, s71, 0
    buffer_load_dwordx4 v72, s[28:31], s33 offen lds
    s_add_u32 m0, s36, 19456
    s_add_u32 s33, s71, 0
    buffer_load_dwordx4 v73, s[28:31], s33 offen lds
    s_add_u32 m0, s36, 20480
    s_add_u32 s33, s71, 0
    buffer_load_dwordx4 v74, s[28:31], s33 offen lds
    s_add_u32 m0, s36, 21504
    s_add_u32 s33, s71, 10240
    buffer_load_dwordx4 v70, s[28:31], s33 offen lds
    s_add_u32 m0, s36, 22528
    s_add_u32 s33, s71, 10240
    buffer_load_dwordx4 v71, s[28:31], s33 offen lds
    s_add_u32 m0, s36, 23552
    s_add_u32 s33, s71, 10240
    buffer_load_dwordx4 v72, s[28:31], s33 offen lds
    s_add_u32 m0, s36, 24576
    s_add_u32 s33, s71, 10240
    buffer_load_dwordx4 v73, s[28:31], s33 offen lds
    s_add_u32 m0, s36, 25600
    s_add_u32 s33, s71, 10240
    buffer_load_dwordx4 v74, s[28:31], s33 offen lds
    s_add_u32 m0, s36, 26624
    s_add_u32 s33, s71, 20480
    buffer_load_dwordx4 v70, s[28:31], s33 offen lds
    s_add_u32 m0, s36, 27648
    s_add_u32 s33, s71, 20480
    buffer_load_dwordx4 v71, s[28:31], s33 offen lds
    s_add_u32 m0, s36, 28672
    s_add_u32 s33, s71, 20480
    buffer_load_dwordx4 v72, s[28:31], s33 offen lds
    s_add_u32 m0, s36, 29696
    s_add_u32 s33, s71, 20480
    buffer_load_dwordx4 v73, s[28:31], s33 offen lds
    s_add_u32 m0, s36, 30720
    s_add_u32 s33, s71, 20480
    buffer_load_dwordx4 v74, s[28:31], s33 offen lds
    s_add_u32 m0, s36, 31744
    s_add_u32 s33, s71, 30720
    buffer_load_dwordx4 v70, s[28:31], s33 offen lds
    s_waitcnt vmcnt(20)
    s_barrier
    v_add_u32 v86, s64, v76
    v_add_u32 v85, s64, v77
    v_add_u32 v84, s64, v78
    v_add_u32 v93, s64, v79
    ds_read_b64_tr_b16 a[80:81], v86 offset:0
    ds_read_b64_tr_b16 a[82:83], v86 offset:512
    ds_read_b64_tr_b16 a[84:85], v84 offset:0
    ds_read_b64_tr_b16 a[86:87], v84 offset:512
    ds_read_b64_tr_b16 a[88:89], v85 offset:0
    ds_read_b64_tr_b16 a[90:91], v85 offset:512
    ds_read_b64_tr_b16 a[92:93], v93 offset:0
    ds_read_b64_tr_b16 a[94:95], v93 offset:512
    v_add_u32 v86, s65, v76
    v_add_u32 v85, s65, v77
    v_add_u32 v84, s65, v78
    v_add_u32 v93, s65, v79
    ds_read_b64_tr_b16 a[112:113], v86 offset:0
    ds_read_b64_tr_b16 a[114:115], v86 offset:512
    ds_read_b64_tr_b16 a[116:117], v84 offset:0
    ds_read_b64_tr_b16 a[118:119], v84 offset:512
    ds_read_b64_tr_b16 a[120:121], v85 offset:0
    ds_read_b64_tr_b16 a[122:123], v85 offset:512
    ds_read_b64_tr_b16 a[124:125], v93 offset:0
    ds_read_b64_tr_b16 a[126:127], v93 offset:512
    v_add_u32 v86, s66, v76
    v_add_u32 v85, s66, v77
    v_add_u32 v84, s66, v78
    v_add_u32 v93, s66, v79
    ds_read_b64_tr_b16 a[144:145], v86 offset:0
    ds_read_b64_tr_b16 a[146:147], v86 offset:512
    ds_read_b64_tr_b16 a[148:149], v84 offset:0
    ds_read_b64_tr_b16 a[150:151], v84 offset:512
    ds_read_b64_tr_b16 a[152:153], v85 offset:0
    ds_read_b64_tr_b16 a[154:155], v85 offset:512
    ds_read_b64_tr_b16 a[156:157], v93 offset:0
    ds_read_b64_tr_b16 a[158:159], v93 offset:512
    v_add_u32 v86, s67, v76
    v_add_u32 v85, s67, v77
    v_add_u32 v84, s67, v78
    v_add_u32 v93, s67, v79
    ds_read_b64_tr_b16 a[192:193], v86 offset:0
    ds_read_b64_tr_b16 a[194:195], v86 offset:512
    ds_read_b64_tr_b16 a[196:197], v84 offset:0
    ds_read_b64_tr_b16 a[198:199], v84 offset:512
    ds_read_b64_tr_b16 a[200:201], v85 offset:0
    ds_read_b64_tr_b16 a[202:203], v85 offset:512
    ds_read_b64_tr_b16 a[204:205], v93 offset:0
    ds_read_b64_tr_b16 a[206:207], v93 offset:512
    s_waitcnt lgkmcnt(0)
    s_barrier
    s_waitcnt vmcnt(16)
    s_barrier
    ds_read_b64_tr_b16 a[64:65], v76 offset:32768
    ds_read_b64_tr_b16 a[66:67], v76 offset:33280
    ds_read_b64_tr_b16 a[68:69], v78 offset:32768
    ds_read_b64_tr_b16 a[70:71], v78 offset:33280
    ds_read_b64_tr_b16 a[72:73], v77 offset:32768
    ds_read_b64_tr_b16 a[74:75], v77 offset:33280
    ds_read_b64_tr_b16 a[76:77], v79 offset:32768
    ds_read_b64_tr_b16 a[78:79], v79 offset:33280
    s_waitcnt lgkmcnt(0)
    s_barrier
    s_add_u32 m0, s36, 32768
    s_add_u32 s33, s71, 30720
    buffer_load_dwordx4 v71, s[28:31], s33 offen lds
    s_add_u32 m0, s36, 33792
    s_add_u32 s33, s71, 30720
    buffer_load_dwordx4 v72, s[28:31], s33 offen lds
    s_add_u32 m0, s36, 34816
    s_add_u32 s33, s71, 30720
    buffer_load_dwordx4 v73, s[28:31], s33 offen lds
    s_add_u32 m0, s36, 35840
    s_add_u32 s33, s71, 30720
    buffer_load_dwordx4 v74, s[28:31], s33 offen lds
    s_add_u32 m0, s36, 12288
    s_add_u32 s33, s70, 2097152
    buffer_load_dwordx4 v80, s[8:11], s33 offen lds
    s_add_u32 m0, s36, 13312
    s_add_u32 s33, s70, 2129920
    buffer_load_dwordx4 v81, s[8:11], s33 offen lds
    s_add_u32 m0, s36, 14336
    s_add_u32 s33, s70, 2162688
    buffer_load_dwordx4 v82, s[8:11], s33 offen lds
    s_add_u32 m0, s36, 15360
    s_add_u32 s33, s70, 2195456
    buffer_load_dwordx4 v83, s[8:11], s33 offen lds
    s_waitcnt vmcnt(20)
    s_add_u32 m0, s36, 8192
    s_add_u32 s33, s70, 2097152
    buffer_load_dwordx4 v80, s[12:15], s33 offen lds
    s_add_u32 m0, s36, 9216
    s_add_u32 s33, s70, 2129920
    buffer_load_dwordx4 v81, s[12:15], s33 offen lds
    s_add_u32 m0, s36, 10240
    s_add_u32 s33, s70, 2162688
    buffer_load_dwordx4 v82, s[12:15], s33 offen lds
    s_add_u32 m0, s36, 11264
    s_add_u32 s33, s70, 2195456
    buffer_load_dwordx4 v83, s[12:15], s33 offen lds
    s_waitcnt vmcnt(20)
    s_add_u32 m0, s36, 0
    s_add_u32 s33, s70, 0
    buffer_load_dwordx4 v80, s[12:15], s33 offen lds
    s_add_u32 m0, s36, 1024
    s_add_u32 s33, s70, 32768
    buffer_load_dwordx4 v81, s[12:15], s33 offen lds
    s_add_u32 m0, s36, 2048
    s_add_u32 s33, s70, 65536
    buffer_load_dwordx4 v82, s[12:15], s33 offen lds
    s_add_u32 m0, s36, 3072
    s_add_u32 s33, s70, 98304
    buffer_load_dwordx4 v83, s[12:15], s33 offen lds
    s_waitcnt vmcnt(20)
    buffer_load_dword v92, v91, s[16:19], 0 offen sc1
    s_add_u32 m0, s36, 4096
    s_add_u32 s33, s70, 524288
    buffer_load_dwordx4 v80, s[12:15], s33 offen lds
    s_add_u32 m0, s36, 5120
    s_add_u32 s33, s70, 557056
    buffer_load_dwordx4 v81, s[12:15], s33 offen lds
    s_add_u32 m0, s36, 6144
    s_add_u32 s33, s70, 589824
    buffer_load_dwordx4 v82, s[12:15], s33 offen lds
    s_add_u32 m0, s36, 7168
    s_add_u32 s33, s70, 622592
    buffer_load_dwordx4 v83, s[12:15], s33 offen lds
    s_waitcnt vmcnt(21)
    s_waitcnt vmcnt(17)
    s_barrier
    v_add_u32 v86, s72, v88
    v_add_u32 v85, s72, v87
    ds_read_b64_tr_b16 v[160:161], v85 offset:128
    ds_read_b64_tr_b16 v[162:163], v85 offset:10368
    ds_read_b32 v12, v86 offset:0
    ds_read_b32 v13, v86 offset:640
    ds_read_b32 v14, v86 offset:64
    ds_read_b32 v15, v86 offset:704
    ds_read_b32 v16, v86 offset:1280
    ds_read_b32 v17, v86 offset:1920
    ds_read_b32 v18, v86 offset:1344
    ds_read_b32 v19, v86 offset:1984
    ds_read_b32 v20, v86 offset:5120
    ds_read_b32 v21, v86 offset:5760
    ds_read_b32 v22, v86 offset:5184
    ds_read_b32 v23, v86 offset:5824
    ds_read_b32 v24, v86 offset:6400
    ds_read_b32 v25, v86 offset:7040
    ds_read_b32 v26, v86 offset:6464
    ds_read_b32 v27, v86 offset:7104
    s_waitcnt lgkmcnt(14)
    v_perm_b32 v96, v13, v12, s78
    v_perm_b32 v104, v13, v12, s79
    s_waitcnt lgkmcnt(12)
    v_perm_b32 v97, v15, v14, s78
    v_perm_b32 v105, v15, v14, s79
    s_waitcnt lgkmcnt(10)
    v_perm_b32 v98, v17, v16, s78
    v_perm_b32 v106, v17, v16, s79
    s_waitcnt lgkmcnt(8)
    v_perm_b32 v99, v19, v18, s78
    v_perm_b32 v107, v19, v18, s79
    s_waitcnt lgkmcnt(6)
    v_perm_b32 v100, v21, v20, s78
    v_perm_b32 v108, v21, v20, s79
    s_waitcnt lgkmcnt(4)
    v_perm_b32 v101, v23, v22, s78
    v_perm_b32 v109, v23, v22, s79
    s_waitcnt lgkmcnt(2)
    v_perm_b32 v102, v25, v24, s78
    v_perm_b32 v110, v25, v24, s79
    s_waitcnt lgkmcnt(0)
    v_perm_b32 v103, v27, v26, s78
    v_perm_b32 v111, v27, v26, s79
    v_add_u32 v86, s73, v88
    v_add_u32 v85, s73, v87
    ds_read_b64_tr_b16 v[164:165], v85 offset:128
    ds_read_b64_tr_b16 v[166:167], v85 offset:10368
    ds_read_b32 v28, v86 offset:0
    ds_read_b32 v29, v86 offset:640
    ds_read_b32 v30, v86 offset:64
    ds_read_b32 v31, v86 offset:704
    ds_read_b32 v32, v86 offset:1280
    ds_read_b32 v33, v86 offset:1920
    ds_read_b32 v34, v86 offset:1344
    ds_read_b32 v35, v86 offset:1984
    ds_read_b32 v36, v86 offset:5120
    ds_read_b32 v37, v86 offset:5760
    ds_read_b32 v38, v86 offset:5184
    ds_read_b32 v39, v86 offset:5824
    ds_read_b32 v40, v86 offset:6400
    ds_read_b32 v41, v86 offset:7040
    ds_read_b32 v42, v86 offset:6464
    ds_read_b32 v43, v86 offset:7104
    s_waitcnt lgkmcnt(14)
    v_perm_b32 v112, v29, v28, s78
    v_perm_b32 v120, v29, v28, s79
    s_waitcnt lgkmcnt(12)
    v_perm_b32 v113, v31, v30, s78
    v_perm_b32 v121, v31, v30, s79
    s_waitcnt lgkmcnt(10)
    v_perm_b32 v114, v33, v32, s78
    v_perm_b32 v122, v33, v32, s79
    s_waitcnt lgkmcnt(8)
    v_perm_b32 v115, v35, v34, s78
    v_perm_b32 v123, v35, v34, s79
    s_waitcnt lgkmcnt(6)
    v_perm_b32 v116, v37, v36, s78
    v_perm_b32 v124, v37, v36, s79
    s_waitcnt lgkmcnt(4)
    v_perm_b32 v117, v39, v38, s78
    v_perm_b32 v125, v39, v38, s79
    s_waitcnt lgkmcnt(2)
    v_perm_b32 v118, v41, v40, s78
    v_perm_b32 v126, v41, v40, s79
    s_waitcnt lgkmcnt(0)
    v_perm_b32 v119, v43, v42, s78
    v_perm_b32 v127, v43, v42, s79
    v_add_u32 v86, s74, v88
    v_add_u32 v85, s74, v87
    ds_read_b64_tr_b16 v[168:169], v85 offset:128
    ds_read_b64_tr_b16 v[170:171], v85 offset:10368
    ds_read_b32 v12, v86 offset:0
    ds_read_b32 v13, v86 offset:640
    ds_read_b32 v14, v86 offset:64
    ds_read_b32 v15, v86 offset:704
    ds_read_b32 v16, v86 offset:1280
    ds_read_b32 v17, v86 offset:1920
    ds_read_b32 v18, v86 offset:1344
    ds_read_b32 v19, v86 offset:1984
    ds_read_b32 v20, v86 offset:5120
    ds_read_b32 v21, v86 offset:5760
    ds_read_b32 v22, v86 offset:5184
    ds_read_b32 v23, v86 offset:5824
    ds_read_b32 v24, v86 offset:6400
    ds_read_b32 v25, v86 offset:7040
    ds_read_b32 v26, v86 offset:6464
    ds_read_b32 v27, v86 offset:7104
    s_waitcnt lgkmcnt(14)
    v_perm_b32 v128, v13, v12, s78
    v_perm_b32 v136, v13, v12, s79
    s_waitcnt lgkmcnt(12)
    v_perm_b32 v129, v15, v14, s78
    v_perm_b32 v137, v15, v14, s79
    s_waitcnt lgkmcnt(10)
    v_perm_b32 v130, v17, v16, s78
    v_perm_b32 v138, v17, v16, s79
    s_waitcnt lgkmcnt(8)
    v_perm_b32 v131, v19, v18, s78
    v_perm_b32 v139, v19, v18, s79
    s_waitcnt lgkmcnt(6)
    v_perm_b32 v132, v21, v20, s78
    v_perm_b32 v140, v21, v20, s79
    s_waitcnt lgkmcnt(4)
    v_perm_b32 v133, v23, v22, s78
    v_perm_b32 v141, v23, v22, s79
    s_waitcnt lgkmcnt(2)
    v_perm_b32 v134, v25, v24, s78
    v_perm_b32 v142, v25, v24, s79
    s_waitcnt lgkmcnt(0)
    v_perm_b32 v135, v27, v26, s78
    v_perm_b32 v143, v27, v26, s79
    v_add_u32 v86, s75, v88
    v_add_u32 v85, s75, v87
    ds_read_b64_tr_b16 v[172:173], v85 offset:128
    ds_read_b64_tr_b16 v[174:175], v85 offset:10368
    ds_read_b32 v28, v86 offset:0
    ds_read_b32 v29, v86 offset:640
    ds_read_b32 v30, v86 offset:64
    ds_read_b32 v31, v86 offset:704
    ds_read_b32 v32, v86 offset:1280
    ds_read_b32 v33, v86 offset:1920
    ds_read_b32 v34, v86 offset:1344
    ds_read_b32 v35, v86 offset:1984
    ds_read_b32 v36, v86 offset:5120
    ds_read_b32 v37, v86 offset:5760
    ds_read_b32 v38, v86 offset:5184
    ds_read_b32 v39, v86 offset:5824
    ds_read_b32 v40, v86 offset:6400
    ds_read_b32 v41, v86 offset:7040
    ds_read_b32 v42, v86 offset:6464
    ds_read_b32 v43, v86 offset:7104
    s_waitcnt lgkmcnt(14)
    v_perm_b32 v144, v29, v28, s78
    v_perm_b32 v152, v29, v28, s79
    s_waitcnt lgkmcnt(12)
    v_perm_b32 v145, v31, v30, s78
    v_perm_b32 v153, v31, v30, s79
    s_waitcnt lgkmcnt(10)
    v_perm_b32 v146, v33, v32, s78
    v_perm_b32 v154, v33, v32, s79
    s_waitcnt lgkmcnt(8)
    v_perm_b32 v147, v35, v34, s78
    v_perm_b32 v155, v35, v34, s79
    s_waitcnt lgkmcnt(6)
    v_perm_b32 v148, v37, v36, s78
    v_perm_b32 v156, v37, v36, s79
    s_waitcnt lgkmcnt(4)
    v_perm_b32 v149, v39, v38, s78
    v_perm_b32 v157, v39, v38, s79
    s_waitcnt lgkmcnt(2)
    v_perm_b32 v150, v41, v40, s78
    v_perm_b32 v158, v41, v40, s79
    s_waitcnt lgkmcnt(0)
    v_perm_b32 v151, v43, v42, s78
    v_perm_b32 v159, v43, v42, s79
    s_waitcnt lgkmcnt(0)
    s_barrier
    s_waitcnt vmcnt(13)
    s_barrier
    ds_read_b64_tr_b16 a[224:225], v76 offset:12288
    ds_read_b64_tr_b16 a[226:227], v76 offset:12800
    ds_read_b64_tr_b16 a[228:229], v78 offset:12288
    ds_read_b64_tr_b16 a[230:231], v78 offset:12800
    ds_read_b64_tr_b16 a[232:233], v77 offset:12288
    ds_read_b64_tr_b16 a[234:235], v77 offset:12800
    ds_read_b64_tr_b16 a[236:237], v79 offset:12288
    ds_read_b64_tr_b16 a[238:239], v79 offset:12800
    s_waitcnt lgkmcnt(0)
    s_barrier
    s_waitcnt vmcnt(9)
    s_barrier
    ds_read_b64_tr_b16 a[240:241], v76 offset:8192
    ds_read_b64_tr_b16 a[242:243], v76 offset:8704
    ds_read_b64_tr_b16 a[244:245], v78 offset:8192
    ds_read_b64_tr_b16 a[246:247], v78 offset:8704
    ds_read_b64_tr_b16 a[248:249], v77 offset:8192
    ds_read_b64_tr_b16 a[250:251], v77 offset:8704
    ds_read_b64_tr_b16 a[252:253], v79 offset:8192
    ds_read_b64_tr_b16 a[254:255], v79 offset:8704
    s_waitcnt lgkmcnt(0)
    s_barrier
    s_add_u32 m0, s36, 8192
    s_add_u32 s33, s70, 1048576
    buffer_load_dwordx4 v80, s[12:15], s33 offen lds
    s_add_u32 m0, s36, 9216
    s_add_u32 s33, s70, 1081344
    buffer_load_dwordx4 v81, s[12:15], s33 offen lds
    s_add_u32 m0, s36, 10240
    s_add_u32 s33, s70, 1114112
    buffer_load_dwordx4 v82, s[12:15], s33 offen lds
    s_add_u32 m0, s36, 11264
    s_add_u32 s33, s70, 1146880
    buffer_load_dwordx4 v83, s[12:15], s33 offen lds
    s_add_u32 m0, s36, 12288
    s_add_u32 s33, s70, 1572864
    buffer_load_dwordx4 v80, s[12:15], s33 offen lds
    s_add_u32 m0, s36, 13312
    s_add_u32 s33, s70, 1605632
    buffer_load_dwordx4 v81, s[12:15], s33 offen lds
    s_add_u32 m0, s36, 14336
    s_add_u32 s33, s70, 1638400
    buffer_load_dwordx4 v82, s[12:15], s33 offen lds
    s_add_u32 m0, s36, 15360
    s_add_u32 s33, s70, 1671168
    buffer_load_dwordx4 v83, s[12:15], s33 offen lds
    s_add_u32 m0, s36, 16384
    s_add_u32 s33, s70, 0
    buffer_load_dwordx4 v80, s[24:27], s33 offen lds
    s_add_u32 m0, s36, 17408
    s_add_u32 s33, s70, 32768
    buffer_load_dwordx4 v81, s[24:27], s33 offen lds
    s_add_u32 m0, s36, 18432
    s_add_u32 s33, s70, 65536
    buffer_load_dwordx4 v82, s[24:27], s33 offen lds
    s_add_u32 m0, s36, 19456
    s_add_u32 s33, s70, 98304
    buffer_load_dwordx4 v83, s[24:27], s33 offen lds
    s_add_u32 m0, s36, 20480
    s_add_u32 s33, s70, 524288
    buffer_load_dwordx4 v80, s[24:27], s33 offen lds
    s_add_u32 m0, s36, 21504
    s_add_u32 s33, s70, 557056
    buffer_load_dwordx4 v81, s[24:27], s33 offen lds
    s_add_u32 m0, s36, 22528
    s_add_u32 s33, s70, 589824
    buffer_load_dwordx4 v82, s[24:27], s33 offen lds
    s_add_u32 m0, s36, 23552
    s_add_u32 s33, s70, 622592
    buffer_load_dwordx4 v83, s[24:27], s33 offen lds
    s_waitcnt vmcnt(21)
    s_add_u32 m0, s36, 24576
    s_add_u32 s33, s70, 1048576
    buffer_load_dwordx4 v80, s[24:27], s33 offen lds
    s_add_u32 m0, s36, 25600
    s_add_u32 s33, s70, 1081344
    buffer_load_dwordx4 v81, s[24:27], s33 offen lds
    s_add_u32 m0, s36, 26624
    s_add_u32 s33, s70, 1114112
    buffer_load_dwordx4 v82, s[24:27], s33 offen lds
    s_add_u32 m0, s36, 27648
    s_add_u32 s33, s70, 1146880
    buffer_load_dwordx4 v83, s[24:27], s33 offen lds
    s_waitcnt vmcnt(20)
    s_add_u32 m0, s36, 28672
    s_add_u32 s33, s70, 1572864
    buffer_load_dwordx4 v80, s[24:27], s33 offen lds
    s_add_u32 m0, s36, 29696
    s_add_u32 s33, s70, 1605632
    buffer_load_dwordx4 v81, s[24:27], s33 offen lds
    s_add_u32 m0, s36, 30720
    s_add_u32 s33, s70, 1638400
    buffer_load_dwordx4 v82, s[24:27], s33 offen lds
    s_add_u32 m0, s36, 31744
    s_add_u32 s33, s70, 1671168
    buffer_load_dwordx4 v83, s[24:27], s33 offen lds
    s_waitcnt vmcnt(20)
    s_add_u32 m0, s36, 32768
    s_add_u32 s33, s69, 2097152
    buffer_load_dwordx4 v80, s[24:27], s33 offen lds
    s_add_u32 m0, s36, 33792
    s_add_u32 s33, s69, 2129920
    buffer_load_dwordx4 v81, s[24:27], s33 offen lds
    s_add_u32 m0, s36, 34816
    s_add_u32 s33, s69, 2162688
    buffer_load_dwordx4 v82, s[24:27], s33 offen lds
    s_add_u32 m0, s36, 35840
    s_add_u32 s33, s69, 2195456
    buffer_load_dwordx4 v83, s[24:27], s33 offen lds
    s_waitcnt vmcnt(20)
    v_readlane_b32 s33, v92, 48
    s_nop 0
    s_cmp_ge_u32 s33, 192
    s_cselect_b32 s33, s59, 0x10000000
    s_mov_b64 exec, 0x101
    s_nop 0
    buffer_load_dword v89, v4, s[4:7], s33 offen sc1
    s_mov_b64 exec, -1
    s_barrier
    v_add_u32 v86, s64, v76
    v_add_u32 v85, s64, v77
    v_add_u32 v84, s64, v78
    v_add_u32 v93, s64, v79
    ds_read_b64_tr_b16 a[96:97], v86 offset:0
    ds_read_b64_tr_b16 a[98:99], v86 offset:512
    ds_read_b64_tr_b16 a[100:101], v84 offset:0
    ds_read_b64_tr_b16 a[102:103], v84 offset:512
    ds_read_b64_tr_b16 a[104:105], v85 offset:0
    ds_read_b64_tr_b16 a[106:107], v85 offset:512
    ds_read_b64_tr_b16 a[108:109], v93 offset:0
    ds_read_b64_tr_b16 a[110:111], v93 offset:512
    v_add_u32 v86, s65, v76
    v_add_u32 v85, s65, v77
    v_add_u32 v84, s65, v78
    v_add_u32 v93, s65, v79
    ds_read_b64_tr_b16 v[12:13], v86 offset:0
    ds_read_b64_tr_b16 v[14:15], v86 offset:512
    ds_read_b64_tr_b16 v[16:17], v84 offset:0
    ds_read_b64_tr_b16 v[18:19], v84 offset:512
    ds_read_b64_tr_b16 v[20:21], v85 offset:0
    ds_read_b64_tr_b16 v[22:23], v85 offset:512
    ds_read_b64_tr_b16 v[24:25], v93 offset:0
    ds_read_b64_tr_b16 v[26:27], v93 offset:512
    v_add_u32 v86, s66, v76
    v_add_u32 v85, s66, v77
    v_add_u32 v84, s66, v78
    v_add_u32 v93, s66, v79
    ds_read_b64_tr_b16 a[160:161], v86 offset:0
    ds_read_b64_tr_b16 a[162:163], v86 offset:512
    ds_read_b64_tr_b16 a[164:165], v84 offset:0
    ds_read_b64_tr_b16 a[166:167], v84 offset:512
    ds_read_b64_tr_b16 a[168:169], v85 offset:0
    ds_read_b64_tr_b16 a[170:171], v85 offset:512
    ds_read_b64_tr_b16 a[172:173], v93 offset:0
    ds_read_b64_tr_b16 a[174:175], v93 offset:512
    v_add_u32 v86, s67, v76
    v_add_u32 v85, s67, v77
    v_add_u32 v84, s67, v78
    v_add_u32 v93, s67, v79
    ds_read_b64_tr_b16 v[28:29], v86 offset:0
    ds_read_b64_tr_b16 v[30:31], v86 offset:512
    ds_read_b64_tr_b16 v[32:33], v84 offset:0
    ds_read_b64_tr_b16 v[34:35], v84 offset:512
    ds_read_b64_tr_b16 v[36:37], v85 offset:0
    ds_read_b64_tr_b16 v[38:39], v85 offset:512
    ds_read_b64_tr_b16 v[40:41], v93 offset:0
    ds_read_b64_tr_b16 v[42:43], v93 offset:512
    s_waitcnt lgkmcnt(0)
    s_barrier
    s_add_u32 m0, s36, 0
    s_add_u32 s33, s69, 0
    buffer_load_dwordx4 v80, s[24:27], s33 offen lds
    s_add_u32 m0, s36, 1024
    s_add_u32 s33, s69, 32768
    buffer_load_dwordx4 v81, s[24:27], s33 offen lds
    s_add_u32 m0, s36, 2048
    s_add_u32 s33, s69, 65536
    buffer_load_dwordx4 v82, s[24:27], s33 offen lds
    s_add_u32 m0, s36, 3072
    s_add_u32 s33, s69, 98304
    buffer_load_dwordx4 v83, s[24:27], s33 offen lds
    s_waitcnt vmcnt(21)
    s_add_u32 m0, s36, 4096
    s_add_u32 s33, s69, 524288
    buffer_load_dwordx4 v80, s[24:27], s33 offen lds
    s_add_u32 m0, s36, 5120
    s_add_u32 s33, s69, 557056
    buffer_load_dwordx4 v81, s[24:27], s33 offen lds
    s_add_u32 m0, s36, 6144
    s_add_u32 s33, s69, 589824
    buffer_load_dwordx4 v82, s[24:27], s33 offen lds
    s_add_u32 m0, s36, 7168
    s_add_u32 s33, s69, 622592
    buffer_load_dwordx4 v83, s[24:27], s33 offen lds
    s_waitcnt vmcnt(21)
    s_add_u32 m0, s36, 8192
    s_add_u32 s33, s69, 1048576
    buffer_load_dwordx4 v80, s[24:27], s33 offen lds
    s_add_u32 m0, s36, 9216
    s_add_u32 s33, s69, 1081344
    buffer_load_dwordx4 v81, s[24:27], s33 offen lds
    s_add_u32 m0, s36, 10240
    s_add_u32 s33, s69, 1114112
    buffer_load_dwordx4 v82, s[24:27], s33 offen lds
    s_add_u32 m0, s36, 11264
    s_add_u32 s33, s69, 1146880
    buffer_load_dwordx4 v83, s[24:27], s33 offen lds
    s_waitcnt vmcnt(21)
    s_add_u32 m0, s36, 12288
    s_add_u32 s33, s69, 1572864
    buffer_load_dwordx4 v80, s[24:27], s33 offen lds
    s_add_u32 m0, s36, 13312
    s_add_u32 s33, s69, 1605632
    buffer_load_dwordx4 v81, s[24:27], s33 offen lds
    s_add_u32 m0, s36, 14336
    s_add_u32 s33, s69, 1638400
    buffer_load_dwordx4 v82, s[24:27], s33 offen lds
    s_add_u32 m0, s36, 15360
    s_add_u32 s33, s69, 1671168
    buffer_load_dwordx4 v83, s[24:27], s33 offen lds
    s_waitcnt vmcnt(21)
    s_barrier
    v_add_u32 v86, s64, v76
    v_add_u32 v85, s64, v77
    v_add_u32 v84, s64, v78
    v_add_u32 v93, s64, v79
    ds_read_b64_tr_b16 v[44:45], v86 offset:16384
    ds_read_b64_tr_b16 v[46:47], v86 offset:16896
    ds_read_b64_tr_b16 v[48:49], v84 offset:16384
    ds_read_b64_tr_b16 v[50:51], v84 offset:16896
    ds_read_b64_tr_b16 v[52:53], v85 offset:16384
    ds_read_b64_tr_b16 v[54:55], v85 offset:16896
    ds_read_b64_tr_b16 v[56:57], v93 offset:16384
    ds_read_b64_tr_b16 v[58:59], v93 offset:16896
    v_add_u32 v86, s65, v76
    v_add_u32 v85, s65, v77
    v_add_u32 v84, s65, v78
    v_add_u32 v93, s65, v79
    ds_read_b64_tr_b16 a[128:129], v86 offset:16384
    ds_read_b64_tr_b16 a[130:131], v86 offset:16896
    ds_read_b64_tr_b16 a[132:133], v84 offset:16384
    ds_read_b64_tr_b16 a[134:135], v84 offset:16896
    ds_read_b64_tr_b16 a[136:137], v85 offset:16384
    ds_read_b64_tr_b16 a[138:139], v85 offset:16896
    ds_read_b64_tr_b16 a[140:141], v93 offset:16384
    ds_read_b64_tr_b16 a[142:143], v93 offset:16896
    v_add_u32 v86, s66, v76
    v_add_u32 v85, s66, v77
    v_add_u32 v84, s66, v78
    v_add_u32 v93, s66, v79
    ds_read_b64_tr_b16 a[176:177], v86 offset:16384
    ds_read_b64_tr_b16 a[178:179], v86 offset:16896
    ds_read_b64_tr_b16 a[180:181], v84 offset:16384
    ds_read_b64_tr_b16 a[182:183], v84 offset:16896
    ds_read_b64_tr_b16 a[184:185], v85 offset:16384
    ds_read_b64_tr_b16 a[186:187], v85 offset:16896
    ds_read_b64_tr_b16 a[188:189], v93 offset:16384
    ds_read_b64_tr_b16 a[190:191], v93 offset:16896
    v_add_u32 v86, s67, v76
    v_add_u32 v85, s67, v77
    v_add_u32 v84, s67, v78
    v_add_u32 v93, s67, v79
    ds_read_b64_tr_b16 a[208:209], v86 offset:16384
    ds_read_b64_tr_b16 a[210:211], v86 offset:16896
    ds_read_b64_tr_b16 a[212:213], v84 offset:16384
    ds_read_b64_tr_b16 a[214:215], v84 offset:16896
    ds_read_b64_tr_b16 a[216:217], v85 offset:16384
    ds_read_b64_tr_b16 a[218:219], v85 offset:16896
    ds_read_b64_tr_b16 a[220:221], v93 offset:16384
    ds_read_b64_tr_b16 a[222:223], v93 offset:16896
    s_waitcnt lgkmcnt(0)
    s_barrier
    ds_write_b128 v1, v[12:15] offset:20480
    ds_write_b128 v1, v[16:19] offset:21504
    ds_write_b128 v1, v[20:23] offset:22528
    ds_write_b128 v1, v[24:27] offset:23552
    ds_write_b128 v1, v[28:31] offset:24576
    ds_write_b128 v1, v[32:35] offset:25600
    ds_write_b128 v1, v[36:39] offset:26624
    ds_write_b128 v1, v[40:43] offset:27648
    ds_write_b128 v1, v[44:47] offset:28672
    ds_write_b128 v1, v[48:51] offset:29696
    ds_write_b128 v1, v[52:55] offset:30720
    ds_write_b128 v1, v[56:59] offset:31744
    s_add_u32 m0, s36, 16384
    s_add_u32 s33, s70, 2097152
    buffer_load_dwordx4 v80, s[24:27], s33 offen lds
    s_add_u32 m0, s36, 17408
    s_add_u32 s33, s70, 2129920
    buffer_load_dwordx4 v81, s[24:27], s33 offen lds
    s_add_u32 m0, s36, 18432
    s_add_u32 s33, s70, 2162688
    buffer_load_dwordx4 v82, s[24:27], s33 offen lds
    s_add_u32 m0, s36, 19456
    s_add_u32 s33, s70, 2195456
    buffer_load_dwordx4 v83, s[24:27], s33 offen lds
    s_waitcnt vmcnt(21)
    s_barrier
    ds_read_b64_tr_b16 v[12:13], v76 offset:32768
    ds_read_b64_tr_b16 v[14:15], v76 offset:33280
    ds_read_b64_tr_b16 v[16:17], v78 offset:32768
    ds_read_b64_tr_b16 v[18:19], v78 offset:33280
    ds_read_b64_tr_b16 v[20:21], v77 offset:32768
    ds_read_b64_tr_b16 v[22:23], v77 offset:33280
    ds_read_b64_tr_b16 v[24:25], v79 offset:32768
    ds_read_b64_tr_b16 v[26:27], v79 offset:33280
    s_waitcnt lgkmcnt(0)
    s_barrier
    ds_write_b128 v1, v[12:15] offset:32768
    ds_write_b128 v1, v[16:19] offset:33792
    ds_write_b128 v1, v[20:23] offset:34816
    ds_write_b128 v1, v[24:27] offset:35840
    s_waitcnt vmcnt(16)
    s_waitcnt vmcnt(12)
    v_readlane_b32 s33, v89, 0
    v_readlane_b32 s34, v89, 8
    s_nop 0
    s_min_u32 s60, s33, s34
    s_cmp_lg_u32 s60, 0
    s_cselect_b32 s33, s55, 0x10000000
    s_cselect_b32 s57, 0x10000000, s55
    s_mov_b32 exec_hi, 0
    buffer_load_dword v89, v90, s[4:7], s33 offen sc1
    s_mov_b32 exec_hi, -1
    v_lshrrev_b32 v94, 5, v95
    v_mul_u32_u24 v94, 164864, v94
    v_lshl_add_u32 v94, v0, 3, v94
    s_add_u32 s33, s40, 168960
    s_cmp_lg_u32 s61, 0
    s_cselect_b32 s33, s33, 0x10000000
    buffer_load_dword v89, v94, s[4:7], s33 offen sc1
    buffer_load_dword v92, v91, s[16:19], 0 offen sc1
    s_waitcnt vmcnt(11)
    s_waitcnt vmcnt(7)
    s_barrier
    v_add_u32 v86, s64, v76
    v_add_u32 v85, s64, v77
    v_add_u32 v84, s64, v78
    v_add_u32 v93, s64, v79
    ds_read_b64_tr_b16 v[12:13], v86 offset:0
    ds_read_b64_tr_b16 v[14:15], v86 offset:512
    ds_read_b64_tr_b16 v[16:17], v84 offset:0
    ds_read_b64_tr_b16 v[18:19], v84 offset:512
    ds_read_b64_tr_b16 v[20:21], v85 offset:0
    ds_read_b64_tr_b16 v[22:23], v85 offset:512
    ds_read_b64_tr_b16 v[24:25], v93 offset:0
    ds_read_b64_tr_b16 v[26:27], v93 offset:512
    v_add_u32 v86, s65, v76
    v_add_u32 v85, s65, v77
    v_add_u32 v84, s65, v78
    v_add_u32 v93, s65, v79
    ds_read_b64_tr_b16 v[28:29], v86 offset:0
    ds_read_b64_tr_b16 v[30:31], v86 offset:512
    ds_read_b64_tr_b16 v[32:33], v84 offset:0
    ds_read_b64_tr_b16 v[34:35], v84 offset:512
    ds_read_b64_tr_b16 v[36:37], v85 offset:0
    ds_read_b64_tr_b16 v[38:39], v85 offset:512
    ds_read_b64_tr_b16 v[40:41], v93 offset:0
    ds_read_b64_tr_b16 v[42:43], v93 offset:512
    v_add_u32 v86, s66, v76
    v_add_u32 v85, s66, v77
    v_add_u32 v84, s66, v78
    v_add_u32 v93, s66, v79
    ds_read_b64_tr_b16 v[44:45], v86 offset:0
    ds_read_b64_tr_b16 v[46:47], v86 offset:512
    ds_read_b64_tr_b16 v[48:49], v84 offset:0
    ds_read_b64_tr_b16 v[50:51], v84 offset:512
    ds_read_b64_tr_b16 v[52:53], v85 offset:0
    ds_read_b64_tr_b16 v[54:55], v85 offset:512
    ds_read_b64_tr_b16 v[56:57], v93 offset:0
    ds_read_b64_tr_b16 v[58:59], v93 offset:512
    v_add_u32 v86, s67, v76
    v_add_u32 v85, s67, v77
    v_add_u32 v84, s67, v78
    v_add_u32 v93, s67, v79
    ds_read_b64_tr_b16 v[60:61], v86 offset:0
    ds_read_b64_tr_b16 v[62:63], v86 offset:512
    ds_read_b64_tr_b16 v[64:65], v84 offset:0
    ds_read_b64_tr_b16 v[66:67], v84 offset:512
    ds_read_b64_tr_b16 v[68:69], v85 offset:0
    ds_read_b64_tr_b16 v[70:71], v85 offset:512
    ds_read_b64_tr_b16 v[72:73], v93 offset:0
    ds_read_b64_tr_b16 v[74:75], v93 offset:512
    s_waitcnt lgkmcnt(0)
    s_barrier
    ds_write_b128 v1, v[12:15] offset:0
    ds_write_b128 v1, v[16:19] offset:1024
    ds_write_b128 v1, v[20:23] offset:2048
    ds_write_b128 v1, v[24:27] offset:3072
    ds_write_b128 v1, v[28:31] offset:4096
    ds_write_b128 v1, v[32:35] offset:5120
    ds_write_b128 v1, v[36:39] offset:6144
    ds_write_b128 v1, v[40:43] offset:7168
    ds_write_b128 v1, v[44:47] offset:8192
    ds_write_b128 v1, v[48:51] offset:9216
    ds_write_b128 v1, v[52:55] offset:10240
    ds_write_b128 v1, v[56:59] offset:11264
    ds_write_b128 v1, v[60:63] offset:12288
    ds_write_b128 v1, v[64:67] offset:13312
    ds_write_b128 v1, v[68:71] offset:14336
    ds_write_b128 v1, v[72:75] offset:15360
    s_waitcnt vmcnt(3)
    s_barrier
    ds_read_b64_tr_b16 v[12:13], v76 offset:16384
    ds_read_b64_tr_b16 v[14:15], v76 offset:16896
    ds_read_b64_tr_b16 v[16:17], v78 offset:16384
    ds_read_b64_tr_b16 v[18:19], v78 offset:16896
    ds_read_b64_tr_b16 v[20:21], v77 offset:16384
    ds_read_b64_tr_b16 v[22:23], v77 offset:16896
    ds_read_b64_tr_b16 v[24:25], v79 offset:16384
    ds_read_b64_tr_b16 v[26:27], v79 offset:16896
    s_waitcnt lgkmcnt(0)
    s_barrier
    ds_write_b128 v1, v[12:15] offset:16384
    ds_write_b128 v1, v[16:19] offset:17408
    ds_write_b128 v1, v[20:23] offset:18432
    ds_write_b128 v1, v[24:27] offset:19456
    s_waitcnt vmcnt(0) lgkmcnt(0)
    v_mov_b32 v14, v92
    v_mov_b32 v18, v90
    s_mov_b32 s34, 0
    s_cmp_lg_u32 s22, 0
    s_cbranch_scc1 L_cd_1
    s_mov_b32 s32, 262144
    v_mbcnt_lo_u32_b32 v15, -1, 0
    v_mbcnt_hi_u32_b32 v15, -1, v15
    v_lshlrev_b32 v15, 2, v15
    s_branch L_c_2_l
L_c_2:
    s_sleep 4
    buffer_load_dword v14, v15, s[16:19], 0 offen sc1
    s_sub_u32 s32, s32, 1
    s_cbranch_scc1 L_abort
    s_waitcnt vmcnt(0)
L_c_2_l:
    v_cmp_lt_u32 vcc, 32, v14
    v_readlane_b32 s36, v14, 48
    v_readlane_b32 s34, v14, 50
    s_and_b32 s33, vcc_lo, 0x10001
    s_and_b32 s35, vcc_hi, 0x3f
    s_or_b32 s33, s33, s35
    s_cbranch_scc1 L_recheck
    v_cmp_ne_u32 vcc, 32, v14
    s_nop 0
    s_and_b32 s33, vcc_lo, 0x10001
    s_and_b32 s35, vcc_hi, 0x3f
    s_or_b32 s33, s33, s35
    s_cbranch_scc1 L_c_2
    s_cmp_lt_u32 s36, 192
    s_cbranch_scc1 L_c_2
    s_cmp_lt_u32 s34, 48
    s_cbranch_scc1 L_c_2
L_cd_1:
    s_lshl_b32 s33, s20, 1
    s_lshr_b32 s35, s34, s33
    s_and_b32 s35, s35, 3
    s_lshl_b32 s35, s35, 13
    s_add_u32 s44, s44, s35
    s_xor_b32 s33, s33, 2
    s_lshr_b32 s35, s34, s33
    s_and_b32 s35, s35, 3
    s_lshl_b32 s35, s35, 13
    s_add_u32 s42, s42, s35
    s_add_u32 s35, s23, 1
    s_min_u32 s35, s35, 63
    s_cmp_lt_u32 s35, s60
    s_cbranch_scc1 Rfi_kv_oki
    s_mov_b32 s32, 262144
    v_and_b32 v36, 16, v0
    v_mul_u32_u24 v36, 264, v36
Rfi_kv_pi:
    buffer_load_dword v37, v36, s[4:7], s59 offen sc1
    s_sub_u32 s32, s32, 1
    s_cbranch_scc1 L_abort
    s_waitcnt vmcnt(0)
    v_readlane_b32 s33, v37, 0
    v_readlane_b32 s34, v37, 1
    s_nop 1
    s_min_u32 s60, s33, s34
    s_cmp_lt_u32 s35, s60
    s_cbranch_scc0 Rfi_kv_pi
Rfi_kv_oki:
    s_mov_b32 exec_hi, 0
    buffer_load_dword v8, v18, s[4:7], s57 offen sc1
    s_mov_b32 exec_hi, -1
Rf_start:
    s_mov_b32 s8, 0x3f803f80
    s_mov_b32 s9, 0x3f803f80
    s_mov_b32 s10, 0x3f003f00
    s_mov_b32 s11, 0x3f003f00
    s_mov_b32 s12, 0xffffff7f
    s_lshl_b32 s13, s3, 10
    s_lshl_b32 s14, s3, 8
    s_add_u32 s14, s14, 4096
    s_movk_i32 s53, 4096
    s_lshl_b32 s15, s3, 11
    s_lshl_b32 s33, s20, 5
    s_add_u32 s33, s33, s21
    s_lshl_b32 s33, s33, 2
    s_add_u32 s33, s33, s3
    s_and_b32 s57, s44, 0x6000
    s_add_u32 s57, s57, 71310336
    s_cmp_eq_u32 s33, 64
    s_cselect_b32 s57, s57, 0x10000000
    s_cmp_eq_u32 s3, 3
    s_cselect_b32 s58, s59, 0x20000000
    s_sub_u32 s58, s58, 786432
    v_lshrrev_b32 v3, 8, v0
    v_lshrrev_b32 v12, 1, v0
    v_mad_u32_u24 v3, v3, s53, v12
    v_mov_b64 v[12:13], 0
    v_mov_b64 v[14:15], 0
    v_mov_b64 v[16:17], 0
    v_mov_b64 v[18:19], 0
    v_mov_b64 v[20:21], 0
    v_mov_b64 v[22:23], 0
    v_mov_b64 v[24:25], 0
    v_mov_b64 v[26:27], 0
    v_mov_b64 v[28:29], 0
    v_mov_b64 v[30:31], 0
    v_mov_b64 v[32:33], 0
    v_mov_b64 v[34:35], 0
    s_and_b32 s33, s23, 3
    s_lshl_b32 s33, s33, 13
    s_add_u32 s41, s37, s33
    s_add_u32 s43, s39, s33
    s_xor_b32 s34, s33, 16384
    s_add_u32 s45, s39, s34
    s_branch Rf_loop
.p2align 5
Rf_loop:
    s_barrier
Rf_loop2:
    s_mov_b32 s32, 262144
    s_add_u32 s52, s47, 33792
    s_add_u32 m0, s13, 5120
    v_mov_b64 v[12:13], 0
    v_mov_b64 v[14:15], 0
    v_mov_b64 v[16:17], 0
    v_mov_b64 v[18:19], 0
    v_mov_b64 v[20:21], 0
    v_mov_b64 v[22:23], 0
    v_mov_b64 v[28:29], 0
    v_mov_b64 v[30:31], 0
    v_mov_b64 v[32:33], 0
    v_mov_b64 v[34:35], 0
    v_mov_b64 v[24:25], 0
    v_mov_b64 v[26:27], 0
    ds_read_b128 v[64:67], v1 offset:0
    ds_read_b128 v[68:71], v1 offset:1024
    ds_read_b128 v[72:75], v1 offset:2048
    ds_read_b128 v[76:79], v1 offset:3072
    ds_read_b128 v[80:83], v1 offset:4096
    ds_read_b128 v[84:87], v1 offset:5120
    buffer_load_dwordx4 v[40:43], v2, s[4:7], s41 offen sc1
    buffer_load_dword v48, v7, s[4:7], s41 offen sc1
    v_mov_b64 v[56:57], -1
    v_mov_b64 v[58:59], -1
    s_add_u32 s48, s38, s50
    s_add_u32 s54, s48, 33792
    buffer_store_dwordx4 v[56:59], v4, s[4:7], s48 offen
    s_mov_b64 exec, 0xffff
    buffer_store_dwordx4 v[56:59], v4, s[4:7], s54 offen
    s_mov_b64 exec, -1
    buffer_store_dword v56, v5, s[4:7], s45 offen
    s_waitcnt vmcnt(3)
Rf_op:
    ds_write_b32 v7, v48 offset:0
    ds_write_b128 v2, v[40:43] offset:0
    v_max3_u32 v49, v40, v41, v42
    v_max3_u32 v49, v49, v43, v48
    v_cmp_eq_u32 vcc, -1, v49
    v_smfmac_f32_16x16x64_bf16 v[12:15], v[40:43], v[176:183], v6 abid:1
    v_smfmac_f32_16x16x64_bf16 v[20:23], v[40:43], v[192:199], v6 abid:1
    s_cbranch_vccnz Rf_o2
Rf_og:
    s_waitcnt lgkmcnt(0)
    s_barrier
    ds_read_b128 v[56:59], v9 offset:0
    v_smfmac_f32_16x16x64_bf16 v[16:19], v[40:43], v[184:191], v6 abid:1
    buffer_load_dwordx4 v[44:47], v2, s[4:7], s42 offen sc1
    v_smfmac_f32_16x16x64_bf16 v[28:31], v[40:43], v[64:71], v6 abid:1
    ds_read_b128 v[64:67], v1 offset:6144
    v_smfmac_f32_16x16x64_bf16 v[24:27], v[40:43], v[200:207], v6 abid:1
    buffer_load_dword v48, v7, s[4:7], s42 offen sc1
    v_smfmac_f32_16x16x64_bf16 v[32:35], v[40:43], v[72:79], v6 abid:1
    ds_read_b128 v[68:71], v1 offset:7168
    s_waitcnt lgkmcnt(2)
    v_smfmac_f32_16x16x64_bf16 v[12:15], v[56:59], v[208:215], v6 abid:1
    ds_read_b128 v[60:63], v10 offset:0
    v_smfmac_f32_16x16x64_bf16 v[20:23], v[56:59], v[224:231], v6 abid:1
    ds_read_b128 v[72:75], v1 offset:8192
    v_smfmac_f32_16x16x64_bf16 v[28:31], v[56:59], v[80:87], v6 abid:1
    buffer_load_dwordx4 v2, s[4:7], s42 offen sc1 lds
    s_add_u32 m0, s14, 5120
    v_smfmac_f32_16x16x64_bf16 v[16:19], v[56:59], v[216:223], v6 abid:1
    ds_read_b128 v[76:79], v1 offset:9216
    v_lshl_add_u32 v8, v0, 3, s15
    v_smfmac_f32_16x16x64_bf16 v[24:27], v[56:59], v[232:239], v6 abid:1
    ds_read_b128 v[80:83], v1 offset:10240
    s_waitcnt lgkmcnt(4)
    v_smfmac_f32_16x16x64_bf16 v[32:35], v[56:59], v[64:71], v6 abid:1
    ds_read_b128 v[84:87], v1 offset:11264
    s_waitcnt lgkmcnt(4)
    v_smfmac_f32_16x16x64_bf16 v[12:15], v[60:63], v[240:247], v6 abid:1
    buffer_load_dword v7, s[4:7], s42 offen sc1 lds
    v_smfmac_f32_16x16x64_bf16 v[20:23], v[60:63], a[0:7], v6 abid:1
    ds_read_b128 v[36:39], v11 offset:0
    s_sub_u32 s35, s58, s55
    v_writelane_b32 v8, s35, 32
    s_waitcnt lgkmcnt(3)
    v_smfmac_f32_16x16x64_bf16 v[28:31], v[60:63], v[72:79], v6 abid:1
    ds_read_b128 v[64:67], v1 offset:12288
    v_smfmac_f32_16x16x64_bf16 v[16:19], v[60:63], v[248:255], v6 abid:1
    ds_read_b128 v[68:71], v1 offset:13312
    v_smfmac_f32_16x16x64_bf16 v[24:27], v[60:63], a[8:15], v6 abid:1
    buffer_load_dwordx4 v[88:91], v0, s[4:7], s56 offen sc1
    s_waitcnt lgkmcnt(3)
    v_smfmac_f32_16x16x64_bf16 v[32:35], v[60:63], v[80:87], v6 abid:1
    ds_read_b128 v[72:75], v1 offset:14336
    s_add_u32 s35, s35, 4224
    v_writelane_b32 v8, s35, 33
    s_waitcnt lgkmcnt(3)
    v_smfmac_f32_16x16x64_bf16 v[12:15], v[36:39], a[16:23], v6 abid:1
    ds_read_b128 v[76:79], v1 offset:15360
    v_smfmac_f32_16x16x64_bf16 v[20:23], v[36:39], a[32:39], v6 abid:1
    ds_read_b128 v[52:55], v0 offset:4096
    s_waitcnt lgkmcnt(3)
    v_smfmac_f32_16x16x64_bf16 v[28:31], v[36:39], v[64:71], v6 abid:1
    buffer_load_dwordx4 v[92:95], v0, s[4:7], s56 offen offset:1024 sc1
    v_smfmac_f32_16x16x64_bf16 v[16:19], v[36:39], a[24:31], v6 abid:1
    ds_read_b128 v[84:87], v1 offset:33792
    ds_read_b128 v[80:83], v1 offset:32768
    v_smfmac_f32_16x16x64_bf16 v[24:27], v[36:39], a[40:47], v6 abid:1
    ds_read_b128 v[64:67], v1 offset:34816
    s_waitcnt lgkmcnt(4)
    v_smfmac_f32_16x16x64_bf16 v[32:35], v[36:39], v[72:79], v6 abid:1
    ds_read_b128 v[68:71], v1 offset:35840
    s_waitcnt lgkmcnt(4)
    v_smfmac_f32_16x16x64_bf16 v[12:15], v[52:55], a[48:55], v6 abid:1
    buffer_load_dwordx4 v[56:59], v0, s[4:7], s55 offen sc1
    v_smfmac_f32_16x16x64_bf16 v[20:23], v[52:55], a[64:71], v6 abid:1
    ds_read_b128 v[72:75], v1 offset:20480
    s_waitcnt vmcnt(6)
    v_max3_u32 v49, v44, v45, v46
    s_waitcnt lgkmcnt(3)
    v_smfmac_f32_16x16x64_bf16 v[28:31], v[52:55], v[80:87], v6 abid:1
    ds_read_b128 v[76:79], v1 offset:21504
    s_waitcnt vmcnt(5)
    v_max3_u32 v49, v49, v47, v48
    v_smfmac_f32_16x16x64_bf16 v[16:19], v[52:55], a[56:63], v6 abid:1
    ds_read_b128 v[80:83], v1 offset:22528
    v_cmp_eq_u32 vcc, -1, v49
    v_smfmac_f32_16x16x64_bf16 v[24:27], v[52:55], a[72:79], v6 abid:1
    buffer_load_dwordx4 v[60:63], v0, s[4:7], s55 offen offset:1024 sc1
    s_waitcnt lgkmcnt(3)
    v_smfmac_f32_16x16x64_bf16 v[32:35], v[52:55], v[64:71], v6 abid:1
    s_cbranch_vccnz Rf_xr
Rf_xb:
    v_smfmac_f32_16x16x64_bf16 v[12:15], v[44:47], a[80:87], v6 abid:1
    s_waitcnt vmcnt(4)
    s_barrier
    ds_read_b128 v[40:43], v9 offset:5120
    s_add_u32 s55, s55, 786432
    s_add_u32 s56, s56, 786432
    v_smfmac_f32_16x16x64_bf16 v[20:23], v[44:47], a[96:103], v6 abid:1
    s_mov_b32 exec_hi, 3
    buffer_load_dword v8, v8, s[4:7], s55 offen sc1
    s_mov_b32 exec_hi, -1
    v_smfmac_f32_16x16x64_bf16 v[16:19], v[44:47], a[88:95], v6 abid:1
    ds_read_b128 v[84:87], v1 offset:23552
    v_smfmac_f32_16x16x64_bf16 v[24:27], v[44:47], a[104:111], v6 abid:1
    ds_read_b128 v[48:51], v10 offset:5120
    s_waitcnt lgkmcnt(2)
    v_smfmac_f32_16x16x64_bf16 v[12:15], v[40:43], a[112:119], v6 abid:1
    ds_read_b128 v[36:39], v11 offset:5120
    v_smfmac_f32_16x16x64_bf16 v[20:23], v[40:43], v[72:79], v6 abid:1
    ds_read_b128 v[64:67], v1 offset:24576
    v_smfmac_f32_16x16x64_bf16 v[16:19], v[40:43], a[120:127], v6 abid:1
    ds_read_b128 v[68:71], v1 offset:25600
    s_waitcnt lgkmcnt(4)
    v_smfmac_f32_16x16x64_bf16 v[24:27], v[40:43], v[80:87], v6 abid:1
    ds_read_b128 v[72:75], v1 offset:26624
    s_waitcnt lgkmcnt(4)
    v_smfmac_f32_16x16x64_bf16 v[12:15], v[48:51], a[144:151], v6 abid:1
    ds_read_b128 v[76:79], v1 offset:27648
    v_smfmac_f32_16x16x64_bf16 v[20:23], v[48:51], a[160:167], v6 abid:1
    ds_read_b128 v[52:55], v0 offset:9216
    v_smfmac_f32_16x16x64_bf16 v[16:19], v[48:51], a[152:159], v6 abid:1
    ds_read_b128 v[80:83], v1 offset:28672
    v_smfmac_f32_16x16x64_bf16 v[24:27], v[48:51], a[168:175], v6 abid:1
    ds_read_b128 v[84:87], v1 offset:29696
    s_waitcnt lgkmcnt(7)
    v_smfmac_f32_16x16x64_bf16 v[12:15], v[36:39], a[192:199], v6 abid:1
    s_waitcnt lgkmcnt(5)
    v_smfmac_f32_16x16x64_bf16 v[20:23], v[36:39], v[64:71], v6 abid:1
    ds_read_b128 v[64:67], v1 offset:30720
    v_smfmac_f32_16x16x64_bf16 v[16:19], v[36:39], a[200:207], v6 abid:1
    ds_read_b128 v[68:71], v1 offset:31744
    s_waitcnt lgkmcnt(5)
    v_smfmac_f32_16x16x64_bf16 v[24:27], v[36:39], v[72:79], v6 abid:1
    ds_read_b128 v[72:75], v0 offset:13312
    s_waitcnt lgkmcnt(5)
    v_smfmac_f32_16x16x64_bf16 v[12:15], v[52:55], a[224:231], v6 abid:1
    v_smfmac_f32_16x16x64_bf16 v[20:23], v[52:55], a[240:247], v6 abid:1
    v_smfmac_f32_16x16x64_bf16 v[16:19], v[52:55], a[232:239], v6 abid:1
    v_cvt_pk_bf16_f32 v12, v12, v13
    v_smfmac_f32_16x16x64_bf16 v[24:27], v[52:55], a[248:255], v6 abid:1
    s_waitcnt lgkmcnt(0)
    v_cvt_pk_bf16_f32 v13, v14, v15
    v_cvt_pk_bf16_f32 v14, v20, v21
    v_cvt_pk_bf16_f32 v15, v22, v23
    v_cvt_pk_bf16_f32 v16, v16, v17
    v_cvt_pk_bf16_f32 v17, v18, v19
    v_mfma_f32_16x16x32_bf16 v[20:23], v[12:15], v[72:75], 0
    v_cvt_pk_bf16_f32 v18, v24, v25
    v_cvt_pk_bf16_f32 v19, v26, v27
    s_waitcnt vmcnt(1)
    s_nop 0
    v_mfma_f32_16x16x32_bf16 v[24:27], v[16:19], v[72:75], 0
    ds_read_b128 v[72:75], v1 offset:16384
    s_nop 0
    v_cvt_pk_bf16_f32 v20, v20, v21
    v_cvt_pk_bf16_f32 v21, v22, v23
    v_smfmac_f32_16x16x64_bf16 v[28:31], v[44:47], v[80:87], v6 abid:1
    ds_read_b128 v[76:79], v1 offset:17408
    s_nop 1
    v_cvt_pk_bf16_f32 v22, v24, v25
    v_cvt_pk_bf16_f32 v23, v26, v27
    s_nop 1
    v_mfma_f32_16x16x32_bf16 v[24:27], v[20:23], v[20:23], 0
    ds_read_b128 v[80:83], v1 offset:18432
    v_mfma_f32_16x16x32_bf16 v[12:15], v[56:59], v[20:23], 0
    ds_read_b128 v[84:87], v1 offset:19456
    v_mfma_f32_16x16x32_bf16 v[16:19], v[60:63], v[20:23], 0
    v_permlane32_swap_b32 v24, v26
    v_permlane32_swap_b32 v25, v27
    v_xor_b32 v60, 256, v7
    v_xor_b32 v61, 512, v7
    v_mov_b32_dpp v26, v27 row_ror:8 row_mask:0xf bank_mask:0xc
    v_mov_b32_dpp v12, v16 row_ror:8 row_mask:0xf bank_mask:0xc
    ds_write_b32 v7, v26 offset:0
    v_mov_b32_dpp v13, v17 row_ror:8 row_mask:0xf bank_mask:0xc
    v_mov_b32_dpp v14, v18 row_ror:8 row_mask:0xf bank_mask:0xc
    v_mov_b32_dpp v15, v19 row_ror:8 row_mask:0xf bank_mask:0xc
    v_smfmac_f32_16x16x64_bf16 v[32:35], v[44:47], v[64:71], v6 abid:1
    ds_write_b128 v2, v[12:15] offset:0
    v_smfmac_f32_16x16x64_bf16 v[28:31], v[40:43], a[128:135], v6 abid:1
    v_xor_b32 v62, 768, v7
    v_smfmac_f32_16x16x64_bf16 v[32:35], v[40:43], a[136:143], v6 abid:1
    v_bfe_u32 v63, v0, 8, 1
    v_smfmac_f32_16x16x64_bf16 v[28:31], v[48:51], a[176:183], v6 abid:1
    v_lshlrev_b32 v63, 7, v63
    v_smfmac_f32_16x16x64_bf16 v[32:35], v[48:51], a[184:191], v6 abid:1
    s_waitcnt lgkmcnt(0)
    s_barrier
    ds_read_b128 v[16:19], v9 offset:0
    v_smfmac_f32_16x16x64_bf16 v[28:31], v[36:39], a[208:215], v6 abid:1
    ds_read_b32 v60, v60 offset:0
    ds_read_b128 v[20:23], v10 offset:0
    v_smfmac_f32_16x16x64_bf16 v[32:35], v[36:39], a[216:223], v6 abid:1
    ds_read_b32 v61, v61 offset:0
    ds_read_b128 v[56:59], v11 offset:0
    v_smfmac_f32_16x16x64_bf16 v[28:31], v[52:55], v[72:79], v6 abid:1
    ds_read_b32 v62, v62 offset:0
    v_xor_b32 v27, v63, v2
    v_smfmac_f32_16x16x64_bf16 v[32:35], v[52:55], v[80:87], v6 abid:1
    v_mov_b64 v[40:41], 0
    v_mov_b64 v[44:45], 0
    s_waitcnt lgkmcnt(4)
    v_add_f32 v26, v26, v60
    v_pk_add_f32 v[12:13], v[12:13], v[16:17]
    v_pk_add_f32 v[14:15], v[14:15], v[18:19]
    v_cvt_pk_bf16_f32 v84, v28, v29
    v_cvt_pk_bf16_f32 v85, v30, v31
    s_waitcnt lgkmcnt(0)
    v_pk_add_f32 v[20:21], v[20:21], v[56:57]
    v_pk_add_f32 v[22:23], v[22:23], v[58:59]
    v_add_f32 v61, v61, v62
    v_pk_add_f32 v[12:13], v[12:13], v[20:21]
    v_pk_add_f32 v[14:15], v[14:15], v[22:23]
    v_add_f32 v26, v26, v61
    v_mul_f32 v26, s62, v26
    v_exp_f32 v16, v12
    v_exp_f32 v17, v13
    v_exp_f32 v18, v14
    v_exp_f32 v19, v15
    v_cvt_pk_bf16_f32 v20, v16, v17
    v_cvt_pk_bf16_f32 v21, v18, v19
    v_exp_f32 v24, v26
    v_mov_b32_dpp v22, v20 row_ror:8 row_mask:0xf bank_mask:0xf
    v_mov_b32_dpp v23, v21 row_ror:8 row_mask:0xf bank_mask:0xf
    v_mov_b32_dpp v25, v24 row_ror:8 row_mask:0xf bank_mask:0xf
    v_cvt_pk_bf16_f32 v42, v24, v25
    v_mfma_f32_16x16x32_bf16 v[36:39], v[88:91], v[20:23], 0
    v_cvt_pk_bf16_f32 v43, v24, v25
    v_cvt_pk_bf16_f32 v86, v32, v33
    v_cvt_pk_bf16_f32 v87, v34, v35
    v_mfma_f32_16x16x32_bf16 v[48:51], v[92:95], v[20:23], 0
    v_max3_f32 v56, |v12|, |v13|, |v14|
    v_max3_f32 v56, v56, |v15|, |v26|
    v_mfma_f32_16x16x32_bf16 v[36:39], v[84:87], v[42:45], v[36:39]
    v_cmp_nge_f32 vcc, s46, v56
    v_mov_b64 v[66:67], s[8:9]
    v_mfma_f32_16x16x32_bf16 v[48:51], v[84:87], v[40:43], v[48:51]
    v_mov_b64 v[68:69], s[8:9]
    v_mov_b64 v[64:65], s[10:11]
    s_nop 0
    v_cvt_pk_bf16_f32 v72, v36, v37
    v_mfma_f32_16x16x32_bf16 v[52:55], v[20:23], v[66:69], 0
    v_cvt_pk_bf16_f32 v73, v38, v39
    s_cbranch_vccnz Rf_max
Rf_pvd:
    v_cvt_pk_bf16_f32 v74, v48, v49
    v_cvt_pk_bf16_f32 v75, v50, v51
    v_mfma_f32_16x16x32_bf16 v[52:55], v[42:45], v[64:67], v[52:55]
    ds_write_b128 v27, v[72:75] offset:5120
    v_mov_b32_dpp v72, v72 row_ror:8 row_mask:0xf bank_mask:0xc
    v_mov_b32_dpp v73, v73 row_ror:8 row_mask:0xf bank_mask:0xc
    v_mov_b32_dpp v74, v74 row_ror:8 row_mask:0xf bank_mask:0xc
    v_mov_b32_dpp v75, v75 row_ror:8 row_mask:0xf bank_mask:0xc
    v_and_or_b32 v60, v9, s12, v63
    v_and_or_b32 v61, v10, s12, v63
    v_and_or_b32 v62, v11, s12, v63
    v_mov_b64 v[12:13], 0
    v_mov_b64 v[14:15], 0
    v_mov_b64 v[16:17], 0
    v_mov_b64 v[18:19], 0
    v_smfmac_f32_16x16x64_bf16 v[12:15], v[72:75], v[96:103], v6
    s_waitcnt lgkmcnt(0)
    s_barrier
    ds_read_b128 v[76:79], v60 offset:5120
    v_smfmac_f32_16x16x64_bf16 v[16:19], v[72:75], v[104:111], v6
    ds_read_b128 v[80:83], v61 offset:5120
    ds_read_b128 v[84:87], v62 offset:5120
    v_mfma_f32_16x16x32_bf16 v[56:59], v[72:75], v[160:163], 0
    v_rcp_f32 v52, v52
    v_rcp_f32 v53, v53
    s_waitcnt lgkmcnt(2)
    v_mfma_f32_16x16x32_bf16 v[56:59], v[76:79], v[164:167], v[56:59]
    v_rcp_f32 v54, v54
    s_waitcnt lgkmcnt(1)
    v_mfma_f32_16x16x32_bf16 v[56:59], v[80:83], v[168:171], v[56:59]
    v_rcp_f32 v55, v55
    s_waitcnt lgkmcnt(0)
    v_mfma_f32_16x16x32_bf16 v[56:59], v[84:87], v[172:175], v[56:59]
    v_smfmac_f32_16x16x64_bf16 v[12:15], v[76:79], v[112:119], v6
    v_smfmac_f32_16x16x64_bf16 v[12:15], v[80:83], v[128:135], v6
    v_mul_f32 v56, v56, v52
    v_smfmac_f32_16x16x64_bf16 v[12:15], v[84:87], v[144:151], v6
    v_mul_f32 v57, v57, v53
    v_mul_f32 v58, v58, v54
    v_smfmac_f32_16x16x64_bf16 v[16:19], v[76:79], v[120:127], v6
    v_mul_f32 v59, v59, v55
    v_cvt_pk_bf16_f32 v56, v56, v57
    v_smfmac_f32_16x16x64_bf16 v[16:19], v[80:83], v[136:143], v6
    v_cvt_pk_bf16_f32 v57, v58, v59
    v_smfmac_f32_16x16x64_bf16 v[16:19], v[84:87], v[152:159], v6
    s_mov_b32 exec_hi, 0
    buffer_store_dwordx2 v[56:57], v3, s[4:7], s52 offen
    s_mov_b32 exec_hi, -1
    v_pk_mul_f32 v[12:13], v[12:13], v[52:53]
    v_pk_mul_f32 v[14:15], v[14:15], v[54:55]
    v_cvt_pk_bf16_f32 v12, v12, v13
    v_cvt_pk_bf16_f32 v13, v14, v15
    s_nop 0
    v_pk_mul_f32 v[16:17], v[16:17], v[52:53]
    v_pk_mul_f32 v[18:19], v[18:19], v[54:55]
    v_cvt_pk_bf16_f32 v14, v16, v17
    v_cvt_pk_bf16_f32 v15, v18, v19
    buffer_store_dwordx4 v[12:15], v4, s[4:7], s47 offen
    s_add_u32 s23, s23, 1
    ds_read_b128 v[88:91], v0 offset:14336
    v_mov_b64 v[92:93], 0
    s_add_u32 s42, s42, 32768
    s_add_u32 s44, s44, 32768
    s_and_b32 s33, s23, 3
    s_lshl_b32 s33, s33, 13
    s_add_u32 s41, s37, s33
    s_add_u32 s43, s39, s33
    s_xor_b32 s34, s33, 16384
    s_add_u32 s45, s39, s34
    s_mov_b32 s47, s48
    s_add_u32 s36, s40, s50
    s_add_u32 s50, s50, 168960
    s_cmp_eq_u32 s50, 506880
    s_cselect_b32 s50, 0, s50
    s_cmp_eq_u32 s61, 0
    s_cbranch_scc1 Rf_nored
    s_sleep 3
    buffer_load_dwordx4 v[36:39], v0, s[4:7], s49 offen offset:0 sc1
    buffer_load_dwordx4 v[40:43], v0, s[4:7], s49 offen offset:1024 sc1
    buffer_load_dwordx4 v[44:47], v0, s[4:7], s49 offen offset:2048 sc1
    buffer_load_dwordx4 v[48:51], v0, s[4:7], s49 offen offset:3072 sc1
    s_sleep 2
    buffer_load_dwordx4 v[36:39], v0, s[4:7], s49 offen offset:0 sc1
    buffer_load_dwordx4 v[40:43], v0, s[4:7], s49 offen offset:1024 sc1
    buffer_load_dwordx4 v[44:47], v0, s[4:7], s49 offen offset:2048 sc1
    buffer_load_dwordx4 v[48:51], v0, s[4:7], s49 offen offset:3072 sc1
    s_add_u32 s33, s23, 1
    v_mov_b32 v60, s33
    buffer_store_dword v60, off, s[4:7], s57 sc1
    s_mov_b32 s32, 64
    s_waitcnt lgkmcnt(0)
    s_waitcnt vmcnt(7)
    v_smfmac_f32_16x16x64_bf16 v[92:95], v[88:91], v[36:43], v6
    s_waitcnt vmcnt(5)
    v_smfmac_f32_16x16x64_bf16 v[92:95], v[88:91], v[44:51], v6
    s_nop 7
    v_cmp_u_f32 vcc, v92, v93
    v_add_f32_dpp v60, v92, v92 row_ror:8 row_mask:0xf bank_mask:0xf
    v_add_f32_dpp v61, v93, v93 row_ror:8 row_mask:0xf bank_mask:0xf
    v_cvt_pk_bf16_f32 v94, v60, v61
    s_cbranch_vccnz Rf_ragain
Rf_rg:
    buffer_store_dword v94, v5, s[4:7], s43 offen
    buffer_store_dword v94, v5, s[4:7], s44 offen sc1
    s_mov_b32 s49, s36
Rf_join:
    s_cmp_lt_u32 s23, 63
    s_cbranch_scc1 Rf_loop
    s_endpgm
Rf_ragain:
    buffer_load_dwordx4 v[36:39], v0, s[4:7], s49 offen offset:0 sc1
    buffer_load_dwordx4 v[40:43], v0, s[4:7], s49 offen offset:1024 sc1
    buffer_load_dwordx4 v[44:47], v0, s[4:7], s49 offen offset:2048 sc1
    buffer_load_dwordx4 v[48:51], v0, s[4:7], s49 offen offset:3072 sc1
    v_mov_b64 v[92:93], 0
    s_sub_u32 s32, s32, 1
    s_cbranch_scc1 Rf_rslow
    s_waitcnt vmcnt(7)
    v_smfmac_f32_16x16x64_bf16 v[92:95], v[88:91], v[36:43], v6
    s_waitcnt vmcnt(5)
    v_smfmac_f32_16x16x64_bf16 v[92:95], v[88:91], v[44:51], v6
    s_nop 7
    v_cmp_u_f32 vcc, v92, v93
    v_add_f32_dpp v60, v92, v92 row_ror:8 row_mask:0xf bank_mask:0xf
    v_add_f32_dpp v61, v93, v93 row_ror:8 row_mask:0xf bank_mask:0xf
    v_cvt_pk_bf16_f32 v94, v60, v61
    s_cbranch_vccz Rf_rg
Rf_ragain2:
    buffer_load_dwordx4 v[36:39], v0, s[4:7], s49 offen offset:0 sc1
    buffer_load_dwordx4 v[40:43], v0, s[4:7], s49 offen offset:1024 sc1
    buffer_load_dwordx4 v[44:47], v0, s[4:7], s49 offen offset:2048 sc1
    buffer_load_dwordx4 v[48:51], v0, s[4:7], s49 offen offset:3072 sc1
    v_mov_b64 v[92:93], 0
    s_sub_u32 s32, s32, 1
    s_cbranch_scc1 Rf_rslow
    s_waitcnt vmcnt(6)
    v_smfmac_f32_16x16x64_bf16 v[92:95], v[88:91], v[36:43], v6
    s_waitcnt vmcnt(4)
    v_smfmac_f32_16x16x64_bf16 v[92:95], v[88:91], v[44:51], v6
    s_nop 7
    v_cmp_u_f32 vcc, v92, v93
    v_add_f32_dpp v60, v92, v92 row_ror:8 row_mask:0xf bank_mask:0xf
    v_add_f32_dpp v61, v93, v93 row_ror:8 row_mask:0xf bank_mask:0xf
    v_cvt_pk_bf16_f32 v94, v60, v61
    s_cbranch_vccz Rf_rg
    s_branch Rf_ragain2
Rf_rslow:
    s_mov_b32 s32, 262144
Rf_rsl:
    buffer_load_dwordx4 v[36:39], v0, s[4:7], s49 offen offset:0 sc1
    buffer_load_dwordx4 v[40:43], v0, s[4:7], s49 offen offset:1024 sc1
    buffer_load_dwordx4 v[44:47], v0, s[4:7], s49 offen offset:2048 sc1
    buffer_load_dwordx4 v[48:51], v0, s[4:7], s49 offen offset:3072 sc1
    s_sub_u32 s32, s32, 1
    s_cbranch_scc1 L_abort
    s_waitcnt vmcnt(0)
    v_max3_u32 v60, v36, v37, v38
    v_max3_u32 v60, v60, v39, v40
    v_max3_u32 v60, v60, v41, v42
    v_max3_u32 v60, v60, v43, v44
    v_max3_u32 v60, v60, v45, v46
    v_max3_u32 v60, v60, v47, v48
    v_max3_u32 v60, v60, v49, v50
    v_max_u32 v60, v60, v51
    v_cmp_eq_u32 vcc, -1, v60
    s_cbranch_vccnz Rf_rsl
    s_waitcnt vmcnt(0)
    v_smfmac_f32_16x16x64_bf16 v[92:95], v[88:91], v[36:43], v6
    s_waitcnt vmcnt(0)
    v_smfmac_f32_16x16x64_bf16 v[92:95], v[88:91], v[44:51], v6
    s_nop 7
    v_add_f32_dpp v60, v92, v92 row_ror:8 row_mask:0xf bank_mask:0xf
    v_add_f32_dpp v61, v93, v93 row_ror:8 row_mask:0xf bank_mask:0xf
    v_cvt_pk_bf16_f32 v94, v60, v61
    s_branch Rf_rg
Rf_nored:
    s_waitcnt lgkmcnt(0)
    s_cmp_eq_u32 s3, 3
    s_cbranch_scc0 Rf_join
    s_waitcnt vmcnt(0)
    v_readlane_b32 s33, v8, 32
    v_readlane_b32 s34, v8, 33
    s_nop 1
    s_min_u32 s60, s33, s34
    s_add_u32 s35, s23, 1
    s_min_u32 s35, s35, 63
    s_cmp_lt_u32 s35, s60
    s_cbranch_scc1 Rf_kv_oka
    s_mov_b32 s32, 262144
    v_and_b32 v36, 16, v0
    v_mul_u32_u24 v36, 264, v36
Rf_kv_pa:
    buffer_load_dword v37, v36, s[4:7], s59 offen sc1
    s_sub_u32 s32, s32, 1
    s_cbranch_scc1 L_abort
    s_waitcnt vmcnt(0)
    v_readlane_b32 s33, v37, 0
    v_readlane_b32 s34, v37, 1
    s_nop 1
    s_min_u32 s60, s33, s34
    s_cmp_lt_u32 s35, s60
    s_cbranch_scc0 Rf_kv_pa
Rf_kv_oka:
    s_branch Rf_join
Rf_o2:
    buffer_load_dwordx4 v[40:43], v2, s[4:7], s41 offen sc1
    buffer_load_dword v48, v7, s[4:7], s41 offen sc1
    s_sub_u32 s32, s32, 1
    s_cbranch_scc1 L_abort
    s_nop 2
    v_mov_b64 v[12:13], 0
    v_mov_b64 v[14:15], 0
    v_mov_b64 v[20:21], 0
    v_mov_b64 v[22:23], 0
    s_waitcnt vmcnt(0)
    s_branch Rf_op
Rf_xr:
    s_mov_b32 s32, 262144
Rf_xl:
    buffer_load_dwordx4 v[44:47], v2, s[4:7], s42 offen sc1
    buffer_load_dword v48, v7, s[4:7], s42 offen sc1
    s_sub_u32 s32, s32, 1
    s_cbranch_scc1 L_abort
    s_waitcnt vmcnt(0)
    ds_write_b32 v7, v48 offset:5120
    ds_write_b128 v2, v[44:47] offset:5120
    v_max3_u32 v49, v44, v45, v46
    v_max3_u32 v49, v49, v47, v48
    v_cmp_eq_u32 vcc, -1, v49
    s_cbranch_vccnz Rf_xl
    s_waitcnt lgkmcnt(0)
    s_branch Rf_xb
Rf_max:
    v_max3_f32 v56, v12, v13, v14
    v_max3_f32 v56, v56, v15, v26
    s_nop 1
    v_max_f32_dpp v57, v56, v56 row_ror:8 row_mask:0xf bank_mask:0xf
    v_max_f32_dpp v58, v56, v56 row_ror:8 row_mask:0xf bank_mask:0xf
    s_nop 1
    v_permlane16_swap_b32 v57, v58
    v_max_f32 v56, v57, v58
    v_max_f32 v58, v57, v58
    s_nop 1
    v_permlane32_swap_b32 v56, v58
    v_max_f32 v56, v56, v58
    v_sub_f32 v12, v12, v56
    v_sub_f32 v13, v13, v56
    v_sub_f32 v14, v14, v56
    v_sub_f32 v15, v15, v56
    v_sub_f32 v26, v26, v56
    v_exp_f32 v16, v12
    v_exp_f32 v17, v13
    v_exp_f32 v18, v14
    v_exp_f32 v19, v15
    v_cvt_pk_bf16_f32 v20, v16, v17
    v_cvt_pk_bf16_f32 v21, v18, v19
    v_exp_f32 v24, v26
    v_mov_b32_dpp v22, v20 row_ror:8 row_mask:0xf bank_mask:0xf
    v_mov_b32_dpp v23, v21 row_ror:8 row_mask:0xf bank_mask:0xf
    v_mov_b32_dpp v25, v24 row_ror:8 row_mask:0xf bank_mask:0xf
    v_cvt_pk_bf16_f32 v42, v24, v25
    v_mfma_f32_16x16x32_bf16 v[36:39], v[88:91], v[20:23], 0
    v_cvt_pk_bf16_f32 v43, v24, v25
    v_cvt_pk_bf16_f32 v86, v32, v33
    v_cvt_pk_bf16_f32 v87, v34, v35
    v_mfma_f32_16x16x32_bf16 v[48:51], v[92:95], v[20:23], 0
    s_nop 0
    v_mfma_f32_16x16x32_bf16 v[36:39], v[84:87], v[42:45], v[36:39]
    v_mov_b64 v[66:67], s[8:9]
    v_mfma_f32_16x16x32_bf16 v[48:51], v[84:87], v[40:43], v[48:51]
    v_mov_b64 v[68:69], s[8:9]
    v_mov_b64 v[64:65], s[10:11]
    s_nop 0
    v_cvt_pk_bf16_f32 v72, v36, v37
    v_mfma_f32_16x16x32_bf16 v[52:55], v[20:23], v[66:69], 0
    v_cvt_pk_bf16_f32 v73, v38, v39
    s_branch Rf_pvd
L_exit0:
    s_endpgm
L_bulk:
    s_sub_u32 s37, s20, 2
    s_lshl_b32 s37, s37, 5
    s_add_u32 s37, s37, s21
    s_load_dwordx2 s[8:9], s[0:1], 8
    s_mov_b32 s10, 10240
    s_mov_b32 s11, 0x20000
    v_mbcnt_lo_u32_b32 v5, -1, 0
    v_mbcnt_hi_u32_b32 v5, -1, v5
    s_lshl_b32 s33, s3, 6
    v_add_u32 v5, s33, v5
    v_lshlrev_b32 v6, 4, v5
    v_lshlrev_b32 v7, 2, v5
    v_add_u32 v7, 4096, v7
    v_mov_b64 v[8:9], -1
    v_mov_b64 v[10:11], -1
    v_mov_b32 v12, 0
    s_add_u32 s38, s37, 0
    s_add_u32 s33, s38, 8708
    s_lshl_b32 s33, s33, 13
    s_cmp_ge_u32 s38, 252
    s_cselect_b32 s34, 2129920, 0
    s_add_u32 s33, s33, s34
    buffer_store_dwordx4 v[8:11], v6, s[4:7], s33 offen sc1
    buffer_store_dword v8, v7, s[4:7], s33 offen sc1
    s_add_u32 s38, s37, 192
    s_add_u32 s33, s38, 8708
    s_lshl_b32 s33, s33, 13
    s_cmp_ge_u32 s38, 252
    s_cselect_b32 s34, 2129920, 0
    s_add_u32 s33, s33, s34
    buffer_store_dwordx4 v[8:11], v6, s[4:7], s33 offen sc1
    buffer_store_dword v8, v7, s[4:7], s33 offen sc1
    s_add_u32 s38, s37, 384
    s_add_u32 s33, s38, 8708
    s_lshl_b32 s33, s33, 13
    s_cmp_ge_u32 s38, 252
    s_cselect_b32 s34, 2129920, 0
    s_add_u32 s33, s33, s34
    s_sub_u32 s34, s38, 504
    s_lshl_b32 s34, s34, 13
    s_add_u32 s34, s34, 2228224
    s_add_u32 s34, s34, s22
    s_and_b32 s35, s38, 3
    s_cselect_b32 s34, s34, 268435456
    s_cmp_ge_u32 s38, 504
    s_cselect_b32 s33, s34, s33
    s_sub_u32 s34, s38, 512
    s_mul_i32 s34, s34, 5120
    s_add_u32 s34, s34, 2293760
    s_add_u32 s34, s34, s22
    s_cmp_ge_u32 s38, 512
    s_cselect_b32 s33, s34, s33
    s_sub_u32 s34, s38, 710
    s_mul_i32 s34, s34, 5120
    s_add_u32 s34, s34, 98304000
    s_cmp_ge_u32 s38, 710
    s_cselect_b32 s33, s34, s33
    s_cmp_ge_u32 s38, 762
    s_cselect_b32 s33, 268435456, s33
    buffer_store_dwordx4 v[8:11], v6, s[4:7], s33 offen sc1
    buffer_store_dword v8, v7, s[4:7], s33 offen sc1
    s_add_u32 s38, s37, 576
    s_add_u32 s33, s38, 8708
    s_lshl_b32 s33, s33, 13
    s_cmp_ge_u32 s38, 252
    s_cselect_b32 s34, 2129920, 0
    s_add_u32 s33, s33, s34
    s_sub_u32 s34, s38, 504
    s_lshl_b32 s34, s34, 13
    s_add_u32 s34, s34, 2228224
    s_add_u32 s34, s34, s22
    s_and_b32 s35, s38, 3
    s_cselect_b32 s34, s34, 268435456
    s_cmp_ge_u32 s38, 504
    s_cselect_b32 s33, s34, s33
    s_sub_u32 s34, s38, 512
    s_mul_i32 s34, s34, 5120
    s_add_u32 s34, s34, 2293760
    s_add_u32 s34, s34, s22
    s_cmp_ge_u32 s38, 512
    s_cselect_b32 s33, s34, s33
    s_sub_u32 s34, s38, 710
    s_mul_i32 s34, s34, 5120
    s_add_u32 s34, s34, 98304000
    s_cmp_ge_u32 s38, 710
    s_cselect_b32 s33, s34, s33
    s_cmp_ge_u32 s38, 762
    s_cselect_b32 s33, 268435456, s33
    buffer_store_dwordx4 v[8:11], v6, s[4:7], s33 offen sc1
    buffer_store_dword v8, v7, s[4:7], s33 offen sc1
    s_lshl_b32 s33, s37, 10
    s_add_u32 s33, s33, 69201920
    s_cmp_lt_u32 s37, 32
    s_cselect_b32 s33, s33, 268435456
    buffer_store_dword v12, v7, s[4:7], s33 offen sc1
    s_sub_u32 s38, s37, 32
    s_cmp_lt_u32 s38, 10
    s_cbranch_scc0 L_nom0_3
    s_and_b32 s39, s38, 1
    s_lshr_b32 s38, s38, 1
    s_mul_i32 s33, s39, 4194304
    s_lshl_b32 s34, s38, 13
    s_add_u32 s33, s33, s34
    s_add_u32 s33, s33, 71303168
    s_lshl_b32 s34, s39, 15
    s_add_u32 s34, s34, 2228224
    s_add_u32 s34, s34, s22
    s_cmp_eq_u32 s38, 4
    s_cselect_b32 s33, s34, s33
    s_mul_i32 s34, s39, 640
    v_bfe_u32 v13, v6, 6, 2
    v_bfe_u32 v14, v6, 4, 1
    v_lshl_add_u32 v13, v13, 1, v14
    v_mul_u32_u24 v13, 1280, v13
    v_lshrrev_b32 v14, 8, v6
    v_lshl_add_u32 v13, v14, 5, v13
    v_bfe_u32 v14, v6, 5, 1
    v_lshl_add_u32 v13, v14, 4, v13
    v_and_b32 v14, 15, v6
    v_add_u32 v13, v13, v14
    s_waitcnt lgkmcnt(0)
    buffer_load_dwordx4 v[16:19], v13, s[8:11], s34 offen
    v_bfe_u32 v13, v7, 6, 2
    v_bfe_u32 v14, v7, 4, 1
    v_lshl_add_u32 v13, v13, 1, v14
    v_mul_u32_u24 v13, 1280, v13
    v_lshrrev_b32 v14, 8, v7
    v_lshl_add_u32 v13, v14, 5, v13
    v_bfe_u32 v14, v7, 5, 1
    v_lshl_add_u32 v13, v14, 4, v13
    v_and_b32 v14, 15, v7
    v_add_u32 v13, v13, v14
    buffer_load_dword v20, v13, s[8:11], s34 offen
    s_waitcnt vmcnt(1)
    v_min_u32 v16, -2, v16
    v_min_u32 v17, -2, v17
    v_min_u32 v18, -2, v18
    v_min_u32 v19, -2, v19
    s_waitcnt vmcnt(0)
    v_min_u32 v20, -2, v20
    buffer_store_dwordx4 v[16:19], v6, s[4:7], s33 offen sc1
    buffer_store_dword v20, v7, s[4:7], s33 offen sc1
    s_add_u32 s33, s33, 7168
    buffer_store_dword v12, off, s[4:7], s33 sc1
L_nom0_3:
    s_waitcnt lgkmcnt(0)
    s_cmp_lg_u32 s22, 0
    s_cbranch_scc1 L_fb2
    s_waitcnt vmcnt(0)
    s_barrier
    v_mbcnt_lo_u32_b32 v14, -1, 0
    v_mbcnt_hi_u32_b32 v14, -1, v14
    v_or_b32 v14, s3, v14
    v_cmp_eq_u32 vcc, 0, v14
    v_mov_b32 v14, 0x1000
    v_mov_b32 v15, 192
    v_cndmask_b32 v14, v14, v15, vcc
    v_mov_b32 v15, 1
    buffer_atomic_add v15, v14, s[16:19], 0 offen
L_dispatch:
    s_sub_u32 s33, s20, 2
    s_lshl_b32 s33, s33, 5
    s_add_u32 s33, s33, s21
    s_add_u32 s21, s33, 0
    s_sub_u32 s30, s33, 0
    s_mov_b32 s31, 32
    s_cmp_lt_u32 s33, 32
    s_cbranch_scc1 L_role_t
    s_add_u32 s21, s33, 4294967264
    s_sub_u32 s30, s33, 32
    s_mov_b32 s31, 32
    s_cmp_lt_u32 s33, 64
    s_cbranch_scc1 L_role_o0
    s_add_u32 s21, s33, 4294967232
    s_sub_u32 s30, s33, 64
    s_mov_b32 s31, 32
    s_cmp_lt_u32 s33, 96
    s_cbranch_scc1 L_role_p
    s_add_u32 s21, s33, 4294967232
    s_sub_u32 s30, s33, 96
    s_mov_b32 s31, 32
    s_cmp_lt_u32 s33, 128
    s_cbranch_scc1 L_role_p
    s_add_u32 s21, s33, 4294967232
    s_sub_u32 s30, s33, 128
    s_mov_b32 s31, 32
    s_cmp_lt_u32 s33, 160
    s_cbranch_scc1 L_role_p
    s_add_u32 s21, s33, 4294967232
    s_sub_u32 s30, s33, 160
    s_mov_b32 s31, 24
    s_cmp_lt_u32 s33, 184
    s_cbranch_scc1 L_role_bp
    s_add_u32 s21, s33, 4294967144
    s_sub_u32 s30, s33, 184
    s_mov_b32 s31, 8
    s_cmp_lt_u32 s33, 192
    s_cbranch_scc1 L_role_o0
L_idle:
    s_mov_b32 s34, 0
    s_cmp_lg_u32 s22, 0
    s_cbranch_scc1 L_cd_4
    s_mov_b32 s32, 262144
    v_mbcnt_lo_u32_b32 v15, -1, 0
    v_mbcnt_hi_u32_b32 v15, -1, v15
    v_lshlrev_b32 v15, 2, v15
L_c_5:
    s_sleep 4
    buffer_load_dword v14, v15, s[16:19], 0 offen sc1
    s_sub_u32 s32, s32, 1
    s_cbranch_scc1 L_abort
    s_waitcnt vmcnt(0)
L_c_5_l:
    v_cmp_lt_u32 vcc, 32, v14
    v_readlane_b32 s36, v14, 48
    v_readlane_b32 s34, v14, 50
    s_and_b32 s33, vcc_lo, 0x10001
    s_and_b32 s35, vcc_hi, 0x3f
    s_or_b32 s33, s33, s35
    s_cbranch_scc1 L_recheck
    v_cmp_ne_u32 vcc, 32, v14
    s_nop 0
    s_and_b32 s33, vcc_lo, 0x10001
    s_and_b32 s35, vcc_hi, 0x3f
    s_or_b32 s33, s33, s35
    s_cbranch_scc1 L_c_5
    s_cmp_lt_u32 s36, 192
    s_cbranch_scc1 L_c_5
L_cd_4:
    s_endpgm
L_role_o0:
    s_lshr_b32 s33, s21, 1
    s_or_b32 s33, s33, s3
    s_or_b32 s33, s33, s22
    s_cbranch_scc1 L_role_o
    s_mov_b32 s44, -1
    s_mov_b32 s45, -1
    s_mov_b32 s46, -1
    s_mov_b32 s47, -1
    s_mul_i32 s39, s21, 4194304
    s_add_u32 s39, s39, 71309312
    s_add_u32 s37, s39, 196608
    v_mov_b32 v14, 0
L_probe:
    s_memtime s[40:41]
    s_waitcnt lgkmcnt(0)
    buffer_store_dword v14, off, s[4:7], s39 sc1
    s_waitcnt vmcnt(0)
    s_memtime s[42:43]
    s_waitcnt lgkmcnt(0)
    s_sub_u32 s42, s42, s40
    s_min_u32 s44, s44, s42
    s_add_u32 s39, s39, 8192
    s_memtime s[40:41]
    s_waitcnt lgkmcnt(0)
    buffer_store_dword v14, off, s[4:7], s39 sc1
    s_waitcnt vmcnt(0)
    s_memtime s[42:43]
    s_waitcnt lgkmcnt(0)
    s_sub_u32 s42, s42, s40
    s_min_u32 s45, s45, s42
    s_add_u32 s39, s39, 8192
    s_memtime s[40:41]
    s_waitcnt lgkmcnt(0)
    buffer_store_dword v14, off, s[4:7], s39 sc1
    s_waitcnt vmcnt(0)
    s_memtime s[42:43]
    s_waitcnt lgkmcnt(0)
    s_sub_u32 s42, s42, s40
    s_min_u32 s46, s46, s42
    s_add_u32 s39, s39, 8192
    s_memtime s[40:41]
    s_waitcnt lgkmcnt(0)
    buffer_store_dword v14, off, s[4:7], s39 sc1
    s_waitcnt vmcnt(0)
    s_memtime s[42:43]
    s_waitcnt lgkmcnt(0)
    s_sub_u32 s42, s42, s40
    s_min_u32 s47, s47, s42
    s_add_u32 s39, s39, 8192
    s_cmp_lt_u32 s39, s37
    s_cbranch_scc1 L_probe
    s_cmp_lt_u32 s45, s44
    s_cselect_b32 s40, 1, 0
    s_min_u32 s41, s44, s45
    s_cmp_lt_u32 s47, s46
    s_cselect_b32 s42, 3, 2
    s_min_u32 s43, s46, s47
    s_cmp_lt_u32 s43, s41
    s_cselect_b32 s40, s42, s40
    s_xor_b32 s40, s40, 2
    s_lshl_b32 s41, s21, 1
    s_lshl_b32 s40, s40, s41
    s_lshl_b32 s41, 16, s21
    s_or_b32 s40, s40, s41
    v_mov_b32 v14, s40
    s_mov_b64 exec, 1
    buffer_atomic_or v14, off, s[16:19], 0 offset:200
    s_mov_b64 exec, -1
L_role_o:
    s_cmp_ge_u32 s21, 20
    s_cselect_b32 s39, 2, 0
    s_mul_i32 s33, s39, 10
    s_sub_u32 s40, s21, s33
    s_load_dwordx2 s[8:9], s[0:1], 40
    s_mov_b32 s10, 5242880
    s_mov_b32 s11, 0x20000
    s_load_dwordx2 s[24:25], s[0:1], 80
    s_mov_b32 s26, 5242880
    s_mov_b32 s27, 0x20000
    v_mbcnt_lo_u32_b32 v20, -1, 0
    v_mbcnt_hi_u32_b32 v20, -1, v20
    v_lshrrev_b32 v21, 4, v20
    v_and_b32 v22, 15, v20
    v_lshrrev_b32 v6, 2, v20
    v_mul_u32_u24 v6, 1280, v6
    v_and_b32 v7, 3, v20
    v_lshl_add_u32 v23, v7, 4, v6
    s_mul_i32 s37, s3, 40960
    s_mul_i32 s38, s3, 1310720
    s_lshl_b32 s33, s40, 6
    s_add_u32 s38, s38, s33
    v_lshlrev_b32 v8, 3, v7
    v_add_u32 v8, s37, v8
    v_lshrrev_b32 v6, 3, v22
    v_lshlrev_b32 v6, 5, v6
    v_and_b32 v7, 1, v21
    v_lshl_add_u32 v6, v7, 4, v6
    v_lshrrev_b32 v7, 1, v21
    v_lshl_add_u32 v6, v7, 2, v6
    v_bfe_u32 v7, v22, 2, 1
    v_add_u32 v6, v6, v7
    v_lshl_add_u32 v24, v6, 6, v8
    s_waitcnt lgkmcnt(0)
    s_barrier
    s_add_u32 m0, s37, 0
    s_add_u32 s33, s38, 0
    buffer_load_dwordx4 v23, s[8:11], s33 offen lds
    s_add_u32 m0, s37, 1024
    s_add_u32 s33, s38, 20480
    buffer_load_dwordx4 v23, s[8:11], s33 offen lds
    s_add_u32 m0, s37, 2048
    s_add_u32 s33, s38, 40960
    buffer_load_dwordx4 v23, s[8:11], s33 offen lds
    s_add_u32 m0, s37, 3072
    s_add_u32 s33, s38, 61440
    buffer_load_dwordx4 v23, s[8:11], s33 offen lds
    s_add_u32 m0, s37, 4096
    s_add_u32 s33, s38, 81920
    buffer_load_dwordx4 v23, s[8:11], s33 offen lds
    s_add_u32 m0, s37, 5120
    s_add_u32 s33, s38, 102400
    buffer_load_dwordx4 v23, s[8:11], s33 offen lds
    s_add_u32 m0, s37, 6144
    s_add_u32 s33, s38, 122880
    buffer_load_dwordx4 v23, s[8:11], s33 offen lds
    s_add_u32 m0, s37, 7168
    s_add_u32 s33, s38, 143360
    buffer_load_dwordx4 v23, s[8:11], s33 offen lds
    s_add_u32 m0, s37, 8192
    s_add_u32 s33, s38, 163840
    buffer_load_dwordx4 v23, s[8:11], s33 offen lds
    s_add_u32 m0, s37, 9216
    s_add_u32 s33, s38, 184320
    buffer_load_dwordx4 v23, s[8:11], s33 offen lds
    s_add_u32 m0, s37, 10240
    s_add_u32 s33, s38, 204800
    buffer_load_dwordx4 v23, s[8:11], s33 offen lds
    s_add_u32 m0, s37, 11264
    s_add_u32 s33, s38, 225280
    buffer_load_dwordx4 v23, s[8:11], s33 offen lds
    s_add_u32 m0, s37, 12288
    s_add_u32 s33, s38, 245760
    buffer_load_dwordx4 v23, s[8:11], s33 offen lds
    s_add_u32 m0, s37, 13312
    s_add_u32 s33, s38, 266240
    buffer_load_dwordx4 v23, s[8:11], s33 offen lds
    s_add_u32 m0, s37, 14336
    s_add_u32 s33, s38, 286720
    buffer_load_dwordx4 v23, s[8:11], s33 offen lds
    s_add_u32 m0, s37, 15360
    s_add_u32 s33, s38, 307200
    buffer_load_dwordx4 v23, s[8:11], s33 offen lds
    s_add_u32 m0, s37, 16384
    s_add_u32 s33, s38, 327680
    buffer_load_dwordx4 v23, s[8:11], s33 offen lds
    s_add_u32 m0, s37, 17408
    s_add_u32 s33, s38, 348160
    buffer_load_dwordx4 v23, s[8:11], s33 offen lds
    s_add_u32 m0, s37, 18432
    s_add_u32 s33, s38, 368640
    buffer_load_dwordx4 v23, s[8:11], s33 offen lds
    s_add_u32 m0, s37, 19456
    s_add_u32 s33, s38, 389120
    buffer_load_dwordx4 v23, s[8:11], s33 offen lds
    s_add_u32 m0, s37, 20480
    s_add_u32 s33, s38, 409600
    buffer_load_dwordx4 v23, s[8:11], s33 offen lds
    s_add_u32 m0, s37, 21504
    s_add_u32 s33, s38, 430080
    buffer_load_dwordx4 v23, s[8:11], s33 offen lds
    s_add_u32 m0, s37, 22528
    s_add_u32 s33, s38, 450560
    buffer_load_dwordx4 v23, s[8:11], s33 offen lds
    s_add_u32 m0, s37, 23552
    s_add_u32 s33, s38, 471040
    buffer_load_dwordx4 v23, s[8:11], s33 offen lds
    s_add_u32 m0, s37, 24576
    s_add_u32 s33, s38, 491520
    buffer_load_dwordx4 v23, s[8:11], s33 offen lds
    s_add_u32 m0, s37, 25600
    s_add_u32 s33, s38, 512000
    buffer_load_dwordx4 v23, s[8:11], s33 offen lds
    s_add_u32 m0, s37, 26624
    s_add_u32 s33, s38, 532480
    buffer_load_dwordx4 v23, s[8:11], s33 offen lds
    s_add_u32 m0, s37, 27648
    s_add_u32 s33, s38, 552960
    buffer_load_dwordx4 v23, s[8:11], s33 offen lds
    s_add_u32 m0, s37, 28672
    s_add_u32 s33, s38, 573440
    buffer_load_dwordx4 v23, s[8:11], s33 offen lds
    s_add_u32 m0, s37, 29696
    s_add_u32 s33, s38, 593920
    buffer_load_dwordx4 v23, s[8:11], s33 offen lds
    s_add_u32 m0, s37, 30720
    s_add_u32 s33, s38, 614400
    buffer_load_dwordx4 v23, s[8:11], s33 offen lds
    s_add_u32 m0, s37, 31744
    s_add_u32 s33, s38, 634880
    buffer_load_dwordx4 v23, s[8:11], s33 offen lds
    s_add_u32 m0, s37, 32768
    s_add_u32 s33, s38, 655360
    buffer_load_dwordx4 v23, s[8:11], s33 offen lds
    s_add_u32 m0, s37, 33792
    s_add_u32 s33, s38, 675840
    buffer_load_dwordx4 v23, s[8:11], s33 offen lds
    s_add_u32 m0, s37, 34816
    s_add_u32 s33, s38, 696320
    buffer_load_dwordx4 v23, s[8:11], s33 offen lds
    s_add_u32 m0, s37, 35840
    s_add_u32 s33, s38, 716800
    buffer_load_dwordx4 v23, s[8:11], s33 offen lds
    s_add_u32 m0, s37, 36864
    s_add_u32 s33, s38, 737280
    buffer_load_dwordx4 v23, s[8:11], s33 offen lds
    s_add_u32 m0, s37, 37888
    s_add_u32 s33, s38, 757760
    buffer_load_dwordx4 v23, s[8:11], s33 offen lds
    s_add_u32 m0, s37, 38912
    s_add_u32 s33, s38, 778240
    buffer_load_dwordx4 v23, s[8:11], s33 offen lds
    s_add_u32 m0, s37, 39936
    s_add_u32 s33, s38, 798720
    buffer_load_dwordx4 v23, s[8:11], s33 offen lds
    s_waitcnt vmcnt(36)
    ds_read_b64_tr_b16 a[0:1], v24 offset:0
    ds_read_b64_tr_b16 a[2:3], v24 offset:128
    ds_read_b64_tr_b16 a[4:5], v24 offset:512
    ds_read_b64_tr_b16 a[6:7], v24 offset:640
    ds_read_b64_tr_b16 a[8:9], v24 offset:32
    ds_read_b64_tr_b16 a[10:11], v24 offset:160
    ds_read_b64_tr_b16 a[12:13], v24 offset:544
    ds_read_b64_tr_b16 a[14:15], v24 offset:672
    s_waitcnt lgkmcnt(0)
    s_add_u32 m0, s37, 0
    s_add_u32 s33, s38, 819200
    buffer_load_dwordx4 v23, s[8:11], s33 offen lds
    s_add_u32 m0, s37, 1024
    s_add_u32 s33, s38, 839680
    buffer_load_dwordx4 v23, s[8:11], s33 offen lds
    s_add_u32 m0, s37, 2048
    s_add_u32 s33, s38, 860160
    buffer_load_dwordx4 v23, s[8:11], s33 offen lds
    s_add_u32 m0, s37, 3072
    s_add_u32 s33, s38, 880640
    buffer_load_dwordx4 v23, s[8:11], s33 offen lds
    s_waitcnt vmcnt(36)
    ds_read_b64_tr_b16 a[16:17], v24 offset:4096
    ds_read_b64_tr_b16 a[18:19], v24 offset:4224
    ds_read_b64_tr_b16 a[20:21], v24 offset:4608
    ds_read_b64_tr_b16 a[22:23], v24 offset:4736
    ds_read_b64_tr_b16 a[24:25], v24 offset:4128
    ds_read_b64_tr_b16 a[26:27], v24 offset:4256
    ds_read_b64_tr_b16 a[28:29], v24 offset:4640
    ds_read_b64_tr_b16 a[30:31], v24 offset:4768
    s_waitcnt lgkmcnt(0)
    s_add_u32 m0, s37, 4096
    s_add_u32 s33, s38, 901120
    buffer_load_dwordx4 v23, s[8:11], s33 offen lds
    s_add_u32 m0, s37, 5120
    s_add_u32 s33, s38, 921600
    buffer_load_dwordx4 v23, s[8:11], s33 offen lds
    s_add_u32 m0, s37, 6144
    s_add_u32 s33, s38, 942080
    buffer_load_dwordx4 v23, s[8:11], s33 offen lds
    s_add_u32 m0, s37, 7168
    s_add_u32 s33, s38, 962560
    buffer_load_dwordx4 v23, s[8:11], s33 offen lds
    s_waitcnt vmcnt(36)
    ds_read_b64_tr_b16 a[32:33], v24 offset:8192
    ds_read_b64_tr_b16 a[34:35], v24 offset:8320
    ds_read_b64_tr_b16 a[36:37], v24 offset:8704
    ds_read_b64_tr_b16 a[38:39], v24 offset:8832
    ds_read_b64_tr_b16 a[40:41], v24 offset:8224
    ds_read_b64_tr_b16 a[42:43], v24 offset:8352
    ds_read_b64_tr_b16 a[44:45], v24 offset:8736
    ds_read_b64_tr_b16 a[46:47], v24 offset:8864
    s_waitcnt lgkmcnt(0)
    s_add_u32 m0, s37, 8192
    s_add_u32 s33, s38, 983040
    buffer_load_dwordx4 v23, s[8:11], s33 offen lds
    s_add_u32 m0, s37, 9216
    s_add_u32 s33, s38, 1003520
    buffer_load_dwordx4 v23, s[8:11], s33 offen lds
    s_add_u32 m0, s37, 10240
    s_add_u32 s33, s38, 1024000
    buffer_load_dwordx4 v23, s[8:11], s33 offen lds
    s_add_u32 m0, s37, 11264
    s_add_u32 s33, s38, 1044480
    buffer_load_dwordx4 v23, s[8:11], s33 offen lds
    s_waitcnt vmcnt(36)
    ds_read_b64_tr_b16 a[48:49], v24 offset:12288
    ds_read_b64_tr_b16 a[50:51], v24 offset:12416
    ds_read_b64_tr_b16 a[52:53], v24 offset:12800
    ds_read_b64_tr_b16 a[54:55], v24 offset:12928
    ds_read_b64_tr_b16 a[56:57], v24 offset:12320
    ds_read_b64_tr_b16 a[58:59], v24 offset:12448
    ds_read_b64_tr_b16 a[60:61], v24 offset:12832
    ds_read_b64_tr_b16 a[62:63], v24 offset:12960
    s_waitcnt lgkmcnt(0)
    s_add_u32 m0, s37, 12288
    s_add_u32 s33, s38, 1064960
    buffer_load_dwordx4 v23, s[8:11], s33 offen lds
    s_add_u32 m0, s37, 13312
    s_add_u32 s33, s38, 1085440
    buffer_load_dwordx4 v23, s[8:11], s33 offen lds
    s_add_u32 m0, s37, 14336
    s_add_u32 s33, s38, 1105920
    buffer_load_dwordx4 v23, s[8:11], s33 offen lds
    s_add_u32 m0, s37, 15360
    s_add_u32 s33, s38, 1126400
    buffer_load_dwordx4 v23, s[8:11], s33 offen lds
    s_waitcnt vmcnt(36)
    ds_read_b64_tr_b16 a[64:65], v24 offset:16384
    ds_read_b64_tr_b16 a[66:67], v24 offset:16512
    ds_read_b64_tr_b16 a[68:69], v24 offset:16896
    ds_read_b64_tr_b16 a[70:71], v24 offset:17024
    ds_read_b64_tr_b16 a[72:73], v24 offset:16416
    ds_read_b64_tr_b16 a[74:75], v24 offset:16544
    ds_read_b64_tr_b16 a[76:77], v24 offset:16928
    ds_read_b64_tr_b16 a[78:79], v24 offset:17056
    s_waitcnt lgkmcnt(0)
    s_add_u32 m0, s37, 16384
    s_add_u32 s33, s38, 1146880
    buffer_load_dwordx4 v23, s[8:11], s33 offen lds
    s_add_u32 m0, s37, 17408
    s_add_u32 s33, s38, 1167360
    buffer_load_dwordx4 v23, s[8:11], s33 offen lds
    s_add_u32 m0, s37, 18432
    s_add_u32 s33, s38, 1187840
    buffer_load_dwordx4 v23, s[8:11], s33 offen lds
    s_add_u32 m0, s37, 19456
    s_add_u32 s33, s38, 1208320
    buffer_load_dwordx4 v23, s[8:11], s33 offen lds
    s_waitcnt vmcnt(36)
    ds_read_b64_tr_b16 a[80:81], v24 offset:20480
    ds_read_b64_tr_b16 a[82:83], v24 offset:20608
    ds_read_b64_tr_b16 a[84:85], v24 offset:20992
    ds_read_b64_tr_b16 a[86:87], v24 offset:21120
    ds_read_b64_tr_b16 a[88:89], v24 offset:20512
    ds_read_b64_tr_b16 a[90:91], v24 offset:20640
    ds_read_b64_tr_b16 a[92:93], v24 offset:21024
    ds_read_b64_tr_b16 a[94:95], v24 offset:21152
    s_waitcnt lgkmcnt(0)
    s_add_u32 m0, s37, 20480
    s_add_u32 s33, s38, 1228800
    buffer_load_dwordx4 v23, s[8:11], s33 offen lds
    s_add_u32 m0, s37, 21504
    s_add_u32 s33, s38, 1249280
    buffer_load_dwordx4 v23, s[8:11], s33 offen lds
    s_add_u32 m0, s37, 22528
    s_add_u32 s33, s38, 1269760
    buffer_load_dwordx4 v23, s[8:11], s33 offen lds
    s_add_u32 m0, s37, 23552
    s_add_u32 s33, s38, 1290240
    buffer_load_dwordx4 v23, s[8:11], s33 offen lds
    s_waitcnt vmcnt(36)
    ds_read_b64_tr_b16 a[96:97], v24 offset:24576
    ds_read_b64_tr_b16 a[98:99], v24 offset:24704
    ds_read_b64_tr_b16 a[100:101], v24 offset:25088
    ds_read_b64_tr_b16 a[102:103], v24 offset:25216
    ds_read_b64_tr_b16 a[104:105], v24 offset:24608
    ds_read_b64_tr_b16 a[106:107], v24 offset:24736
    ds_read_b64_tr_b16 a[108:109], v24 offset:25120
    ds_read_b64_tr_b16 a[110:111], v24 offset:25248
    s_waitcnt lgkmcnt(0)
    s_waitcnt vmcnt(32)
    ds_read_b64_tr_b16 a[112:113], v24 offset:28672
    ds_read_b64_tr_b16 a[114:115], v24 offset:28800
    ds_read_b64_tr_b16 a[116:117], v24 offset:29184
    ds_read_b64_tr_b16 a[118:119], v24 offset:29312
    ds_read_b64_tr_b16 a[120:121], v24 offset:28704
    ds_read_b64_tr_b16 a[122:123], v24 offset:28832
    ds_read_b64_tr_b16 a[124:125], v24 offset:29216
    ds_read_b64_tr_b16 a[126:127], v24 offset:29344
    s_waitcnt lgkmcnt(0)
    s_waitcnt vmcnt(28)
    ds_read_b64_tr_b16 a[128:129], v24 offset:32768
    ds_read_b64_tr_b16 a[130:131], v24 offset:32896
    ds_read_b64_tr_b16 a[132:133], v24 offset:33280
    ds_read_b64_tr_b16 a[134:135], v24 offset:33408
    ds_read_b64_tr_b16 a[136:137], v24 offset:32800
    ds_read_b64_tr_b16 a[138:139], v24 offset:32928
    ds_read_b64_tr_b16 a[140:141], v24 offset:33312
    ds_read_b64_tr_b16 a[142:143], v24 offset:33440
    s_waitcnt lgkmcnt(0)
    s_waitcnt vmcnt(24)
    ds_read_b64_tr_b16 a[144:145], v24 offset:36864
    ds_read_b64_tr_b16 a[146:147], v24 offset:36992
    ds_read_b64_tr_b16 a[148:149], v24 offset:37376
    ds_read_b64_tr_b16 a[150:151], v24 offset:37504
    ds_read_b64_tr_b16 a[152:153], v24 offset:36896
    ds_read_b64_tr_b16 a[154:155], v24 offset:37024
    ds_read_b64_tr_b16 a[156:157], v24 offset:37408
    ds_read_b64_tr_b16 a[158:159], v24 offset:37536
    s_waitcnt lgkmcnt(0)
    s_waitcnt vmcnt(20)
    ds_read_b64_tr_b16 a[160:161], v24 offset:0
    ds_read_b64_tr_b16 a[162:163], v24 offset:128
    ds_read_b64_tr_b16 a[164:165], v24 offset:512
    ds_read_b64_tr_b16 a[166:167], v24 offset:640
    ds_read_b64_tr_b16 a[168:169], v24 offset:32
    ds_read_b64_tr_b16 a[170:171], v24 offset:160
    ds_read_b64_tr_b16 a[172:173], v24 offset:544
    ds_read_b64_tr_b16 a[174:175], v24 offset:672
    s_waitcnt lgkmcnt(0)
    s_waitcnt vmcnt(16)
    ds_read_b64_tr_b16 a[176:177], v24 offset:4096
    ds_read_b64_tr_b16 a[178:179], v24 offset:4224
    ds_read_b64_tr_b16 a[180:181], v24 offset:4608
    ds_read_b64_tr_b16 a[182:183], v24 offset:4736
    ds_read_b64_tr_b16 a[184:185], v24 offset:4128
    ds_read_b64_tr_b16 a[186:187], v24 offset:4256
    ds_read_b64_tr_b16 a[188:189], v24 offset:4640
    ds_read_b64_tr_b16 a[190:191], v24 offset:4768
    s_waitcnt lgkmcnt(0)
    s_waitcnt vmcnt(12)
    ds_read_b64_tr_b16 a[192:193], v24 offset:8192
    ds_read_b64_tr_b16 a[194:195], v24 offset:8320
    ds_read_b64_tr_b16 a[196:197], v24 offset:8704
    ds_read_b64_tr_b16 a[198:199], v24 offset:8832
    ds_read_b64_tr_b16 a[200:201], v24 offset:8224
    ds_read_b64_tr_b16 a[202:203], v24 offset:8352
    ds_read_b64_tr_b16 a[204:205], v24 offset:8736
    ds_read_b64_tr_b16 a[206:207], v24 offset:8864
    s_waitcnt lgkmcnt(0)
    s_waitcnt vmcnt(8)
    ds_read_b64_tr_b16 a[208:209], v24 offset:12288
    ds_read_b64_tr_b16 a[210:211], v24 offset:12416
    ds_read_b64_tr_b16 a[212:213], v24 offset:12800
    ds_read_b64_tr_b16 a[214:215], v24 offset:12928
    ds_read_b64_tr_b16 a[216:217], v24 offset:12320
    ds_read_b64_tr_b16 a[218:219], v24 offset:12448
    ds_read_b64_tr_b16 a[220:221], v24 offset:12832
    ds_read_b64_tr_b16 a[222:223], v24 offset:12960
    s_waitcnt lgkmcnt(0)
    s_waitcnt vmcnt(4)
    ds_read_b64_tr_b16 a[224:225], v24 offset:16384
    ds_read_b64_tr_b16 a[226:227], v24 offset:16512
    ds_read_b64_tr_b16 a[228:229], v24 offset:16896
    ds_read_b64_tr_b16 a[230:231], v24 offset:17024
    ds_read_b64_tr_b16 a[232:233], v24 offset:16416
    ds_read_b64_tr_b16 a[234:235], v24 offset:16544
    ds_read_b64_tr_b16 a[236:237], v24 offset:16928
    ds_read_b64_tr_b16 a[238:239], v24 offset:17056
    s_waitcnt lgkmcnt(0)
    s_waitcnt vmcnt(0)
    ds_read_b64_tr_b16 a[240:241], v24 offset:20480
    ds_read_b64_tr_b16 a[242:243], v24 offset:20608
    ds_read_b64_tr_b16 a[244:245], v24 offset:20992
    ds_read_b64_tr_b16 a[246:247], v24 offset:21120
    ds_read_b64_tr_b16 a[248:249], v24 offset:20512
    ds_read_b64_tr_b16 a[250:251], v24 offset:20640
    ds_read_b64_tr_b16 a[252:253], v24 offset:21024
    ds_read_b64_tr_b16 a[254:255], v24 offset:21152
    s_waitcnt lgkmcnt(0)
    s_mov_b32 s34, 0
    s_cmp_lg_u32 s22, 0
    s_cbranch_scc1 L_cd_6
    s_mov_b32 s32, 262144
    v_mbcnt_lo_u32_b32 v15, -1, 0
    v_mbcnt_hi_u32_b32 v15, -1, v15
    v_lshlrev_b32 v15, 2, v15
L_c_7:
    s_sleep 4
    buffer_load_dword v14, v15, s[16:19], 0 offen sc1
    s_sub_u32 s32, s32, 1
    s_cbranch_scc1 L_abort
    s_waitcnt vmcnt(0)
L_c_7_l:
    v_cmp_lt_u32 vcc, 32, v14
    v_readlane_b32 s36, v14, 48
    v_readlane_b32 s34, v14, 50
    s_and_b32 s33, vcc_lo, 0x10001
    s_and_b32 s35, vcc_hi, 0x3f
    s_or_b32 s33, s33, s35
    s_cbranch_scc1 L_recheck
    v_cmp_ne_u32 vcc, 32, v14
    s_nop 0
    s_and_b32 s33, vcc_lo, 0x10001
    s_and_b32 s35, vcc_hi, 0x3f
    s_or_b32 s33, s33, s35
    s_cbranch_scc1 L_c_7
    s_cmp_lt_u32 s36, 192
    s_cbranch_scc1 L_c_7
L_cd_6:
    v_lshlrev_b32 v0, 4, v20
    s_lshl_b32 s33, s3, 11
    v_add_u32 v1, s33, v0
    v_lshrrev_b32 v6, 3, v22
    v_mul_u32_u24 v6, 0xaaaa, v6
    v_add_u32 v4, 0x4444, v6
    v_lshrrev_b32 v6, 5, v20
    s_lshl_b32 s33, s3, 1
    v_add_u32 v6, s33, v6
    v_and_b32 v7, 1, v21
    v_lshlrev_b32 v7, 10, v7
    v_lshl_add_u32 v7, v22, 4, v7
    v_lshrrev_b32 v8, 2, v6
    v_lshl_add_u32 v7, v8, 8, v7
    v_and_b32 v8, 3, v6
    v_lshl_add_u32 v2, v8, 2, v7
    v_mul_u32_u24 v6, 2560, v6
    v_and_b32 v7, 31, v20
    v_lshl_add_u32 v3, v7, 1, v6
    v_and_b32 v5, 7, v22
    v_lshlrev_b32 v5, 7, v5
    s_mul_i32 s42, s39, 20480
    s_lshl_b32 s33, s40, 6
    s_add_u32 s42, s42, s33
    s_lshl_b32 s41, s39, 16
    s_lshl_b32 s33, s3, 14
    s_add_u32 s41, s41, s33
    s_add_u32 s41, s41, 81788928
    s_lshl_b32 s43, s3, 10
    s_add_u32 s43, s43, 69232640
    s_mov_b32 s44, 0
    s_mov_b32 s45, 0
    s_barrier
    v_lshrrev_b32 v9, 8, v0
    v_mul_u32_u24 v9, 63488, v9
    v_lshl_add_u32 v9, v0, 3, v9
    s_and_b32 s33, s40, 7
    s_lshl_b32 s33, s33, 11
    v_add_u32 v9, s33, v9
    v_mov_b64 v[160:161], 0
    v_mov_b64 v[162:163], 0
    v_mov_b64 v[164:165], 0
    v_mov_b64 v[166:167], 0
    v_mov_b64 v[168:169], 0
    v_mov_b64 v[170:171], 0
    v_mov_b64 v[172:173], 0
    v_mov_b64 v[174:175], 0
L_o_wait:
    s_mov_b32 s32, 262144
    s_mov_b32 s33, s41
    s_branch L_o_p
L_o_w:
    s_sleep 8
L_o_p:
    buffer_load_dword v6, v5, s[4:7], s43 offen sc1
    s_sub_u32 s32, s32, 1
    s_cbranch_scc1 L_abort
    s_waitcnt vmcnt(0)
    v_cmp_gt_u32 vcc, s45, v6
    s_cbranch_vccnz L_o_w
    v_cmp_ge_u32 vcc, s45, v6
    s_cbranch_vccnz L_o_p
    buffer_load_dwordx4 v[32:35], v0, s[4:7], s33 offen offset:0 sc1
    buffer_load_dwordx4 v[36:39], v0, s[4:7], s33 offen offset:1024 sc1
    buffer_load_dwordx4 v[40:43], v0, s[4:7], s33 offen offset:2048 sc1
    buffer_load_dwordx4 v[44:47], v0, s[4:7], s33 offen offset:3072 sc1
    s_add_u32 s33, s33, 4096
    buffer_load_dwordx4 v[48:51], v0, s[4:7], s33 offen offset:0 sc1
    buffer_load_dwordx4 v[52:55], v0, s[4:7], s33 offen offset:1024 sc1
    buffer_load_dwordx4 v[56:59], v0, s[4:7], s33 offen offset:2048 sc1
    buffer_load_dwordx4 v[60:63], v0, s[4:7], s33 offen offset:3072 sc1
    s_add_u32 s33, s33, 4096
    buffer_load_dwordx4 v[64:67], v0, s[4:7], s33 offen offset:0 sc1
    buffer_load_dwordx4 v[68:71], v0, s[4:7], s33 offen offset:1024 sc1
    buffer_load_dwordx4 v[72:75], v0, s[4:7], s33 offen offset:2048 sc1
    buffer_load_dwordx4 v[76:79], v0, s[4:7], s33 offen offset:3072 sc1
    s_add_u32 s33, s33, 4096
    buffer_load_dwordx4 v[80:83], v0, s[4:7], s33 offen offset:0 sc1
    buffer_load_dwordx4 v[84:87], v0, s[4:7], s33 offen offset:1024 sc1
    buffer_load_dwordx4 v[88:91], v0, s[4:7], s33 offen offset:2048 sc1
    buffer_load_dwordx4 v[92:95], v0, s[4:7], s33 offen offset:3072 sc1
    buffer_load_dword v6, v5, s[4:7], s43 offen sc1
    s_add_u32 s33, s41, 65536
    s_waitcnt vmcnt(15)
    v_smfmac_f32_16x16x64_bf16 v[160:163], v[32:35], a[0:7], v4
    buffer_load_dwordx4 v[96:99], v0, s[4:7], s33 offen offset:0 sc1
    v_smfmac_f32_16x16x64_bf16 v[164:167], v[32:35], a[8:15], v4
    s_waitcnt vmcnt(15)
    v_smfmac_f32_16x16x64_bf16 v[160:163], v[36:39], a[16:23], v4
    buffer_load_dwordx4 v[100:103], v0, s[4:7], s33 offen offset:1024 sc1
    v_smfmac_f32_16x16x64_bf16 v[164:167], v[36:39], a[24:31], v4
    s_waitcnt vmcnt(15)
    v_smfmac_f32_16x16x64_bf16 v[160:163], v[40:43], a[32:39], v4
    buffer_load_dwordx4 v[104:107], v0, s[4:7], s33 offen offset:2048 sc1
    v_smfmac_f32_16x16x64_bf16 v[164:167], v[40:43], a[40:47], v4
    s_waitcnt vmcnt(15)
    v_smfmac_f32_16x16x64_bf16 v[160:163], v[44:47], a[48:55], v4
    buffer_load_dwordx4 v[108:111], v0, s[4:7], s33 offen offset:3072 sc1
    v_smfmac_f32_16x16x64_bf16 v[164:167], v[44:47], a[56:63], v4
    s_waitcnt vmcnt(15)
    v_smfmac_f32_16x16x64_bf16 v[160:163], v[48:51], a[64:71], v4
    s_add_u32 s33, s33, 4096
    buffer_load_dwordx4 v[112:115], v0, s[4:7], s33 offen offset:0 sc1
    v_smfmac_f32_16x16x64_bf16 v[164:167], v[48:51], a[72:79], v4
    s_waitcnt vmcnt(15)
    v_smfmac_f32_16x16x64_bf16 v[160:163], v[52:55], a[80:87], v4
    buffer_load_dwordx4 v[116:119], v0, s[4:7], s33 offen offset:1024 sc1
    v_smfmac_f32_16x16x64_bf16 v[164:167], v[52:55], a[88:95], v4
    s_waitcnt vmcnt(15)
    v_smfmac_f32_16x16x64_bf16 v[160:163], v[56:59], a[96:103], v4
    buffer_load_dwordx4 v[120:123], v0, s[4:7], s33 offen offset:2048 sc1
    v_smfmac_f32_16x16x64_bf16 v[164:167], v[56:59], a[104:111], v4
    s_waitcnt vmcnt(15)
    v_smfmac_f32_16x16x64_bf16 v[160:163], v[60:63], a[112:119], v4
    buffer_load_dwordx4 v[124:127], v0, s[4:7], s33 offen offset:3072 sc1
    v_smfmac_f32_16x16x64_bf16 v[164:167], v[60:63], a[120:127], v4
    s_waitcnt vmcnt(15)
    v_smfmac_f32_16x16x64_bf16 v[160:163], v[64:67], a[128:135], v4
    s_add_u32 s33, s33, 4096
    buffer_load_dwordx4 v[128:131], v0, s[4:7], s33 offen offset:0 sc1
    v_smfmac_f32_16x16x64_bf16 v[164:167], v[64:67], a[136:143], v4
    s_waitcnt vmcnt(15)
    v_smfmac_f32_16x16x64_bf16 v[160:163], v[68:71], a[144:151], v4
    buffer_load_dwordx4 v[132:135], v0, s[4:7], s33 offen offset:1024 sc1
    v_smfmac_f32_16x16x64_bf16 v[164:167], v[68:71], a[152:159], v4
    s_waitcnt vmcnt(15)
    v_smfmac_f32_16x16x64_bf16 v[160:163], v[72:75], a[160:167], v4
    buffer_load_dwordx4 v[136:139], v0, s[4:7], s33 offen offset:2048 sc1
    v_smfmac_f32_16x16x64_bf16 v[164:167], v[72:75], a[168:175], v4
    s_waitcnt vmcnt(15)
    v_smfmac_f32_16x16x64_bf16 v[160:163], v[76:79], a[176:183], v4
    buffer_load_dwordx4 v[140:143], v0, s[4:7], s33 offen offset:3072 sc1
    v_smfmac_f32_16x16x64_bf16 v[164:167], v[76:79], a[184:191], v4
    s_waitcnt vmcnt(15)
    v_smfmac_f32_16x16x64_bf16 v[160:163], v[80:83], a[192:199], v4
    s_add_u32 s33, s33, 4096
    buffer_load_dwordx4 v[144:147], v0, s[4:7], s33 offen offset:0 sc1
    v_smfmac_f32_16x16x64_bf16 v[164:167], v[80:83], a[200:207], v4
    s_waitcnt vmcnt(15)
    v_smfmac_f32_16x16x64_bf16 v[160:163], v[84:87], a[208:215], v4
    buffer_load_dwordx4 v[148:151], v0, s[4:7], s33 offen offset:1024 sc1
    v_smfmac_f32_16x16x64_bf16 v[164:167], v[84:87], a[216:223], v4
    s_waitcnt vmcnt(15)
    v_smfmac_f32_16x16x64_bf16 v[160:163], v[88:91], a[224:231], v4
    buffer_load_dwordx4 v[152:155], v0, s[4:7], s33 offen offset:2048 sc1
    v_smfmac_f32_16x16x64_bf16 v[164:167], v[88:91], a[232:239], v4
    s_waitcnt vmcnt(15)
    v_smfmac_f32_16x16x64_bf16 v[160:163], v[92:95], a[240:247], v4
    buffer_load_dwordx4 v[156:159], v0, s[4:7], s33 offen offset:3072 sc1
    v_smfmac_f32_16x16x64_bf16 v[164:167], v[92:95], a[248:255], v4
    v_min_u32_dpp v6, v6, v6 row_ror:8 row_mask:0xf bank_mask:0xf
    s_nop 1
    v_min_u32_dpp v6, v6, v6 row_ror:4 row_mask:0xf bank_mask:0xf
    s_nop 1
    v_min_u32_dpp v6, v6, v6 row_ror:2 row_mask:0xf bank_mask:0xf
    s_nop 1
    v_min_u32_dpp v6, v6, v6 row_ror:1 row_mask:0xf bank_mask:0xf
    s_nop 0
    v_readfirstlane_b32 s44, v6
    s_nop 0
    s_min_u32 s44, s44, 57
    s_add_u32 s41, s41, 262144
    s_add_u32 s45, s45, 1
    s_mov_b32 s33, s41
    s_cmp_lt_u32 s45, s44
    s_cbranch_scc1 L_o_ramp
L_o_last:
    s_waitcnt vmcnt(15)
    v_smfmac_f32_16x16x64_bf16 v[168:171], v[96:99], a[0:7], v4
    v_smfmac_f32_16x16x64_bf16 v[172:175], v[96:99], a[8:15], v4
    s_waitcnt vmcnt(14)
    v_smfmac_f32_16x16x64_bf16 v[168:171], v[100:103], a[16:23], v4
    v_smfmac_f32_16x16x64_bf16 v[172:175], v[100:103], a[24:31], v4
    s_waitcnt vmcnt(13)
    v_smfmac_f32_16x16x64_bf16 v[168:171], v[104:107], a[32:39], v4
    v_smfmac_f32_16x16x64_bf16 v[172:175], v[104:107], a[40:47], v4
    s_waitcnt vmcnt(12)
    v_smfmac_f32_16x16x64_bf16 v[168:171], v[108:111], a[48:55], v4
    v_smfmac_f32_16x16x64_bf16 v[172:175], v[108:111], a[56:63], v4
    s_waitcnt vmcnt(11)
    v_smfmac_f32_16x16x64_bf16 v[168:171], v[112:115], a[64:71], v4
    v_smfmac_f32_16x16x64_bf16 v[172:175], v[112:115], a[72:79], v4
    ds_write_b128 v1, v[160:163] offset:0
    s_waitcnt vmcnt(10)
    v_smfmac_f32_16x16x64_bf16 v[168:171], v[116:119], a[80:87], v4
    v_smfmac_f32_16x16x64_bf16 v[172:175], v[116:119], a[88:95], v4
    s_waitcnt vmcnt(9)
    v_smfmac_f32_16x16x64_bf16 v[168:171], v[120:123], a[96:103], v4
    v_smfmac_f32_16x16x64_bf16 v[172:175], v[120:123], a[104:111], v4
    s_waitcnt vmcnt(8)
    v_smfmac_f32_16x16x64_bf16 v[168:171], v[124:127], a[112:119], v4
    v_smfmac_f32_16x16x64_bf16 v[172:175], v[124:127], a[120:127], v4
    s_waitcnt vmcnt(7)
    v_smfmac_f32_16x16x64_bf16 v[168:171], v[128:131], a[128:135], v4
    v_smfmac_f32_16x16x64_bf16 v[172:175], v[128:131], a[136:143], v4
    ds_write_b128 v1, v[164:167] offset:1024
    s_waitcnt vmcnt(6)
    v_smfmac_f32_16x16x64_bf16 v[168:171], v[132:135], a[144:151], v4
    v_smfmac_f32_16x16x64_bf16 v[172:175], v[132:135], a[152:159], v4
    s_waitcnt vmcnt(5)
    v_smfmac_f32_16x16x64_bf16 v[168:171], v[136:139], a[160:167], v4
    v_smfmac_f32_16x16x64_bf16 v[172:175], v[136:139], a[168:175], v4
    v_mov_b64 v[160:161], 0
    v_mov_b64 v[162:163], 0
    v_mov_b64 v[164:165], 0
    v_mov_b64 v[166:167], 0
    s_waitcnt vmcnt(4)
    v_smfmac_f32_16x16x64_bf16 v[168:171], v[140:143], a[176:183], v4
    v_smfmac_f32_16x16x64_bf16 v[172:175], v[140:143], a[184:191], v4
    s_waitcnt vmcnt(3)
    v_smfmac_f32_16x16x64_bf16 v[168:171], v[144:147], a[192:199], v4
    v_smfmac_f32_16x16x64_bf16 v[172:175], v[144:147], a[200:207], v4
    s_waitcnt vmcnt(2)
    v_smfmac_f32_16x16x64_bf16 v[168:171], v[148:151], a[208:215], v4
    v_smfmac_f32_16x16x64_bf16 v[172:175], v[148:151], a[216:223], v4
    s_waitcnt vmcnt(1)
    v_smfmac_f32_16x16x64_bf16 v[168:171], v[152:155], a[224:231], v4
    v_smfmac_f32_16x16x64_bf16 v[172:175], v[152:155], a[232:239], v4
    s_waitcnt vmcnt(0)
    v_smfmac_f32_16x16x64_bf16 v[168:171], v[156:159], a[240:247], v4
    v_smfmac_f32_16x16x64_bf16 v[172:175], v[156:159], a[248:255], v4
    s_nop 3
    ds_write_b128 v1, v[168:171] offset:8192
    s_nop 2
    ds_write_b128 v1, v[172:175] offset:9216
    s_waitcnt lgkmcnt(0)
    s_barrier
    ds_read2st64_b32 v[176:177], v2 offset0:0 offset1:2
    ds_read2st64_b32 v[178:179], v2 offset0:8 offset1:10
    ds_read2st64_b32 v[180:181], v2 offset0:16 offset1:18
    ds_read2st64_b32 v[182:183], v2 offset0:24 offset1:26
    ds_read2st64_b32 v[184:185], v2 offset0:32 offset1:34
    ds_read2st64_b32 v[186:187], v2 offset0:40 offset1:42
    ds_read2st64_b32 v[188:189], v2 offset0:48 offset1:50
    ds_read2st64_b32 v[190:191], v2 offset0:56 offset1:58
    v_xor_b32 v1, 16384, v1
    v_xor_b32 v2, 16384, v2
    v_mov_b64 v[168:169], 0
    v_mov_b64 v[170:171], 0
    v_mov_b64 v[172:173], 0
    v_mov_b64 v[174:175], 0
    s_add_u32 s34, s42, 20480
    s_waitcnt lgkmcnt(0)
    v_add_f32 v176, v176, v177
    v_add_f32 v178, v178, v179
    v_add_f32 v180, v180, v181
    v_add_f32 v182, v182, v183
    v_add_f32 v176, v176, v178
    v_add_f32 v180, v180, v182
    v_add_f32 v176, v176, v180
    v_add_f32 v184, v184, v185
    v_add_f32 v186, v186, v187
    v_add_f32 v188, v188, v189
    v_add_f32 v190, v190, v191
    v_add_f32 v184, v184, v186
    v_add_f32 v188, v188, v190
    v_add_f32 v184, v184, v188
    v_cvt_pk_bf16_f32 v7, v176, v184
    buffer_store_short v7, v3, s[24:27], s42 offen
    buffer_store_short_d16_hi v7, v3, s[24:27], s34 offen
    s_add_u32 s42, s42, 81920
    s_cmp_lt_u32 s45, 57
    s_cbranch_scc1 L_o_wait
    s_add_u32 s41, s41, 262144
    s_add_u32 s42, s42, 81920
    s_add_u32 s45, s45, 1
    s_branch L_o2_loop
L_o_ramp:
    s_waitcnt vmcnt(15)
    v_smfmac_f32_16x16x64_bf16 v[168:171], v[96:99], a[0:7], v4
    buffer_load_dwordx4 v[32:35], v0, s[4:7], s33 offen offset:0 sc1
    v_smfmac_f32_16x16x64_bf16 v[172:175], v[96:99], a[8:15], v4
    buffer_load_dwordx4 v[36:39], v0, s[4:7], s33 offen offset:1024 sc1
    s_waitcnt vmcnt(16)
    v_smfmac_f32_16x16x64_bf16 v[168:171], v[100:103], a[16:23], v4
    buffer_load_dwordx4 v[40:43], v0, s[4:7], s33 offen offset:2048 sc1
    v_smfmac_f32_16x16x64_bf16 v[172:175], v[100:103], a[24:31], v4
    buffer_load_dwordx4 v[44:47], v0, s[4:7], s33 offen offset:3072 sc1
    s_waitcnt vmcnt(17)
    v_smfmac_f32_16x16x64_bf16 v[168:171], v[104:107], a[32:39], v4
    s_add_u32 s33, s33, 4096
    buffer_load_dwordx4 v[48:51], v0, s[4:7], s33 offen offset:0 sc1
    v_smfmac_f32_16x16x64_bf16 v[172:175], v[104:107], a[40:47], v4
    buffer_load_dwordx4 v[52:55], v0, s[4:7], s33 offen offset:1024 sc1
    s_waitcnt vmcnt(18)
    v_smfmac_f32_16x16x64_bf16 v[168:171], v[108:111], a[48:55], v4
    buffer_load_dwordx4 v[56:59], v0, s[4:7], s33 offen offset:2048 sc1
    v_smfmac_f32_16x16x64_bf16 v[172:175], v[108:111], a[56:63], v4
    buffer_load_dwordx4 v[60:63], v0, s[4:7], s33 offen offset:3072 sc1
    s_waitcnt vmcnt(19)
    v_smfmac_f32_16x16x64_bf16 v[168:171], v[112:115], a[64:71], v4
    s_add_u32 s33, s33, 4096
    buffer_load_dwordx4 v[64:67], v0, s[4:7], s33 offen offset:0 sc1
    v_smfmac_f32_16x16x64_bf16 v[172:175], v[112:115], a[72:79], v4
    buffer_load_dwordx4 v[68:71], v0, s[4:7], s33 offen offset:1024 sc1
    ds_write_b128 v1, v[160:163] offset:0
    s_waitcnt vmcnt(20)
    v_smfmac_f32_16x16x64_bf16 v[168:171], v[116:119], a[80:87], v4
    buffer_load_dwordx4 v[72:75], v0, s[4:7], s33 offen offset:2048 sc1
    v_smfmac_f32_16x16x64_bf16 v[172:175], v[116:119], a[88:95], v4
    buffer_load_dwordx4 v[76:79], v0, s[4:7], s33 offen offset:3072 sc1
    s_waitcnt vmcnt(21)
    v_smfmac_f32_16x16x64_bf16 v[168:171], v[120:123], a[96:103], v4
    s_add_u32 s33, s33, 4096
    buffer_load_dwordx4 v[80:83], v0, s[4:7], s33 offen offset:0 sc1
    v_smfmac_f32_16x16x64_bf16 v[172:175], v[120:123], a[104:111], v4
    buffer_load_dwordx4 v[84:87], v0, s[4:7], s33 offen offset:1024 sc1
    s_waitcnt vmcnt(22)
    v_smfmac_f32_16x16x64_bf16 v[168:171], v[124:127], a[112:119], v4
    buffer_load_dwordx4 v[88:91], v0, s[4:7], s33 offen offset:2048 sc1
    v_smfmac_f32_16x16x64_bf16 v[172:175], v[124:127], a[120:127], v4
    buffer_load_dwordx4 v[92:95], v0, s[4:7], s33 offen offset:3072 sc1
    s_waitcnt vmcnt(23)
    v_smfmac_f32_16x16x64_bf16 v[168:171], v[128:131], a[128:135], v4
    s_add_u32 s33, s41, 65536
    buffer_load_dwordx4 v[96:99], v0, s[4:7], s33 offen offset:0 sc1
    v_smfmac_f32_16x16x64_bf16 v[172:175], v[128:131], a[136:143], v4
    buffer_load_dwordx4 v[100:103], v0, s[4:7], s33 offen offset:1024 sc1
    ds_write_b128 v1, v[164:167] offset:1024
    s_waitcnt vmcnt(24)
    v_smfmac_f32_16x16x64_bf16 v[168:171], v[132:135], a[144:151], v4
    buffer_load_dwordx4 v[104:107], v0, s[4:7], s33 offen offset:2048 sc1
    v_smfmac_f32_16x16x64_bf16 v[172:175], v[132:135], a[152:159], v4
    buffer_load_dwordx4 v[108:111], v0, s[4:7], s33 offen offset:3072 sc1
    s_waitcnt vmcnt(25)
    v_smfmac_f32_16x16x64_bf16 v[168:171], v[136:139], a[160:167], v4
    s_add_u32 s33, s33, 4096
    buffer_load_dwordx4 v[112:115], v0, s[4:7], s33 offen offset:0 sc1
    v_smfmac_f32_16x16x64_bf16 v[172:175], v[136:139], a[168:175], v4
    buffer_load_dwordx4 v[116:119], v0, s[4:7], s33 offen offset:1024 sc1
    v_mov_b64 v[160:161], 0
    v_mov_b64 v[162:163], 0
    v_mov_b64 v[164:165], 0
    v_mov_b64 v[166:167], 0
    s_waitcnt vmcnt(26)
    v_smfmac_f32_16x16x64_bf16 v[168:171], v[140:143], a[176:183], v4
    buffer_load_dwordx4 v[120:123], v0, s[4:7], s33 offen offset:2048 sc1
    v_smfmac_f32_16x16x64_bf16 v[172:175], v[140:143], a[184:191], v4
    buffer_load_dwordx4 v[124:127], v0, s[4:7], s33 offen offset:3072 sc1
    s_waitcnt vmcnt(27)
    v_smfmac_f32_16x16x64_bf16 v[168:171], v[144:147], a[192:199], v4
    s_add_u32 s33, s33, 4096
    buffer_load_dwordx4 v[128:131], v0, s[4:7], s33 offen offset:0 sc1
    v_smfmac_f32_16x16x64_bf16 v[172:175], v[144:147], a[200:207], v4
    buffer_load_dwordx4 v[132:135], v0, s[4:7], s33 offen offset:1024 sc1
    s_waitcnt vmcnt(28)
    v_smfmac_f32_16x16x64_bf16 v[168:171], v[148:151], a[208:215], v4
    buffer_load_dwordx4 v[136:139], v0, s[4:7], s33 offen offset:2048 sc1
    v_smfmac_f32_16x16x64_bf16 v[172:175], v[148:151], a[216:223], v4
    buffer_load_dwordx4 v[140:143], v0, s[4:7], s33 offen offset:3072 sc1
    s_waitcnt vmcnt(29)
    v_smfmac_f32_16x16x64_bf16 v[168:171], v[152:155], a[224:231], v4
    s_add_u32 s33, s33, 4096
    buffer_load_dwordx4 v[144:147], v0, s[4:7], s33 offen offset:0 sc1
    v_smfmac_f32_16x16x64_bf16 v[172:175], v[152:155], a[232:239], v4
    buffer_load_dwordx4 v[148:151], v0, s[4:7], s33 offen offset:1024 sc1
    s_waitcnt vmcnt(30)
    v_smfmac_f32_16x16x64_bf16 v[168:171], v[156:159], a[240:247], v4
    buffer_load_dwordx4 v[152:155], v0, s[4:7], s33 offen offset:2048 sc1
    v_smfmac_f32_16x16x64_bf16 v[172:175], v[156:159], a[248:255], v4
    buffer_load_dwordx4 v[156:159], v0, s[4:7], s33 offen offset:3072 sc1
L_o_deep:
    s_add_u32 s41, s41, 262144
    s_add_u32 s45, s45, 1
    s_mov_b32 s33, s41
    s_cmp_lt_u32 s45, s44
    s_cbranch_scc1 L_o_d2
    s_waitcnt vmcnt(31)
    v_smfmac_f32_16x16x64_bf16 v[160:163], v[32:35], a[0:7], v4
    v_smfmac_f32_16x16x64_bf16 v[164:167], v[32:35], a[8:15], v4
    s_waitcnt vmcnt(30)
    v_smfmac_f32_16x16x64_bf16 v[160:163], v[36:39], a[16:23], v4
    v_smfmac_f32_16x16x64_bf16 v[164:167], v[36:39], a[24:31], v4
    ds_write_b128 v1, v[168:171] offset:8192
    ds_write_b128 v1, v[172:175] offset:9216
    s_waitcnt vmcnt(29)
    v_smfmac_f32_16x16x64_bf16 v[160:163], v[40:43], a[32:39], v4
    v_smfmac_f32_16x16x64_bf16 v[164:167], v[40:43], a[40:47], v4
    s_waitcnt vmcnt(28)
    v_smfmac_f32_16x16x64_bf16 v[160:163], v[44:47], a[48:55], v4
    v_smfmac_f32_16x16x64_bf16 v[164:167], v[44:47], a[56:63], v4
    s_waitcnt vmcnt(27)
    v_smfmac_f32_16x16x64_bf16 v[160:163], v[48:51], a[64:71], v4
    v_smfmac_f32_16x16x64_bf16 v[164:167], v[48:51], a[72:79], v4
    s_waitcnt lgkmcnt(0)
    s_barrier
    ds_read2st64_b32 v[176:177], v2 offset0:0 offset1:2
    ds_read2st64_b32 v[178:179], v2 offset0:8 offset1:10
    ds_read2st64_b32 v[180:181], v2 offset0:16 offset1:18
    ds_read2st64_b32 v[182:183], v2 offset0:24 offset1:26
    ds_read2st64_b32 v[184:185], v2 offset0:32 offset1:34
    ds_read2st64_b32 v[186:187], v2 offset0:40 offset1:42
    ds_read2st64_b32 v[188:189], v2 offset0:48 offset1:50
    ds_read2st64_b32 v[190:191], v2 offset0:56 offset1:58
    v_xor_b32 v1, 16384, v1
    v_xor_b32 v2, 16384, v2
    v_mov_b64 v[168:169], 0
    v_mov_b64 v[170:171], 0
    v_mov_b64 v[172:173], 0
    v_mov_b64 v[174:175], 0
    s_waitcnt vmcnt(26)
    v_smfmac_f32_16x16x64_bf16 v[160:163], v[52:55], a[80:87], v4
    v_smfmac_f32_16x16x64_bf16 v[164:167], v[52:55], a[88:95], v4
    s_waitcnt vmcnt(25)
    v_smfmac_f32_16x16x64_bf16 v[160:163], v[56:59], a[96:103], v4
    v_smfmac_f32_16x16x64_bf16 v[164:167], v[56:59], a[104:111], v4
    s_waitcnt vmcnt(24)
    v_smfmac_f32_16x16x64_bf16 v[160:163], v[60:63], a[112:119], v4
    v_smfmac_f32_16x16x64_bf16 v[164:167], v[60:63], a[120:127], v4
    s_add_u32 s34, s42, 20480
    s_waitcnt lgkmcnt(0)
    v_add_f32 v176, v176, v177
    v_add_f32 v178, v178, v179
    v_add_f32 v180, v180, v181
    v_add_f32 v182, v182, v183
    v_add_f32 v176, v176, v178
    v_add_f32 v180, v180, v182
    v_add_f32 v176, v176, v180
    v_add_f32 v184, v184, v185
    v_add_f32 v186, v186, v187
    v_add_f32 v188, v188, v189
    v_add_f32 v190, v190, v191
    v_add_f32 v184, v184, v186
    v_add_f32 v188, v188, v190
    v_add_f32 v184, v184, v188
    v_cvt_pk_bf16_f32 v7, v176, v184
    buffer_store_short v7, v3, s[24:27], s42 offen
    buffer_store_short_d16_hi v7, v3, s[24:27], s34 offen
    s_add_u32 s42, s42, 81920
    s_waitcnt vmcnt(23)
    v_smfmac_f32_16x16x64_bf16 v[160:163], v[64:67], a[128:135], v4
    v_smfmac_f32_16x16x64_bf16 v[164:167], v[64:67], a[136:143], v4
    s_waitcnt vmcnt(22)
    v_smfmac_f32_16x16x64_bf16 v[160:163], v[68:71], a[144:151], v4
    v_smfmac_f32_16x16x64_bf16 v[164:167], v[68:71], a[152:159], v4
    s_waitcnt vmcnt(21)
    v_smfmac_f32_16x16x64_bf16 v[160:163], v[72:75], a[160:167], v4
    v_smfmac_f32_16x16x64_bf16 v[164:167], v[72:75], a[168:175], v4
    s_waitcnt vmcnt(20)
    v_smfmac_f32_16x16x64_bf16 v[160:163], v[76:79], a[176:183], v4
    v_smfmac_f32_16x16x64_bf16 v[164:167], v[76:79], a[184:191], v4
    s_waitcnt vmcnt(19)
    v_smfmac_f32_16x16x64_bf16 v[160:163], v[80:83], a[192:199], v4
    v_smfmac_f32_16x16x64_bf16 v[164:167], v[80:83], a[200:207], v4
    s_waitcnt vmcnt(18)
    v_smfmac_f32_16x16x64_bf16 v[160:163], v[84:87], a[208:215], v4
    v_smfmac_f32_16x16x64_bf16 v[164:167], v[84:87], a[216:223], v4
    s_waitcnt vmcnt(17)
    v_smfmac_f32_16x16x64_bf16 v[160:163], v[88:91], a[224:231], v4
    v_smfmac_f32_16x16x64_bf16 v[164:167], v[88:91], a[232:239], v4
    s_waitcnt vmcnt(16)
    v_smfmac_f32_16x16x64_bf16 v[160:163], v[92:95], a[240:247], v4
    v_smfmac_f32_16x16x64_bf16 v[164:167], v[92:95], a[248:255], v4
    s_branch L_o_last
L_o_d2:
    buffer_load_dword v6, v5, s[4:7], s43 offen sc1
    s_waitcnt vmcnt(31)
    v_smfmac_f32_16x16x64_bf16 v[160:163], v[32:35], a[0:7], v4
    v_smfmac_f32_16x16x64_bf16 v[164:167], v[32:35], a[8:15], v4
    buffer_load_dwordx4 v[32:35], v0, s[4:7], s33 offen offset:0 sc1
    s_waitcnt vmcnt(31)
    v_smfmac_f32_16x16x64_bf16 v[160:163], v[36:39], a[16:23], v4
    v_smfmac_f32_16x16x64_bf16 v[164:167], v[36:39], a[24:31], v4
    buffer_load_dwordx4 v[36:39], v0, s[4:7], s33 offen offset:1024 sc1
    ds_write_b128 v1, v[168:171] offset:8192
    ds_write_b128 v1, v[172:175] offset:9216
    s_waitcnt vmcnt(31)
    v_smfmac_f32_16x16x64_bf16 v[160:163], v[40:43], a[32:39], v4
    v_smfmac_f32_16x16x64_bf16 v[164:167], v[40:43], a[40:47], v4
    buffer_load_dwordx4 v[40:43], v0, s[4:7], s33 offen offset:2048 sc1
    s_waitcnt vmcnt(31)
    v_smfmac_f32_16x16x64_bf16 v[160:163], v[44:47], a[48:55], v4
    v_smfmac_f32_16x16x64_bf16 v[164:167], v[44:47], a[56:63], v4
    buffer_load_dwordx4 v[44:47], v0, s[4:7], s33 offen offset:3072 sc1
    s_waitcnt vmcnt(31)
    v_smfmac_f32_16x16x64_bf16 v[160:163], v[48:51], a[64:71], v4
    v_smfmac_f32_16x16x64_bf16 v[164:167], v[48:51], a[72:79], v4
    s_add_u32 s33, s33, 4096
    buffer_load_dwordx4 v[48:51], v0, s[4:7], s33 offen offset:0 sc1
    s_waitcnt lgkmcnt(0)
    s_barrier
    ds_read2st64_b32 v[176:177], v2 offset0:0 offset1:2
    ds_read2st64_b32 v[178:179], v2 offset0:8 offset1:10
    ds_read2st64_b32 v[180:181], v2 offset0:16 offset1:18
    ds_read2st64_b32 v[182:183], v2 offset0:24 offset1:26
    ds_read2st64_b32 v[184:185], v2 offset0:32 offset1:34
    ds_read2st64_b32 v[186:187], v2 offset0:40 offset1:42
    ds_read2st64_b32 v[188:189], v2 offset0:48 offset1:50
    ds_read2st64_b32 v[190:191], v2 offset0:56 offset1:58
    v_xor_b32 v1, 16384, v1
    v_xor_b32 v2, 16384, v2
    v_mov_b64 v[168:169], 0
    v_mov_b64 v[170:171], 0
    v_mov_b64 v[172:173], 0
    v_mov_b64 v[174:175], 0
    s_waitcnt vmcnt(31)
    v_smfmac_f32_16x16x64_bf16 v[160:163], v[52:55], a[80:87], v4
    v_smfmac_f32_16x16x64_bf16 v[164:167], v[52:55], a[88:95], v4
    buffer_load_dwordx4 v[52:55], v0, s[4:7], s33 offen offset:1024 sc1
    s_waitcnt vmcnt(31)
    v_smfmac_f32_16x16x64_bf16 v[160:163], v[56:59], a[96:103], v4
    v_smfmac_f32_16x16x64_bf16 v[164:167], v[56:59], a[104:111], v4
    buffer_load_dwordx4 v[56:59], v0, s[4:7], s33 offen offset:2048 sc1
    s_waitcnt vmcnt(31)
    v_smfmac_f32_16x16x64_bf16 v[160:163], v[60:63], a[112:119], v4
    v_smfmac_f32_16x16x64_bf16 v[164:167], v[60:63], a[120:127], v4
    buffer_load_dwordx4 v[60:63], v0, s[4:7], s33 offen offset:3072 sc1
    s_add_u32 s34, s42, 20480
    s_waitcnt lgkmcnt(0)
    v_add_f32 v176, v176, v177
    v_add_f32 v178, v178, v179
    v_add_f32 v180, v180, v181
    v_add_f32 v182, v182, v183
    v_add_f32 v176, v176, v178
    v_add_f32 v180, v180, v182
    v_add_f32 v176, v176, v180
    v_add_f32 v184, v184, v185
    v_add_f32 v186, v186, v187
    v_add_f32 v188, v188, v189
    v_add_f32 v190, v190, v191
    v_add_f32 v184, v184, v186
    v_add_f32 v188, v188, v190
    v_add_f32 v184, v184, v188
    v_cvt_pk_bf16_f32 v7, v176, v184
    buffer_store_short v7, v3, s[24:27], s42 offen
    buffer_store_short_d16_hi v7, v3, s[24:27], s34 offen
    s_add_u32 s42, s42, 81920
    s_waitcnt vmcnt(31)
    v_smfmac_f32_16x16x64_bf16 v[160:163], v[64:67], a[128:135], v4
    v_smfmac_f32_16x16x64_bf16 v[164:167], v[64:67], a[136:143], v4
    s_add_u32 s33, s33, 4096
    buffer_load_dwordx4 v[64:67], v0, s[4:7], s33 offen offset:0 sc1
    s_waitcnt vmcnt(31)
    v_smfmac_f32_16x16x64_bf16 v[160:163], v[68:71], a[144:151], v4
    v_smfmac_f32_16x16x64_bf16 v[164:167], v[68:71], a[152:159], v4
    buffer_load_dwordx4 v[68:71], v0, s[4:7], s33 offen offset:1024 sc1
    s_waitcnt vmcnt(31)
    v_smfmac_f32_16x16x64_bf16 v[160:163], v[72:75], a[160:167], v4
    v_smfmac_f32_16x16x64_bf16 v[164:167], v[72:75], a[168:175], v4
    buffer_load_dwordx4 v[72:75], v0, s[4:7], s33 offen offset:2048 sc1
    s_waitcnt vmcnt(31)
    v_smfmac_f32_16x16x64_bf16 v[160:163], v[76:79], a[176:183], v4
    v_smfmac_f32_16x16x64_bf16 v[164:167], v[76:79], a[184:191], v4
    buffer_load_dwordx4 v[76:79], v0, s[4:7], s33 offen offset:3072 sc1
    s_waitcnt vmcnt(31)
    v_smfmac_f32_16x16x64_bf16 v[160:163], v[80:83], a[192:199], v4
    v_smfmac_f32_16x16x64_bf16 v[164:167], v[80:83], a[200:207], v4
    s_add_u32 s33, s33, 4096
    buffer_load_dwordx4 v[80:83], v0, s[4:7], s33 offen offset:0 sc1
    s_waitcnt vmcnt(31)
    v_smfmac_f32_16x16x64_bf16 v[160:163], v[84:87], a[208:215], v4
    v_smfmac_f32_16x16x64_bf16 v[164:167], v[84:87], a[216:223], v4
    buffer_load_dwordx4 v[84:87], v0, s[4:7], s33 offen offset:1024 sc1
    s_waitcnt vmcnt(31)
    v_smfmac_f32_16x16x64_bf16 v[160:163], v[88:91], a[224:231], v4
    v_smfmac_f32_16x16x64_bf16 v[164:167], v[88:91], a[232:239], v4
    buffer_load_dwordx4 v[88:91], v0, s[4:7], s33 offen offset:2048 sc1
    s_waitcnt vmcnt(31)
    v_smfmac_f32_16x16x64_bf16 v[160:163], v[92:95], a[240:247], v4
    v_smfmac_f32_16x16x64_bf16 v[164:167], v[92:95], a[248:255], v4
    buffer_load_dwordx4 v[92:95], v0, s[4:7], s33 offen offset:3072 sc1
    s_add_u32 s33, s41, 65536
    s_waitcnt vmcnt(31)
    v_smfmac_f32_16x16x64_bf16 v[168:171], v[96:99], a[0:7], v4
    v_smfmac_f32_16x16x64_bf16 v[172:175], v[96:99], a[8:15], v4
    buffer_load_dwordx4 v[96:99], v0, s[4:7], s33 offen offset:0 sc1
    s_waitcnt vmcnt(31)
    v_smfmac_f32_16x16x64_bf16 v[168:171], v[100:103], a[16:23], v4
    v_smfmac_f32_16x16x64_bf16 v[172:175], v[100:103], a[24:31], v4
    buffer_load_dwordx4 v[100:103], v0, s[4:7], s33 offen offset:1024 sc1
    s_waitcnt vmcnt(31)
    v_smfmac_f32_16x16x64_bf16 v[168:171], v[104:107], a[32:39], v4
    v_smfmac_f32_16x16x64_bf16 v[172:175], v[104:107], a[40:47], v4
    buffer_load_dwordx4 v[104:107], v0, s[4:7], s33 offen offset:2048 sc1
    s_waitcnt vmcnt(31)
    v_smfmac_f32_16x16x64_bf16 v[168:171], v[108:111], a[48:55], v4
    v_smfmac_f32_16x16x64_bf16 v[172:175], v[108:111], a[56:63], v4
    buffer_load_dwordx4 v[108:111], v0, s[4:7], s33 offen offset:3072 sc1
    s_waitcnt vmcnt(31)
    v_smfmac_f32_16x16x64_bf16 v[168:171], v[112:115], a[64:71], v4
    v_smfmac_f32_16x16x64_bf16 v[172:175], v[112:115], a[72:79], v4
    s_add_u32 s33, s33, 4096
    buffer_load_dwordx4 v[112:115], v0, s[4:7], s33 offen offset:0 sc1
    ds_write_b128 v1, v[160:163] offset:0
    s_waitcnt vmcnt(31)
    v_smfmac_f32_16x16x64_bf16 v[168:171], v[116:119], a[80:87], v4
    v_smfmac_f32_16x16x64_bf16 v[172:175], v[116:119], a[88:95], v4
    buffer_load_dwordx4 v[116:119], v0, s[4:7], s33 offen offset:1024 sc1
    s_waitcnt vmcnt(31)
    v_smfmac_f32_16x16x64_bf16 v[168:171], v[120:123], a[96:103], v4
    v_smfmac_f32_16x16x64_bf16 v[172:175], v[120:123], a[104:111], v4
    buffer_load_dwordx4 v[120:123], v0, s[4:7], s33 offen offset:2048 sc1
    s_waitcnt vmcnt(31)
    v_smfmac_f32_16x16x64_bf16 v[168:171], v[124:127], a[112:119], v4
    v_smfmac_f32_16x16x64_bf16 v[172:175], v[124:127], a[120:127], v4
    buffer_load_dwordx4 v[124:127], v0, s[4:7], s33 offen offset:3072 sc1
    s_waitcnt vmcnt(31)
    v_smfmac_f32_16x16x64_bf16 v[168:171], v[128:131], a[128:135], v4
    v_smfmac_f32_16x16x64_bf16 v[172:175], v[128:131], a[136:143], v4
    s_add_u32 s33, s33, 4096
    buffer_load_dwordx4 v[128:131], v0, s[4:7], s33 offen offset:0 sc1
    ds_write_b128 v1, v[164:167] offset:1024
    s_waitcnt vmcnt(31)
    v_smfmac_f32_16x16x64_bf16 v[168:171], v[132:135], a[144:151], v4
    v_smfmac_f32_16x16x64_bf16 v[172:175], v[132:135], a[152:159], v4
    buffer_load_dwordx4 v[132:135], v0, s[4:7], s33 offen offset:1024 sc1
    s_waitcnt vmcnt(31)
    v_smfmac_f32_16x16x64_bf16 v[168:171], v[136:139], a[160:167], v4
    v_smfmac_f32_16x16x64_bf16 v[172:175], v[136:139], a[168:175], v4
    buffer_load_dwordx4 v[136:139], v0, s[4:7], s33 offen offset:2048 sc1
    v_mov_b64 v[160:161], 0
    v_mov_b64 v[162:163], 0
    v_mov_b64 v[164:165], 0
    v_mov_b64 v[166:167], 0
    s_waitcnt vmcnt(31)
    v_smfmac_f32_16x16x64_bf16 v[168:171], v[140:143], a[176:183], v4
    v_smfmac_f32_16x16x64_bf16 v[172:175], v[140:143], a[184:191], v4
    buffer_load_dwordx4 v[140:143], v0, s[4:7], s33 offen offset:3072 sc1
    s_waitcnt vmcnt(31)
    v_smfmac_f32_16x16x64_bf16 v[168:171], v[144:147], a[192:199], v4
    v_smfmac_f32_16x16x64_bf16 v[172:175], v[144:147], a[200:207], v4
    s_add_u32 s33, s33, 4096
    buffer_load_dwordx4 v[144:147], v0, s[4:7], s33 offen offset:0 sc1
    s_waitcnt vmcnt(31)
    v_smfmac_f32_16x16x64_bf16 v[168:171], v[148:151], a[208:215], v4
    v_smfmac_f32_16x16x64_bf16 v[172:175], v[148:151], a[216:223], v4
    buffer_load_dwordx4 v[148:151], v0, s[4:7], s33 offen offset:1024 sc1
    s_waitcnt vmcnt(31)
    v_smfmac_f32_16x16x64_bf16 v[168:171], v[152:155], a[224:231], v4
    v_smfmac_f32_16x16x64_bf16 v[172:175], v[152:155], a[232:239], v4
    buffer_load_dwordx4 v[152:155], v0, s[4:7], s33 offen offset:2048 sc1
    s_waitcnt vmcnt(31)
    v_smfmac_f32_16x16x64_bf16 v[168:171], v[156:159], a[240:247], v4
    v_smfmac_f32_16x16x64_bf16 v[172:175], v[156:159], a[248:255], v4
    buffer_load_dwordx4 v[156:159], v0, s[4:7], s33 offen offset:3072 sc1
    v_min_u32_dpp v6, v6, v6 row_ror:8 row_mask:0xf bank_mask:0xf
    s_nop 1
    v_min_u32_dpp v6, v6, v6 row_ror:4 row_mask:0xf bank_mask:0xf
    s_nop 1
    v_min_u32_dpp v6, v6, v6 row_ror:2 row_mask:0xf bank_mask:0xf
    s_nop 1
    v_min_u32_dpp v6, v6, v6 row_ror:1 row_mask:0xf bank_mask:0xf
    s_nop 0
    v_readfirstlane_b32 s44, v6
    s_nop 0
    s_min_u32 s44, s44, 57
    s_branch L_o_deep
L_role_bp:
    s_sub_u32 s51, s21, 96
    s_lshr_b32 s48, s51, 3
    s_and_b32 s49, s51, 7
    s_lshl_b32 s49, s49, 2
    s_add_u32 s49, s49, s3
    s_load_dwordx2 s[8:9], s[0:1], 64
    s_mov_b32 s10, 2457600
    s_mov_b32 s11, 0x20000
    s_load_dwordx2 s[12:13], s[0:1], 56
    s_mov_b32 s14, 2621440
    s_mov_b32 s15, 0x20000
    s_mul_i32 s37, s48, 1280
    s_mul_i32 s33, s49, 40
    s_add_u32 s37, s37, s33
    s_and_b32 s47, s37, 8
    s_sub_u32 s37, s37, s47
    v_mbcnt_lo_u32_b32 v10, -1, 0
    v_mbcnt_hi_u32_b32 v10, -1, v10
    v_lshrrev_b32 v11, 2, v10
    v_mul_u32_u24 v11, 3840, v11
    v_and_b32 v12, 3, v10
    v_lshl_add_u32 v13, v12, 4, v11
    s_mul_i32 s45, s3, 40960
    s_waitcnt lgkmcnt(0)
    s_barrier
    s_add_u32 m0, s45, 0
    s_add_u32 s33, s37, 0
    buffer_load_dwordx4 v13, s[8:11], s33 offen lds
    s_add_u32 m0, s45, 1024
    s_add_u32 s33, s37, 61440
    buffer_load_dwordx4 v13, s[8:11], s33 offen lds
    s_add_u32 m0, s45, 2048
    s_add_u32 s33, s37, 122880
    buffer_load_dwordx4 v13, s[8:11], s33 offen lds
    s_add_u32 m0, s45, 3072
    s_add_u32 s33, s37, 184320
    buffer_load_dwordx4 v13, s[8:11], s33 offen lds
    s_add_u32 m0, s45, 4096
    s_add_u32 s33, s37, 245760
    buffer_load_dwordx4 v13, s[8:11], s33 offen lds
    s_add_u32 m0, s45, 5120
    s_add_u32 s33, s37, 307200
    buffer_load_dwordx4 v13, s[8:11], s33 offen lds
    s_add_u32 m0, s45, 6144
    s_add_u32 s33, s37, 368640
    buffer_load_dwordx4 v13, s[8:11], s33 offen lds
    s_add_u32 m0, s45, 7168
    s_add_u32 s33, s37, 430080
    buffer_load_dwordx4 v13, s[8:11], s33 offen lds
    s_add_u32 m0, s45, 8192
    s_add_u32 s33, s37, 491520
    buffer_load_dwordx4 v13, s[8:11], s33 offen lds
    s_add_u32 m0, s45, 9216
    s_add_u32 s33, s37, 552960
    buffer_load_dwordx4 v13, s[8:11], s33 offen lds
    s_add_u32 m0, s45, 10240
    s_add_u32 s33, s37, 614400
    buffer_load_dwordx4 v13, s[8:11], s33 offen lds
    s_add_u32 m0, s45, 11264
    s_add_u32 s33, s37, 675840
    buffer_load_dwordx4 v13, s[8:11], s33 offen lds
    s_add_u32 m0, s45, 12288
    s_add_u32 s33, s37, 737280
    buffer_load_dwordx4 v13, s[8:11], s33 offen lds
    s_add_u32 m0, s45, 13312
    s_add_u32 s33, s37, 798720
    buffer_load_dwordx4 v13, s[8:11], s33 offen lds
    s_add_u32 m0, s45, 14336
    s_add_u32 s33, s37, 860160
    buffer_load_dwordx4 v13, s[8:11], s33 offen lds
    s_add_u32 m0, s45, 15360
    s_add_u32 s33, s37, 921600
    buffer_load_dwordx4 v13, s[8:11], s33 offen lds
    s_add_u32 m0, s45, 16384
    s_add_u32 s33, s37, 983040
    buffer_load_dwordx4 v13, s[8:11], s33 offen lds
    s_add_u32 m0, s45, 17408
    s_add_u32 s33, s37, 1044480
    buffer_load_dwordx4 v13, s[8:11], s33 offen lds
    s_add_u32 m0, s45, 18432
    s_add_u32 s33, s37, 1105920
    buffer_load_dwordx4 v13, s[8:11], s33 offen lds
    s_add_u32 m0, s45, 19456
    s_add_u32 s33, s37, 1167360
    buffer_load_dwordx4 v13, s[8:11], s33 offen lds
    s_add_u32 m0, s45, 20480
    s_add_u32 s33, s37, 1228800
    buffer_load_dwordx4 v13, s[8:11], s33 offen lds
    s_add_u32 m0, s45, 21504
    s_add_u32 s33, s37, 1290240
    buffer_load_dwordx4 v13, s[8:11], s33 offen lds
    s_add_u32 m0, s45, 22528
    s_add_u32 s33, s37, 1351680
    buffer_load_dwordx4 v13, s[8:11], s33 offen lds
    s_add_u32 m0, s45, 23552
    s_add_u32 s33, s37, 1413120
    buffer_load_dwordx4 v13, s[8:11], s33 offen lds
    s_add_u32 m0, s45, 24576
    s_add_u32 s33, s37, 1474560
    buffer_load_dwordx4 v13, s[8:11], s33 offen lds
    s_add_u32 m0, s45, 25600
    s_add_u32 s33, s37, 1536000
    buffer_load_dwordx4 v13, s[8:11], s33 offen lds
    s_add_u32 m0, s45, 26624
    s_add_u32 s33, s37, 1597440
    buffer_load_dwordx4 v13, s[8:11], s33 offen lds
    s_add_u32 m0, s45, 27648
    s_add_u32 s33, s37, 1658880
    buffer_load_dwordx4 v13, s[8:11], s33 offen lds
    s_add_u32 m0, s45, 28672
    s_add_u32 s33, s37, 1720320
    buffer_load_dwordx4 v13, s[8:11], s33 offen lds
    s_add_u32 m0, s45, 29696
    s_add_u32 s33, s37, 1781760
    buffer_load_dwordx4 v13, s[8:11], s33 offen lds
    s_add_u32 m0, s45, 30720
    s_add_u32 s33, s37, 1843200
    buffer_load_dwordx4 v13, s[8:11], s33 offen lds
    s_add_u32 m0, s45, 31744
    s_add_u32 s33, s37, 1904640
    buffer_load_dwordx4 v13, s[8:11], s33 offen lds
    s_add_u32 m0, s45, 32768
    s_add_u32 s33, s37, 1966080
    buffer_load_dwordx4 v13, s[8:11], s33 offen lds
    s_add_u32 m0, s45, 33792
    s_add_u32 s33, s37, 2027520
    buffer_load_dwordx4 v13, s[8:11], s33 offen lds
    s_add_u32 m0, s45, 34816
    s_add_u32 s33, s37, 2088960
    buffer_load_dwordx4 v13, s[8:11], s33 offen lds
    s_add_u32 m0, s45, 35840
    s_add_u32 s33, s37, 2150400
    buffer_load_dwordx4 v13, s[8:11], s33 offen lds
    s_add_u32 m0, s45, 36864
    s_add_u32 s33, s37, 2211840
    buffer_load_dwordx4 v13, s[8:11], s33 offen lds
    s_add_u32 m0, s45, 37888
    s_add_u32 s33, s37, 2273280
    buffer_load_dwordx4 v13, s[8:11], s33 offen lds
    s_add_u32 m0, s45, 38912
    s_add_u32 s33, s37, 2334720
    buffer_load_dwordx4 v13, s[8:11], s33 offen lds
    s_add_u32 m0, s45, 39936
    s_add_u32 s33, s37, 2396160
    buffer_load_dwordx4 v13, s[8:11], s33 offen lds
    v_lshrrev_b32 v11, 5, v10
    v_bfe_u32 v12, v10, 2, 2
    v_lshl_add_u32 v11, v11, 3, v12
    v_lshlrev_b32 v11, 6, v11
    v_bfe_u32 v12, v10, 4, 1
    v_lshl_add_u32 v11, v12, 5, v11
    v_and_b32 v12, 3, v10
    v_lshl_add_u32 v11, v12, 3, v11
    s_add_u32 s33, s45, s47
    v_add_u32 v14, s33, v11
    s_waitcnt vmcnt(39)
    ds_read_b64_tr_b16 v[96:97], v14 offset:0
    ds_read_b64_tr_b16 v[98:99], v14 offset:256
    s_waitcnt vmcnt(38)
    ds_read_b64_tr_b16 v[100:101], v14 offset:1024
    ds_read_b64_tr_b16 v[102:103], v14 offset:1280
    s_waitcnt vmcnt(37)
    ds_read_b64_tr_b16 v[104:105], v14 offset:2048
    ds_read_b64_tr_b16 v[106:107], v14 offset:2304
    s_waitcnt vmcnt(36)
    ds_read_b64_tr_b16 v[108:109], v14 offset:3072
    ds_read_b64_tr_b16 v[110:111], v14 offset:3328
    s_waitcnt vmcnt(35)
    ds_read_b64_tr_b16 v[112:113], v14 offset:4096
    ds_read_b64_tr_b16 v[114:115], v14 offset:4352
    s_waitcnt vmcnt(34)
    ds_read_b64_tr_b16 v[116:117], v14 offset:5120
    ds_read_b64_tr_b16 v[118:119], v14 offset:5376
    s_waitcnt vmcnt(33)
    ds_read_b64_tr_b16 v[120:121], v14 offset:6144
    ds_read_b64_tr_b16 v[122:123], v14 offset:6400
    s_waitcnt vmcnt(32)
    ds_read_b64_tr_b16 v[124:125], v14 offset:7168
    ds_read_b64_tr_b16 v[126:127], v14 offset:7424
    s_waitcnt vmcnt(31)
    ds_read_b64_tr_b16 v[128:129], v14 offset:8192
    ds_read_b64_tr_b16 v[130:131], v14 offset:8448
    s_waitcnt vmcnt(30)
    ds_read_b64_tr_b16 v[132:133], v14 offset:9216
    ds_read_b64_tr_b16 v[134:135], v14 offset:9472
    s_waitcnt vmcnt(29)
    ds_read_b64_tr_b16 v[136:137], v14 offset:10240
    ds_read_b64_tr_b16 v[138:139], v14 offset:10496
    s_waitcnt vmcnt(28)
    ds_read_b64_tr_b16 v[140:141], v14 offset:11264
    ds_read_b64_tr_b16 v[142:143], v14 offset:11520
    s_waitcnt vmcnt(27)
    ds_read_b64_tr_b16 v[144:145], v14 offset:12288
    ds_read_b64_tr_b16 v[146:147], v14 offset:12544
    s_waitcnt vmcnt(26)
    ds_read_b64_tr_b16 v[148:149], v14 offset:13312
    ds_read_b64_tr_b16 v[150:151], v14 offset:13568
    s_waitcnt vmcnt(25)
    ds_read_b64_tr_b16 v[152:153], v14 offset:14336
    ds_read_b64_tr_b16 v[154:155], v14 offset:14592
    s_waitcnt vmcnt(24)
    ds_read_b64_tr_b16 v[156:157], v14 offset:15360
    ds_read_b64_tr_b16 v[158:159], v14 offset:15616
    s_waitcnt vmcnt(23)
    ds_read_b64_tr_b16 v[160:161], v14 offset:16384
    ds_read_b64_tr_b16 v[162:163], v14 offset:16640
    s_waitcnt vmcnt(22)
    ds_read_b64_tr_b16 v[164:165], v14 offset:17408
    ds_read_b64_tr_b16 v[166:167], v14 offset:17664
    s_waitcnt vmcnt(21)
    ds_read_b64_tr_b16 v[168:169], v14 offset:18432
    ds_read_b64_tr_b16 v[170:171], v14 offset:18688
    s_waitcnt vmcnt(20)
    ds_read_b64_tr_b16 v[172:173], v14 offset:19456
    ds_read_b64_tr_b16 v[174:175], v14 offset:19712
    s_waitcnt vmcnt(19)
    ds_read_b64_tr_b16 v[176:177], v14 offset:20480
    ds_read_b64_tr_b16 v[178:179], v14 offset:20736
    s_waitcnt vmcnt(18)
    ds_read_b64_tr_b16 v[180:181], v14 offset:21504
    ds_read_b64_tr_b16 v[182:183], v14 offset:21760
    s_waitcnt vmcnt(17)
    ds_read_b64_tr_b16 v[184:185], v14 offset:22528
    ds_read_b64_tr_b16 v[186:187], v14 offset:22784
    s_waitcnt vmcnt(16)
    ds_read_b64_tr_b16 v[188:189], v14 offset:23552
    ds_read_b64_tr_b16 v[190:191], v14 offset:23808
    s_waitcnt vmcnt(15)
    ds_read_b64_tr_b16 v[192:193], v14 offset:24576
    ds_read_b64_tr_b16 v[194:195], v14 offset:24832
    s_waitcnt vmcnt(14)
    ds_read_b64_tr_b16 v[196:197], v14 offset:25600
    ds_read_b64_tr_b16 v[198:199], v14 offset:25856
    s_waitcnt vmcnt(13)
    ds_read_b64_tr_b16 v[200:201], v14 offset:26624
    ds_read_b64_tr_b16 v[202:203], v14 offset:26880
    s_waitcnt vmcnt(12)
    ds_read_b64_tr_b16 v[204:205], v14 offset:27648
    ds_read_b64_tr_b16 v[206:207], v14 offset:27904
    s_waitcnt vmcnt(11)
    ds_read_b64_tr_b16 v[208:209], v14 offset:28672
    ds_read_b64_tr_b16 v[210:211], v14 offset:28928
    s_waitcnt vmcnt(10)
    ds_read_b64_tr_b16 v[212:213], v14 offset:29696
    ds_read_b64_tr_b16 v[214:215], v14 offset:29952
    s_waitcnt vmcnt(9)
    ds_read_b64_tr_b16 v[216:217], v14 offset:30720
    ds_read_b64_tr_b16 v[218:219], v14 offset:30976
    s_waitcnt vmcnt(8)
    ds_read_b64_tr_b16 v[220:221], v14 offset:31744
    ds_read_b64_tr_b16 v[222:223], v14 offset:32000
    s_waitcnt vmcnt(7)
    ds_read_b64_tr_b16 v[224:225], v14 offset:32768
    ds_read_b64_tr_b16 v[226:227], v14 offset:33024
    s_waitcnt vmcnt(6)
    ds_read_b64_tr_b16 v[228:229], v14 offset:33792
    ds_read_b64_tr_b16 v[230:231], v14 offset:34048
    s_waitcnt vmcnt(5)
    ds_read_b64_tr_b16 v[232:233], v14 offset:34816
    ds_read_b64_tr_b16 v[234:235], v14 offset:35072
    s_waitcnt vmcnt(4)
    ds_read_b64_tr_b16 v[236:237], v14 offset:35840
    ds_read_b64_tr_b16 v[238:239], v14 offset:36096
    s_waitcnt vmcnt(3)
    ds_read_b64_tr_b16 v[240:241], v14 offset:36864
    ds_read_b64_tr_b16 v[242:243], v14 offset:37120
    s_waitcnt vmcnt(2)
    ds_read_b64_tr_b16 v[244:245], v14 offset:37888
    ds_read_b64_tr_b16 v[246:247], v14 offset:38144
    s_waitcnt vmcnt(1)
    ds_read_b64_tr_b16 v[248:249], v14 offset:38912
    ds_read_b64_tr_b16 v[250:251], v14 offset:39168
    s_waitcnt vmcnt(0)
    ds_read_b64_tr_b16 v[252:253], v14 offset:39936
    ds_read_b64_tr_b16 v[254:255], v14 offset:40192
    s_waitcnt lgkmcnt(0)
    v_and_b32 v11, 31, v10
    v_cmp_gt_u32 vcc, 20, v11
    s_nop 1
    v_cndmask_b32 v96, 0, v96, vcc
    v_cndmask_b32 v97, 0, v97, vcc
    v_cndmask_b32 v98, 0, v98, vcc
    v_cndmask_b32 v99, 0, v99, vcc
    v_cndmask_b32 v100, 0, v100, vcc
    v_cndmask_b32 v101, 0, v101, vcc
    v_cndmask_b32 v102, 0, v102, vcc
    v_cndmask_b32 v103, 0, v103, vcc
    v_cndmask_b32 v104, 0, v104, vcc
    v_cndmask_b32 v105, 0, v105, vcc
    v_cndmask_b32 v106, 0, v106, vcc
    v_cndmask_b32 v107, 0, v107, vcc
    v_cndmask_b32 v108, 0, v108, vcc
    v_cndmask_b32 v109, 0, v109, vcc
    v_cndmask_b32 v110, 0, v110, vcc
    v_cndmask_b32 v111, 0, v111, vcc
    v_cndmask_b32 v112, 0, v112, vcc
    v_cndmask_b32 v113, 0, v113, vcc
    v_cndmask_b32 v114, 0, v114, vcc
    v_cndmask_b32 v115, 0, v115, vcc
    v_cndmask_b32 v116, 0, v116, vcc
    v_cndmask_b32 v117, 0, v117, vcc
    v_cndmask_b32 v118, 0, v118, vcc
    v_cndmask_b32 v119, 0, v119, vcc
    v_cndmask_b32 v120, 0, v120, vcc
    v_cndmask_b32 v121, 0, v121, vcc
    v_cndmask_b32 v122, 0, v122, vcc
    v_cndmask_b32 v123, 0, v123, vcc
    v_cndmask_b32 v124, 0, v124, vcc
    v_cndmask_b32 v125, 0, v125, vcc
    v_cndmask_b32 v126, 0, v126, vcc
    v_cndmask_b32 v127, 0, v127, vcc
    v_cndmask_b32 v128, 0, v128, vcc
    v_cndmask_b32 v129, 0, v129, vcc
    v_cndmask_b32 v130, 0, v130, vcc
    v_cndmask_b32 v131, 0, v131, vcc
    v_cndmask_b32 v132, 0, v132, vcc
    v_cndmask_b32 v133, 0, v133, vcc
    v_cndmask_b32 v134, 0, v134, vcc
    v_cndmask_b32 v135, 0, v135, vcc
    v_cndmask_b32 v136, 0, v136, vcc
    v_cndmask_b32 v137, 0, v137, vcc
    v_cndmask_b32 v138, 0, v138, vcc
    v_cndmask_b32 v139, 0, v139, vcc
    v_cndmask_b32 v140, 0, v140, vcc
    v_cndmask_b32 v141, 0, v141, vcc
    v_cndmask_b32 v142, 0, v142, vcc
    v_cndmask_b32 v143, 0, v143, vcc
    v_cndmask_b32 v144, 0, v144, vcc
    v_cndmask_b32 v145, 0, v145, vcc
    v_cndmask_b32 v146, 0, v146, vcc
    v_cndmask_b32 v147, 0, v147, vcc
    v_cndmask_b32 v148, 0, v148, vcc
    v_cndmask_b32 v149, 0, v149, vcc
    v_cndmask_b32 v150, 0, v150, vcc
    v_cndmask_b32 v151, 0, v151, vcc
    v_cndmask_b32 v152, 0, v152, vcc
    v_cndmask_b32 v153, 0, v153, vcc
    v_cndmask_b32 v154, 0, v154, vcc
    v_cndmask_b32 v155, 0, v155, vcc
    v_cndmask_b32 v156, 0, v156, vcc
    v_cndmask_b32 v157, 0, v157, vcc
    v_cndmask_b32 v158, 0, v158, vcc
    v_cndmask_b32 v159, 0, v159, vcc
    v_cndmask_b32 v160, 0, v160, vcc
    v_cndmask_b32 v161, 0, v161, vcc
    v_cndmask_b32 v162, 0, v162, vcc
    v_cndmask_b32 v163, 0, v163, vcc
    v_cndmask_b32 v164, 0, v164, vcc
    v_cndmask_b32 v165, 0, v165, vcc
    v_cndmask_b32 v166, 0, v166, vcc
    v_cndmask_b32 v167, 0, v167, vcc
    v_cndmask_b32 v168, 0, v168, vcc
    v_cndmask_b32 v169, 0, v169, vcc
    v_cndmask_b32 v170, 0, v170, vcc
    v_cndmask_b32 v171, 0, v171, vcc
    v_cndmask_b32 v172, 0, v172, vcc
    v_cndmask_b32 v173, 0, v173, vcc
    v_cndmask_b32 v174, 0, v174, vcc
    v_cndmask_b32 v175, 0, v175, vcc
    v_cndmask_b32 v176, 0, v176, vcc
    v_cndmask_b32 v177, 0, v177, vcc
    v_cndmask_b32 v178, 0, v178, vcc
    v_cndmask_b32 v179, 0, v179, vcc
    v_cndmask_b32 v180, 0, v180, vcc
    v_cndmask_b32 v181, 0, v181, vcc
    v_cndmask_b32 v182, 0, v182, vcc
    v_cndmask_b32 v183, 0, v183, vcc
    v_cndmask_b32 v184, 0, v184, vcc
    v_cndmask_b32 v185, 0, v185, vcc
    v_cndmask_b32 v186, 0, v186, vcc
    v_cndmask_b32 v187, 0, v187, vcc
    v_cndmask_b32 v188, 0, v188, vcc
    v_cndmask_b32 v189, 0, v189, vcc
    v_cndmask_b32 v190, 0, v190, vcc
    v_cndmask_b32 v191, 0, v191, vcc
    v_cndmask_b32 v192, 0, v192, vcc
    v_cndmask_b32 v193, 0, v193, vcc
    v_cndmask_b32 v194, 0, v194, vcc
    v_cndmask_b32 v195, 0, v195, vcc
    v_cndmask_b32 v196, 0, v196, vcc
    v_cndmask_b32 v197, 0, v197, vcc
    v_cndmask_b32 v198, 0, v198, vcc
    v_cndmask_b32 v199, 0, v199, vcc
    v_cndmask_b32 v200, 0, v200, vcc
    v_cndmask_b32 v201, 0, v201, vcc
    v_cndmask_b32 v202, 0, v202, vcc
    v_cndmask_b32 v203, 0, v203, vcc
    v_cndmask_b32 v204, 0, v204, vcc
    v_cndmask_b32 v205, 0, v205, vcc
    v_cndmask_b32 v206, 0, v206, vcc
    v_cndmask_b32 v207, 0, v207, vcc
    v_cndmask_b32 v208, 0, v208, vcc
    v_cndmask_b32 v209, 0, v209, vcc
    v_cndmask_b32 v210, 0, v210, vcc
    v_cndmask_b32 v211, 0, v211, vcc
    v_cndmask_b32 v212, 0, v212, vcc
    v_cndmask_b32 v213, 0, v213, vcc
    v_cndmask_b32 v214, 0, v214, vcc
    v_cndmask_b32 v215, 0, v215, vcc
    v_cndmask_b32 v216, 0, v216, vcc
    v_cndmask_b32 v217, 0, v217, vcc
    v_cndmask_b32 v218, 0, v218, vcc
    v_cndmask_b32 v219, 0, v219, vcc
    v_cndmask_b32 v220, 0, v220, vcc
    v_cndmask_b32 v221, 0, v221, vcc
    v_cndmask_b32 v222, 0, v222, vcc
    v_cndmask_b32 v223, 0, v223, vcc
    v_cndmask_b32 v224, 0, v224, vcc
    v_cndmask_b32 v225, 0, v225, vcc
    v_cndmask_b32 v226, 0, v226, vcc
    v_cndmask_b32 v227, 0, v227, vcc
    v_cndmask_b32 v228, 0, v228, vcc
    v_cndmask_b32 v229, 0, v229, vcc
    v_cndmask_b32 v230, 0, v230, vcc
    v_cndmask_b32 v231, 0, v231, vcc
    v_cndmask_b32 v232, 0, v232, vcc
    v_cndmask_b32 v233, 0, v233, vcc
    v_cndmask_b32 v234, 0, v234, vcc
    v_cndmask_b32 v235, 0, v235, vcc
    v_cndmask_b32 v236, 0, v236, vcc
    v_cndmask_b32 v237, 0, v237, vcc
    v_cndmask_b32 v238, 0, v238, vcc
    v_cndmask_b32 v239, 0, v239, vcc
    v_cndmask_b32 v240, 0, v240, vcc
    v_cndmask_b32 v241, 0, v241, vcc
    v_cndmask_b32 v242, 0, v242, vcc
    v_cndmask_b32 v243, 0, v243, vcc
    v_cndmask_b32 v244, 0, v244, vcc
    v_cndmask_b32 v245, 0, v245, vcc
    v_cndmask_b32 v246, 0, v246, vcc
    v_cndmask_b32 v247, 0, v247, vcc
    v_cndmask_b32 v248, 0, v248, vcc
    v_cndmask_b32 v249, 0, v249, vcc
    v_cndmask_b32 v250, 0, v250, vcc
    v_cndmask_b32 v251, 0, v251, vcc
    v_cndmask_b32 v252, 0, v252, vcc
    v_cndmask_b32 v253, 0, v253, vcc
    v_cndmask_b32 v254, 0, v254, vcc
    v_cndmask_b32 v255, 0, v255, vcc
    s_barrier
    v_mbcnt_lo_u32_b32 v10, -1, 0
    v_mbcnt_hi_u32_b32 v10, -1, v10
    v_lshlrev_b32 v10, 7, v10
    s_lshl_b32 s33, s30, 2
    s_add_u32 s33, s33, s3
    s_lshl_b32 s33, s33, 13
    s_lshl_b32 s34, s31, 15
    buffer_load_dword v11, v10, s[12:15], s33 offen
    s_add_u32 s33, s33, s34
    buffer_load_dword v11, v10, s[12:15], s33 offen
    s_add_u32 s33, s33, s34
    buffer_load_dword v11, v10, s[12:15], s33 offen
    s_add_u32 s33, s33, s34
    buffer_load_dword v11, v10, s[12:15], s33 offen
    s_add_u32 s33, s33, s34
    s_waitcnt vmcnt(0)
    s_mov_b32 s34, 0
    s_cmp_lg_u32 s22, 0
    s_cbranch_scc1 L_cd_8
    s_mov_b32 s32, 262144
    v_mbcnt_lo_u32_b32 v15, -1, 0
    v_mbcnt_hi_u32_b32 v15, -1, v15
    v_lshlrev_b32 v15, 2, v15
L_c_9:
    s_sleep 4
    buffer_load_dword v14, v15, s[16:19], 0 offen sc1
    s_sub_u32 s32, s32, 1
    s_cbranch_scc1 L_abort
    s_waitcnt vmcnt(0)
L_c_9_l:
    v_cmp_lt_u32 vcc, 32, v14
    v_readlane_b32 s36, v14, 48
    v_readlane_b32 s34, v14, 50
    s_and_b32 s33, vcc_lo, 0x10001
    s_and_b32 s35, vcc_hi, 0x3f
    s_or_b32 s33, s33, s35
    s_cbranch_scc1 L_recheck
    v_cmp_ne_u32 vcc, 32, v14
    s_nop 0
    s_and_b32 s33, vcc_lo, 0x10001
    s_and_b32 s35, vcc_hi, 0x3f
    s_or_b32 s33, s33, s35
    s_cbranch_scc1 L_c_9
    s_cmp_lt_u32 s36, 192
    s_cbranch_scc1 L_c_9
L_cd_8:
    s_mov_b32 s38, 0
    s_mov_b32 s40, 64
    s_lshl_b32 s44, s51, 7
    s_add_u32 s44, s44, 69229568
    s_cmp_eq_u32 s3, 0
    s_cselect_b32 s44, s44, 268435456
    s_lshl_b32 s39, s48, 22
    s_lshl_b32 s33, s49, 11
    s_add_u32 s39, s39, s33
    s_add_u32 s39, s39, 100663296
    v_mbcnt_lo_u32_b32 v10, -1, 0
    v_mbcnt_hi_u32_b32 v10, -1, v10
    v_lshlrev_b32 v9, 4, v10
    s_cmp_eq_u32 s48, 2
    s_cbranch_scc1 L_bv
    v_mbcnt_lo_u32_b32 v10, -1, 0
    v_mbcnt_hi_u32_b32 v10, -1, v10
    v_lshrrev_b32 v11, 3, v10
    s_lshl_b32 s33, s3, 3
    v_add_u32 v11, s33, v11
    v_lshrrev_b32 v12, 1, v11
    v_xor_b32 v12, v12, v10
    v_and_b32 v12, 7, v12
    v_mul_u32_u24 v11, 1280, v11
    v_lshl_add_u32 v13, v12, 4, v11
    v_bfe_u32 v11, v10, 3, 2
    v_mul_u32_u24 v11, 10240, v11
    v_and_b32 v12, 7, v10
    v_lshl_add_u32 v11, v12, 7, v11
    v_bfe_u32 v12, v10, 1, 3
    v_lshrrev_b32 v15, 5, v10
    v_xor_b32 v12, v12, v15
    v_xor_b32 v15, 0, v12
    v_lshl_add_u32 v16, v15, 4, v11
    v_mov_b32 v20, v16
    v_xor_b32 v15, 2, v12
    v_lshl_add_u32 v17, v15, 4, v11
    v_mov_b32 v21, v17
    v_xor_b32 v15, 4, v12
    v_lshl_add_u32 v18, v15, 4, v11
    v_mov_b32 v22, v18
    v_xor_b32 v15, 6, v12
    v_lshl_add_u32 v19, v15, 4, v11
    v_mov_b32 v23, v19
    s_mul_i32 s45, s3, 10240
    s_add_u32 s43, s45, 0
    s_add_u32 m0, s43, 0
    s_nop 0
    buffer_load_dwordx4 v13, s[12:15], s38 offen offset:0 lds
    s_add_u32 m0, s43, 896
    s_nop 0
    buffer_load_dwordx4 v13, s[12:15], s38 offen offset:128 lds
    s_add_u32 m0, s43, 1792
    s_nop 0
    buffer_load_dwordx4 v13, s[12:15], s38 offen offset:256 lds
    s_add_u32 m0, s43, 2688
    s_nop 0
    buffer_load_dwordx4 v13, s[12:15], s38 offen offset:384 lds
    s_add_u32 m0, s43, 3584
    s_nop 0
    buffer_load_dwordx4 v13, s[12:15], s38 offen offset:512 lds
    s_add_u32 m0, s43, 4480
    s_nop 0
    buffer_load_dwordx4 v13, s[12:15], s38 offen offset:640 lds
    s_add_u32 m0, s43, 5376
    s_nop 0
    buffer_load_dwordx4 v13, s[12:15], s38 offen offset:768 lds
    s_add_u32 m0, s43, 6272
    s_nop 0
    buffer_load_dwordx4 v13, s[12:15], s38 offen offset:896 lds
    s_add_u32 m0, s43, 7168
    s_nop 0
    buffer_load_dwordx4 v13, s[12:15], s38 offen offset:1024 lds
    s_add_u32 m0, s43, 8064
    s_nop 0
    buffer_load_dwordx4 v13, s[12:15], s38 offen offset:1152 lds
    s_add_u32 s38, s38, 40960
    s_cmp_lt_u32 1, s40
    s_cselect_b32 s38, s38, 268435456
    s_add_u32 s43, s45, 40960
    s_add_u32 m0, s43, 0
    s_nop 0
    buffer_load_dwordx4 v13, s[12:15], s38 offen offset:0 lds
    s_add_u32 m0, s43, 896
    s_nop 0
    buffer_load_dwordx4 v13, s[12:15], s38 offen offset:128 lds
    s_add_u32 m0, s43, 1792
    s_nop 0
    buffer_load_dwordx4 v13, s[12:15], s38 offen offset:256 lds
    s_add_u32 m0, s43, 2688
    s_nop 0
    buffer_load_dwordx4 v13, s[12:15], s38 offen offset:384 lds
    s_add_u32 m0, s43, 3584
    s_nop 0
    buffer_load_dwordx4 v13, s[12:15], s38 offen offset:512 lds
    s_add_u32 m0, s43, 4480
    s_nop 0
    buffer_load_dwordx4 v13, s[12:15], s38 offen offset:640 lds
    s_add_u32 m0, s43, 5376
    s_nop 0
    buffer_load_dwordx4 v13, s[12:15], s38 offen offset:768 lds
    s_add_u32 m0, s43, 6272
    s_nop 0
    buffer_load_dwordx4 v13, s[12:15], s38 offen offset:896 lds
    s_add_u32 m0, s43, 7168
    s_nop 0
    buffer_load_dwordx4 v13, s[12:15], s38 offen offset:1024 lds
    s_add_u32 m0, s43, 8064
    s_nop 0
    buffer_load_dwordx4 v13, s[12:15], s38 offen offset:1152 lds
    s_add_u32 s38, s38, 40960
    s_cmp_lt_u32 2, s40
    s_cselect_b32 s38, s38, 268435456
    s_add_u32 s43, s45, 81920
    s_mov_b32 s41, 0
    s_mov_b32 s42, 0
    s_mov_b32 s46, 268435456
    s_waitcnt vmcnt(10)
    s_barrier
    ds_read_b128 v[64:67], v20 offset:0
    ds_read_b128 v[68:71], v21 offset:0
    ds_read_b128 v[72:75], v22 offset:0
    ds_read_b128 v[76:79], v23 offset:0
    ds_read_b128 v[80:83], v20 offset:1024
    ds_read_b128 v[84:87], v21 offset:1024
    ds_read_b128 v[88:91], v22 offset:1024
L_bqk_top:
    s_waitcnt lgkmcnt(6)
    v_mfma_f32_32x32x16_bf16 v[32:47], v[96:99], v[64:67], 0
    ds_read_b128 v[92:95], v23 offset:1024
    s_max_i32 s33, s41, 2
    s_sub_u32 s33, s33, 2
    v_mov_b32 v15, s33
    s_waitcnt lgkmcnt(6)
    v_mfma_f32_32x32x16_bf16 v[32:47], v[100:103], v[68:71], v[32:47]
    ds_read_b128 v[64:67], v20 offset:2048
    v_cvt_pk_bf16_f32 v24, v48, v49
    v_cvt_pk_bf16_f32 v25, v50, v51
    v_cvt_pk_bf16_f32 v26, v56, v57
    v_cvt_pk_bf16_f32 v27, v58, v59
    s_waitcnt lgkmcnt(6)
    v_mfma_f32_32x32x16_bf16 v[32:47], v[104:107], v[72:75], v[32:47]
    ds_read_b128 v[68:71], v21 offset:2048
    v_cvt_pk_bf16_f32 v28, v52, v53
    v_cvt_pk_bf16_f32 v29, v54, v55
    v_cvt_pk_bf16_f32 v30, v60, v61
    v_cvt_pk_bf16_f32 v31, v62, v63
    s_waitcnt lgkmcnt(6)
    v_mfma_f32_32x32x16_bf16 v[32:47], v[108:111], v[76:79], v[32:47]
    ds_read_b128 v[72:75], v22 offset:2048
    buffer_store_dwordx4 v[24:27], v9, s[4:7], s46 offen offset:0 sc1
    s_waitcnt lgkmcnt(6)
    v_mfma_f32_32x32x16_bf16 v[32:47], v[112:115], v[80:83], v[32:47]
    ds_read_b128 v[76:79], v23 offset:2048
    s_waitcnt lgkmcnt(6)
    v_mfma_f32_32x32x16_bf16 v[32:47], v[116:119], v[84:87], v[32:47]
    ds_read_b128 v[80:83], v20 offset:3072
    buffer_store_dwordx4 v[28:31], v9, s[4:7], s46 offen offset:1024 sc1
    s_waitcnt lgkmcnt(6)
    v_mfma_f32_32x32x16_bf16 v[32:47], v[120:123], v[88:91], v[32:47]
    ds_read_b128 v[84:87], v21 offset:3072
    s_waitcnt lgkmcnt(6)
    v_mfma_f32_32x32x16_bf16 v[32:47], v[124:127], v[92:95], v[32:47]
    ds_read_b128 v[88:91], v22 offset:3072
    buffer_store_dword v15, off, s[4:7], s44 sc1
    s_waitcnt lgkmcnt(6)
    v_mfma_f32_32x32x16_bf16 v[32:47], v[128:131], v[64:67], v[32:47]
    ds_read_b128 v[92:95], v23 offset:3072
    s_waitcnt lgkmcnt(6)
    v_mfma_f32_32x32x16_bf16 v[32:47], v[132:135], v[68:71], v[32:47]
    ds_read_b128 v[64:67], v20 offset:4096
    s_waitcnt lgkmcnt(6)
    v_mfma_f32_32x32x16_bf16 v[32:47], v[136:139], v[72:75], v[32:47]
    ds_read_b128 v[68:71], v21 offset:4096
    s_add_u32 m0, s43, 0
    s_nop 0
    buffer_load_dwordx4 v13, s[12:15], s38 offen offset:0 lds
    s_waitcnt lgkmcnt(6)
    v_mfma_f32_32x32x16_bf16 v[32:47], v[140:143], v[76:79], v[32:47]
    ds_read_b128 v[72:75], v22 offset:4096
    s_waitcnt lgkmcnt(6)
    v_mfma_f32_32x32x16_bf16 v[32:47], v[144:147], v[80:83], v[32:47]
    ds_read_b128 v[76:79], v23 offset:4096
    s_add_u32 m0, s43, 896
    s_nop 0
    buffer_load_dwordx4 v13, s[12:15], s38 offen offset:128 lds
    s_waitcnt lgkmcnt(6)
    v_mfma_f32_32x32x16_bf16 v[32:47], v[148:151], v[84:87], v[32:47]
    ds_read_b128 v[80:83], v20 offset:5120
    s_waitcnt lgkmcnt(6)
    v_mfma_f32_32x32x16_bf16 v[32:47], v[152:155], v[88:91], v[32:47]
    ds_read_b128 v[84:87], v21 offset:5120
    s_add_u32 m0, s43, 1792
    s_nop 0
    buffer_load_dwordx4 v13, s[12:15], s38 offen offset:256 lds
    s_waitcnt lgkmcnt(6)
    v_mfma_f32_32x32x16_bf16 v[32:47], v[156:159], v[92:95], v[32:47]
    ds_read_b128 v[88:91], v22 offset:5120
    s_waitcnt lgkmcnt(6)
    v_mfma_f32_32x32x16_bf16 v[32:47], v[160:163], v[64:67], v[32:47]
    ds_read_b128 v[92:95], v23 offset:5120
    s_waitcnt lgkmcnt(6)
    v_mfma_f32_32x32x16_bf16 v[32:47], v[164:167], v[68:71], v[32:47]
    ds_read_b128 v[64:67], v20 offset:6144
    s_add_u32 m0, s43, 2688
    s_nop 0
    buffer_load_dwordx4 v13, s[12:15], s38 offen offset:384 lds
    s_waitcnt lgkmcnt(6)
    v_mfma_f32_32x32x16_bf16 v[32:47], v[168:171], v[72:75], v[32:47]
    ds_read_b128 v[68:71], v21 offset:6144
    s_waitcnt lgkmcnt(6)
    v_mfma_f32_32x32x16_bf16 v[32:47], v[172:175], v[76:79], v[32:47]
    ds_read_b128 v[72:75], v22 offset:6144
    s_add_u32 m0, s43, 3584
    s_nop 0
    buffer_load_dwordx4 v13, s[12:15], s38 offen offset:512 lds
    s_waitcnt lgkmcnt(6)
    v_mfma_f32_32x32x16_bf16 v[32:47], v[176:179], v[80:83], v[32:47]
    ds_read_b128 v[76:79], v23 offset:6144
    s_waitcnt lgkmcnt(6)
    v_mfma_f32_32x32x16_bf16 v[32:47], v[180:183], v[84:87], v[32:47]
    ds_read_b128 v[80:83], v20 offset:7168
    s_add_u32 m0, s43, 4480
    s_nop 0
    buffer_load_dwordx4 v13, s[12:15], s38 offen offset:640 lds
    s_waitcnt lgkmcnt(6)
    v_mfma_f32_32x32x16_bf16 v[32:47], v[184:187], v[88:91], v[32:47]
    ds_read_b128 v[84:87], v21 offset:7168
    s_waitcnt lgkmcnt(6)
    v_mfma_f32_32x32x16_bf16 v[32:47], v[188:191], v[92:95], v[32:47]
    ds_read_b128 v[88:91], v22 offset:7168
    s_waitcnt lgkmcnt(6)
    v_mfma_f32_32x32x16_bf16 v[32:47], v[192:195], v[64:67], v[32:47]
    ds_read_b128 v[92:95], v23 offset:7168
    s_add_u32 m0, s43, 5376
    s_nop 0
    buffer_load_dwordx4 v13, s[12:15], s38 offen offset:768 lds
    s_waitcnt lgkmcnt(6)
    v_mfma_f32_32x32x16_bf16 v[32:47], v[196:199], v[68:71], v[32:47]
    ds_read_b128 v[64:67], v20 offset:8192
    s_waitcnt lgkmcnt(6)
    v_mfma_f32_32x32x16_bf16 v[32:47], v[200:203], v[72:75], v[32:47]
    ds_read_b128 v[68:71], v21 offset:8192
    s_add_u32 m0, s43, 6272
    s_nop 0
    buffer_load_dwordx4 v13, s[12:15], s38 offen offset:896 lds
    s_waitcnt lgkmcnt(6)
    v_mfma_f32_32x32x16_bf16 v[32:47], v[204:207], v[76:79], v[32:47]
    ds_read_b128 v[72:75], v22 offset:8192
    s_waitcnt lgkmcnt(6)
    v_mfma_f32_32x32x16_bf16 v[32:47], v[208:211], v[80:83], v[32:47]
    ds_read_b128 v[76:79], v23 offset:8192
    s_add_u32 m0, s43, 7168
    s_nop 0
    buffer_load_dwordx4 v13, s[12:15], s38 offen offset:1024 lds
    s_waitcnt lgkmcnt(6)
    v_mfma_f32_32x32x16_bf16 v[32:47], v[212:215], v[84:87], v[32:47]
    ds_read_b128 v[80:83], v20 offset:9216
    s_waitcnt lgkmcnt(6)
    v_mfma_f32_32x32x16_bf16 v[32:47], v[216:219], v[88:91], v[32:47]
    ds_read_b128 v[84:87], v21 offset:9216
    s_waitcnt lgkmcnt(6)
    v_mfma_f32_32x32x16_bf16 v[32:47], v[220:223], v[92:95], v[32:47]
    ds_read_b128 v[88:91], v22 offset:9216
    s_add_u32 m0, s43, 8064
    s_nop 0
    buffer_load_dwordx4 v13, s[12:15], s38 offen offset:1152 lds
    s_waitcnt lgkmcnt(6)
    v_mfma_f32_32x32x16_bf16 v[32:47], v[224:227], v[64:67], v[32:47]
    ds_read_b128 v[92:95], v23 offset:9216
    s_add_u32 s42, s42, 40960
    s_cmp_eq_u32 s42, 163840
    s_cselect_b32 s42, 0, s42
    v_add_u32 v20, s42, v16
    v_add_u32 v21, s42, v17
    v_add_u32 v22, s42, v18
    v_add_u32 v23, s42, v19
    s_waitcnt vmcnt(13)
    s_barrier
    s_waitcnt lgkmcnt(6)
    v_mfma_f32_32x32x16_bf16 v[32:47], v[228:231], v[68:71], v[32:47]
    ds_read_b128 v[64:67], v20 offset:0
    s_add_u32 s43, s42, 81920
    s_cmp_ge_u32 s43, 163840
    s_cselect_b32 s33, 163840, 0
    s_sub_u32 s43, s43, s33
    s_add_u32 s43, s43, s45
    s_waitcnt lgkmcnt(6)
    v_mfma_f32_32x32x16_bf16 v[32:47], v[232:235], v[72:75], v[32:47]
    ds_read_b128 v[68:71], v21 offset:0
    s_add_u32 s38, s38, 40960
    s_add_u32 s33, s41, 3
    s_cmp_lt_u32 s33, s40
    s_cselect_b32 s38, s38, 268435456
    s_waitcnt lgkmcnt(6)
    v_mfma_f32_32x32x16_bf16 v[32:47], v[236:239], v[76:79], v[32:47]
    ds_read_b128 v[72:75], v22 offset:0
    s_mov_b32 s46, s39
    s_add_u32 s39, s39, 65536
    s_add_u32 s41, s41, 1
    s_cmp_lt_u32 s41, s40
    s_waitcnt lgkmcnt(6)
    v_mfma_f32_32x32x16_bf16 v[32:47], v[240:243], v[80:83], v[32:47]
    ds_read_b128 v[76:79], v23 offset:0
    s_waitcnt lgkmcnt(6)
    v_mfma_f32_32x32x16_bf16 v[32:47], v[244:247], v[84:87], v[32:47]
    ds_read_b128 v[80:83], v20 offset:1024
    s_waitcnt lgkmcnt(6)
    v_mfma_f32_32x32x16_bf16 v[32:47], v[248:251], v[88:91], v[32:47]
    ds_read_b128 v[84:87], v21 offset:1024
    s_waitcnt lgkmcnt(6)
    v_mfma_f32_32x32x16_bf16 v[32:47], v[252:255], v[92:95], v[32:47]
    ds_read_b128 v[88:91], v22 offset:1024
    s_nop 9
    s_cbranch_scc0 L_bqk_end0
    s_waitcnt lgkmcnt(6)
    v_mfma_f32_32x32x16_bf16 v[48:63], v[96:99], v[64:67], 0
    ds_read_b128 v[92:95], v23 offset:1024
    s_max_i32 s33, s41, 2
    s_sub_u32 s33, s33, 2
    v_mov_b32 v15, s33
    s_waitcnt lgkmcnt(6)
    v_mfma_f32_32x32x16_bf16 v[48:63], v[100:103], v[68:71], v[48:63]
    ds_read_b128 v[64:67], v20 offset:2048
    v_cvt_pk_bf16_f32 v24, v32, v33
    v_cvt_pk_bf16_f32 v25, v34, v35
    v_cvt_pk_bf16_f32 v26, v40, v41
    v_cvt_pk_bf16_f32 v27, v42, v43
    s_waitcnt lgkmcnt(6)
    v_mfma_f32_32x32x16_bf16 v[48:63], v[104:107], v[72:75], v[48:63]
    ds_read_b128 v[68:71], v21 offset:2048
    v_cvt_pk_bf16_f32 v28, v36, v37
    v_cvt_pk_bf16_f32 v29, v38, v39
    v_cvt_pk_bf16_f32 v30, v44, v45
    v_cvt_pk_bf16_f32 v31, v46, v47
    s_waitcnt lgkmcnt(6)
    v_mfma_f32_32x32x16_bf16 v[48:63], v[108:111], v[76:79], v[48:63]
    ds_read_b128 v[72:75], v22 offset:2048
    buffer_store_dwordx4 v[24:27], v9, s[4:7], s46 offen offset:0 sc1
    s_waitcnt lgkmcnt(6)
    v_mfma_f32_32x32x16_bf16 v[48:63], v[112:115], v[80:83], v[48:63]
    ds_read_b128 v[76:79], v23 offset:2048
    s_waitcnt lgkmcnt(6)
    v_mfma_f32_32x32x16_bf16 v[48:63], v[116:119], v[84:87], v[48:63]
    ds_read_b128 v[80:83], v20 offset:3072
    buffer_store_dwordx4 v[28:31], v9, s[4:7], s46 offen offset:1024 sc1
    s_waitcnt lgkmcnt(6)
    v_mfma_f32_32x32x16_bf16 v[48:63], v[120:123], v[88:91], v[48:63]
    ds_read_b128 v[84:87], v21 offset:3072
    s_waitcnt lgkmcnt(6)
    v_mfma_f32_32x32x16_bf16 v[48:63], v[124:127], v[92:95], v[48:63]
    ds_read_b128 v[88:91], v22 offset:3072
    buffer_store_dword v15, off, s[4:7], s44 sc1
    s_waitcnt lgkmcnt(6)
    v_mfma_f32_32x32x16_bf16 v[48:63], v[128:131], v[64:67], v[48:63]
    ds_read_b128 v[92:95], v23 offset:3072
    s_waitcnt lgkmcnt(6)
    v_mfma_f32_32x32x16_bf16 v[48:63], v[132:135], v[68:71], v[48:63]
    ds_read_b128 v[64:67], v20 offset:4096
    s_waitcnt lgkmcnt(6)
    v_mfma_f32_32x32x16_bf16 v[48:63], v[136:139], v[72:75], v[48:63]
    ds_read_b128 v[68:71], v21 offset:4096
    s_add_u32 m0, s43, 0
    s_nop 0
    buffer_load_dwordx4 v13, s[12:15], s38 offen offset:0 lds
    s_waitcnt lgkmcnt(6)
    v_mfma_f32_32x32x16_bf16 v[48:63], v[140:143], v[76:79], v[48:63]
    ds_read_b128 v[72:75], v22 offset:4096
    s_waitcnt lgkmcnt(6)
    v_mfma_f32_32x32x16_bf16 v[48:63], v[144:147], v[80:83], v[48:63]
    ds_read_b128 v[76:79], v23 offset:4096
    s_add_u32 m0, s43, 896
    s_nop 0
    buffer_load_dwordx4 v13, s[12:15], s38 offen offset:128 lds
    s_waitcnt lgkmcnt(6)
    v_mfma_f32_32x32x16_bf16 v[48:63], v[148:151], v[84:87], v[48:63]
    ds_read_b128 v[80:83], v20 offset:5120
    s_waitcnt lgkmcnt(6)
    v_mfma_f32_32x32x16_bf16 v[48:63], v[152:155], v[88:91], v[48:63]
    ds_read_b128 v[84:87], v21 offset:5120
    s_add_u32 m0, s43, 1792
    s_nop 0
    buffer_load_dwordx4 v13, s[12:15], s38 offen offset:256 lds
    s_waitcnt lgkmcnt(6)
    v_mfma_f32_32x32x16_bf16 v[48:63], v[156:159], v[92:95], v[48:63]
    ds_read_b128 v[88:91], v22 offset:5120
    s_waitcnt lgkmcnt(6)
    v_mfma_f32_32x32x16_bf16 v[48:63], v[160:163], v[64:67], v[48:63]
    ds_read_b128 v[92:95], v23 offset:5120
    s_waitcnt lgkmcnt(6)
    v_mfma_f32_32x32x16_bf16 v[48:63], v[164:167], v[68:71], v[48:63]
    ds_read_b128 v[64:67], v20 offset:6144
    s_add_u32 m0, s43, 2688
    s_nop 0
    buffer_load_dwordx4 v13, s[12:15], s38 offen offset:384 lds
    s_waitcnt lgkmcnt(6)
    v_mfma_f32_32x32x16_bf16 v[48:63], v[168:171], v[72:75], v[48:63]
    ds_read_b128 v[68:71], v21 offset:6144
    s_waitcnt lgkmcnt(6)
    v_mfma_f32_32x32x16_bf16 v[48:63], v[172:175], v[76:79], v[48:63]
    ds_read_b128 v[72:75], v22 offset:6144
    s_add_u32 m0, s43, 3584
    s_nop 0
    buffer_load_dwordx4 v13, s[12:15], s38 offen offset:512 lds
    s_waitcnt lgkmcnt(6)
    v_mfma_f32_32x32x16_bf16 v[48:63], v[176:179], v[80:83], v[48:63]
    ds_read_b128 v[76:79], v23 offset:6144
    s_waitcnt lgkmcnt(6)
    v_mfma_f32_32x32x16_bf16 v[48:63], v[180:183], v[84:87], v[48:63]
    ds_read_b128 v[80:83], v20 offset:7168
    s_add_u32 m0, s43, 4480
    s_nop 0
    buffer_load_dwordx4 v13, s[12:15], s38 offen offset:640 lds
    s_waitcnt lgkmcnt(6)
    v_mfma_f32_32x32x16_bf16 v[48:63], v[184:187], v[88:91], v[48:63]
    ds_read_b128 v[84:87], v21 offset:7168
    s_waitcnt lgkmcnt(6)
    v_mfma_f32_32x32x16_bf16 v[48:63], v[188:191], v[92:95], v[48:63]
    ds_read_b128 v[88:91], v22 offset:7168
    s_waitcnt lgkmcnt(6)
    v_mfma_f32_32x32x16_bf16 v[48:63], v[192:195], v[64:67], v[48:63]
    ds_read_b128 v[92:95], v23 offset:7168
    s_add_u32 m0, s43, 5376
    s_nop 0
    buffer_load_dwordx4 v13, s[12:15], s38 offen offset:768 lds
    s_waitcnt lgkmcnt(6)
    v_mfma_f32_32x32x16_bf16 v[48:63], v[196:199], v[68:71], v[48:63]
    ds_read_b128 v[64:67], v20 offset:8192
    s_waitcnt lgkmcnt(6)
    v_mfma_f32_32x32x16_bf16 v[48:63], v[200:203], v[72:75], v[48:63]
    ds_read_b128 v[68:71], v21 offset:8192
    s_add_u32 m0, s43, 6272
    s_nop 0
    buffer_load_dwordx4 v13, s[12:15], s38 offen offset:896 lds
    s_waitcnt lgkmcnt(6)
    v_mfma_f32_32x32x16_bf16 v[48:63], v[204:207], v[76:79], v[48:63]
    ds_read_b128 v[72:75], v22 offset:8192
    s_waitcnt lgkmcnt(6)
    v_mfma_f32_32x32x16_bf16 v[48:63], v[208:211], v[80:83], v[48:63]
    ds_read_b128 v[76:79], v23 offset:8192
    s_add_u32 m0, s43, 7168
    s_nop 0
    buffer_load_dwordx4 v13, s[12:15], s38 offen offset:1024 lds
    s_waitcnt lgkmcnt(6)
    v_mfma_f32_32x32x16_bf16 v[48:63], v[212:215], v[84:87], v[48:63]
    ds_read_b128 v[80:83], v20 offset:9216
    s_waitcnt lgkmcnt(6)
    v_mfma_f32_32x32x16_bf16 v[48:63], v[216:219], v[88:91], v[48:63]
    ds_read_b128 v[84:87], v21 offset:9216
    s_waitcnt lgkmcnt(6)
    v_mfma_f32_32x32x16_bf16 v[48:63], v[220:223], v[92:95], v[48:63]
    ds_read_b128 v[88:91], v22 offset:9216
    s_add_u32 m0, s43, 8064
    s_nop 0
    buffer_load_dwordx4 v13, s[12:15], s38 offen offset:1152 lds
    s_waitcnt lgkmcnt(6)
    v_mfma_f32_32x32x16_bf16 v[48:63], v[224:227], v[64:67], v[48:63]
    ds_read_b128 v[92:95], v23 offset:9216
    s_add_u32 s42, s42, 40960
    s_cmp_eq_u32 s42, 163840
    s_cselect_b32 s42, 0, s42
    v_add_u32 v20, s42, v16
    v_add_u32 v21, s42, v17
    v_add_u32 v22, s42, v18
    v_add_u32 v23, s42, v19
    s_waitcnt vmcnt(13)
    s_barrier
    s_waitcnt lgkmcnt(6)
    v_mfma_f32_32x32x16_bf16 v[48:63], v[228:231], v[68:71], v[48:63]
    ds_read_b128 v[64:67], v20 offset:0
    s_add_u32 s43, s42, 81920
    s_cmp_ge_u32 s43, 163840
    s_cselect_b32 s33, 163840, 0
    s_sub_u32 s43, s43, s33
    s_add_u32 s43, s43, s45
    s_waitcnt lgkmcnt(6)
    v_mfma_f32_32x32x16_bf16 v[48:63], v[232:235], v[72:75], v[48:63]
    ds_read_b128 v[68:71], v21 offset:0
    s_add_u32 s38, s38, 40960
    s_add_u32 s33, s41, 3
    s_cmp_lt_u32 s33, s40
    s_cselect_b32 s38, s38, 268435456
    s_waitcnt lgkmcnt(6)
    v_mfma_f32_32x32x16_bf16 v[48:63], v[236:239], v[76:79], v[48:63]
    ds_read_b128 v[72:75], v22 offset:0
    s_mov_b32 s46, s39
    s_add_u32 s39, s39, 65536
    s_add_u32 s41, s41, 1
    s_cmp_lt_u32 s41, s40
    s_waitcnt lgkmcnt(6)
    v_mfma_f32_32x32x16_bf16 v[48:63], v[240:243], v[80:83], v[48:63]
    ds_read_b128 v[76:79], v23 offset:0
    s_waitcnt lgkmcnt(6)
    v_mfma_f32_32x32x16_bf16 v[48:63], v[244:247], v[84:87], v[48:63]
    ds_read_b128 v[80:83], v20 offset:1024
    s_waitcnt lgkmcnt(6)
    v_mfma_f32_32x32x16_bf16 v[48:63], v[248:251], v[88:91], v[48:63]
    ds_read_b128 v[84:87], v21 offset:1024
    s_waitcnt lgkmcnt(6)
    v_mfma_f32_32x32x16_bf16 v[48:63], v[252:255], v[92:95], v[48:63]
    ds_read_b128 v[88:91], v22 offset:1024
    s_nop 0
    s_cbranch_scc1 L_bqk_top
    s_nop 9
    v_cvt_pk_bf16_f32 v24, v48, v49
    v_cvt_pk_bf16_f32 v25, v50, v51
    v_cvt_pk_bf16_f32 v26, v56, v57
    v_cvt_pk_bf16_f32 v27, v58, v59
    v_cvt_pk_bf16_f32 v28, v52, v53
    v_cvt_pk_bf16_f32 v29, v54, v55
    v_cvt_pk_bf16_f32 v30, v60, v61
    v_cvt_pk_bf16_f32 v31, v62, v63
    buffer_store_dwordx4 v[24:27], v9, s[4:7], s46 offen offset:0 sc1
    buffer_store_dwordx4 v[28:31], v9, s[4:7], s46 offen offset:1024 sc1
    s_branch L_bqk_end
L_bqk_end0:
    v_cvt_pk_bf16_f32 v24, v32, v33
    v_cvt_pk_bf16_f32 v25, v34, v35
    v_cvt_pk_bf16_f32 v26, v40, v41
    v_cvt_pk_bf16_f32 v27, v42, v43
    v_cvt_pk_bf16_f32 v28, v36, v37
    v_cvt_pk_bf16_f32 v29, v38, v39
    v_cvt_pk_bf16_f32 v30, v44, v45
    v_cvt_pk_bf16_f32 v31, v46, v47
    buffer_store_dwordx4 v[24:27], v9, s[4:7], s46 offen offset:0 sc1
    buffer_store_dwordx4 v[28:31], v9, s[4:7], s46 offen offset:1024 sc1
L_bqk_end:
    s_waitcnt vmcnt(0) lgkmcnt(0)
    s_barrier
    v_mov_b32 v15, s40
    buffer_store_dword v15, off, s[4:7], s44 sc1
    s_branch L_b1
L_bv:
    v_mbcnt_lo_u32_b32 v10, -1, 0
    v_mbcnt_hi_u32_b32 v10, -1, v10
    v_lshrrev_b32 v11, 3, v10
    s_lshl_b32 s33, s3, 3
    v_add_u32 v11, s33, v11
    v_lshrrev_b32 v12, 1, v11
    v_xor_b32 v12, v12, v10
    v_and_b32 v12, 7, v12
    v_mul_u32_u24 v11, 1280, v11
    v_lshl_add_u32 v13, v12, 4, v11
    v_bfe_u32 v11, v10, 3, 2
    v_mul_u32_u24 v11, 10240, v11
    v_and_b32 v12, 7, v10
    v_lshl_add_u32 v11, v12, 7, v11
    v_bfe_u32 v12, v10, 1, 3
    v_lshrrev_b32 v15, 5, v10
    v_xor_b32 v12, v12, v15
    v_xor_b32 v15, 0, v12
    v_lshl_add_u32 v16, v15, 4, v11
    v_mov_b32 v20, v16
    v_xor_b32 v15, 2, v12
    v_lshl_add_u32 v17, v15, 4, v11
    v_mov_b32 v21, v17
    v_xor_b32 v15, 4, v12
    v_lshl_add_u32 v18, v15, 4, v11
    v_mov_b32 v22, v18
    v_xor_b32 v15, 6, v12
    v_lshl_add_u32 v19, v15, 4, v11
    v_mov_b32 v23, v19
    v_and_b32 v11, 27, v10
    v_cmp_eq_u32 s[28:29], 24, v11
    v_mov_b32 v14, 0x3f803f80
    s_mul_i32 s45, s3, 10240
    s_add_u32 s43, s45, 0
    s_add_u32 m0, s43, 0
    s_nop 0
    buffer_load_dwordx4 v13, s[12:15], s38 offen offset:0 lds
    s_add_u32 m0, s43, 896
    s_nop 0
    buffer_load_dwordx4 v13, s[12:15], s38 offen offset:128 lds
    s_add_u32 m0, s43, 1792
    s_nop 0
    buffer_load_dwordx4 v13, s[12:15], s38 offen offset:256 lds
    s_add_u32 m0, s43, 2688
    s_nop 0
    buffer_load_dwordx4 v13, s[12:15], s38 offen offset:384 lds
    s_add_u32 m0, s43, 3584
    s_nop 0
    buffer_load_dwordx4 v13, s[12:15], s38 offen offset:512 lds
    s_add_u32 m0, s43, 4480
    s_nop 0
    buffer_load_dwordx4 v13, s[12:15], s38 offen offset:640 lds
    s_add_u32 m0, s43, 5376
    s_nop 0
    buffer_load_dwordx4 v13, s[12:15], s38 offen offset:768 lds
    s_add_u32 m0, s43, 6272
    s_nop 0
    buffer_load_dwordx4 v13, s[12:15], s38 offen offset:896 lds
    s_add_u32 m0, s43, 7168
    s_nop 0
    buffer_load_dwordx4 v13, s[12:15], s38 offen offset:1024 lds
    s_add_u32 m0, s43, 8064
    s_nop 0
    buffer_load_dwordx4 v13, s[12:15], s38 offen offset:1152 lds
    s_add_u32 s38, s38, 40960
    s_cmp_lt_u32 1, s40
    s_cselect_b32 s38, s38, 268435456
    s_add_u32 s43, s45, 40960
    s_add_u32 m0, s43, 0
    s_nop 0
    buffer_load_dwordx4 v13, s[12:15], s38 offen offset:0 lds
    s_add_u32 m0, s43, 896
    s_nop 0
    buffer_load_dwordx4 v13, s[12:15], s38 offen offset:128 lds
    s_add_u32 m0, s43, 1792
    s_nop 0
    buffer_load_dwordx4 v13, s[12:15], s38 offen offset:256 lds
    s_add_u32 m0, s43, 2688
    s_nop 0
    buffer_load_dwordx4 v13, s[12:15], s38 offen offset:384 lds
    s_add_u32 m0, s43, 3584
    s_nop 0
    buffer_load_dwordx4 v13, s[12:15], s38 offen offset:512 lds
    s_add_u32 m0, s43, 4480
    s_nop 0
    buffer_load_dwordx4 v13, s[12:15], s38 offen offset:640 lds
    s_add_u32 m0, s43, 5376
    s_nop 0
    buffer_load_dwordx4 v13, s[12:15], s38 offen offset:768 lds
    s_add_u32 m0, s43, 6272
    s_nop 0
    buffer_load_dwordx4 v13, s[12:15], s38 offen offset:896 lds
    s_add_u32 m0, s43, 7168
    s_nop 0
    buffer_load_dwordx4 v13, s[12:15], s38 offen offset:1024 lds
    s_add_u32 m0, s43, 8064
    s_nop 0
    buffer_load_dwordx4 v13, s[12:15], s38 offen offset:1152 lds
    s_add_u32 s38, s38, 40960
    s_cmp_lt_u32 2, s40
    s_cselect_b32 s38, s38, 268435456
    s_add_u32 s43, s45, 81920
    s_mov_b32 s41, 0
    s_mov_b32 s42, 0
    s_mov_b32 s46, 268435456
    s_waitcnt vmcnt(10)
    s_barrier
    ds_read_b128 v[64:67], v20 offset:0
    ds_read_b128 v[68:71], v21 offset:0
    ds_read_b128 v[72:75], v22 offset:0
    ds_read_b128 v[76:79], v23 offset:0
    ds_read_b128 v[80:83], v20 offset:1024
    ds_read_b128 v[84:87], v21 offset:1024
    ds_read_b128 v[88:91], v22 offset:1024
L_bv_top:
    s_waitcnt lgkmcnt(6)
    v_mfma_f32_32x32x16_bf16 v[32:47], v[64:67], v[96:99], 0
    ds_read_b128 v[92:95], v23 offset:1024
    s_max_i32 s33, s41, 2
    s_sub_u32 s33, s33, 2
    v_mov_b32 v15, s33
    s_waitcnt lgkmcnt(6)
    v_mfma_f32_32x32x16_bf16 v[32:47], v[68:71], v[100:103], v[32:47]
    ds_read_b128 v[64:67], v20 offset:2048
    v_cvt_pk_bf16_f32 v24, v48, v49
    v_cvt_pk_bf16_f32 v25, v50, v51
    v_cvt_pk_bf16_f32 v26, v56, v57
    v_cvt_pk_bf16_f32 v27, v58, v59
    s_waitcnt lgkmcnt(6)
    v_mfma_f32_32x32x16_bf16 v[32:47], v[72:75], v[104:107], v[32:47]
    ds_read_b128 v[68:71], v21 offset:2048
    v_cvt_pk_bf16_f32 v28, v52, v53
    v_cvt_pk_bf16_f32 v29, v54, v55
    v_cvt_pk_bf16_f32 v30, v60, v61
    v_cvt_pk_bf16_f32 v31, v62, v63
    s_waitcnt lgkmcnt(6)
    v_mfma_f32_32x32x16_bf16 v[32:47], v[76:79], v[108:111], v[32:47]
    ds_read_b128 v[72:75], v22 offset:2048
    v_cndmask_b32 v24, v24, v14, s[28:29]
    v_cndmask_b32 v25, v25, v14, s[28:29]
    v_cndmask_b32 v26, v26, v14, s[28:29]
    v_cndmask_b32 v27, v27, v14, s[28:29]
    s_waitcnt lgkmcnt(6)
    v_mfma_f32_32x32x16_bf16 v[32:47], v[80:83], v[112:115], v[32:47]
    ds_read_b128 v[76:79], v23 offset:2048
    v_cndmask_b32 v28, v28, v14, s[28:29]
    v_cndmask_b32 v29, v29, v14, s[28:29]
    v_cndmask_b32 v30, v30, v14, s[28:29]
    v_cndmask_b32 v31, v31, v14, s[28:29]
    s_waitcnt lgkmcnt(6)
    v_mfma_f32_32x32x16_bf16 v[32:47], v[84:87], v[116:119], v[32:47]
    ds_read_b128 v[80:83], v20 offset:3072
    buffer_store_dwordx4 v[24:27], v9, s[4:7], s46 offen offset:0 sc1
    s_waitcnt lgkmcnt(6)
    v_mfma_f32_32x32x16_bf16 v[32:47], v[88:91], v[120:123], v[32:47]
    ds_read_b128 v[84:87], v21 offset:3072
    s_waitcnt lgkmcnt(6)
    v_mfma_f32_32x32x16_bf16 v[32:47], v[92:95], v[124:127], v[32:47]
    ds_read_b128 v[88:91], v22 offset:3072
    buffer_store_dwordx4 v[28:31], v9, s[4:7], s46 offen offset:1024 sc1
    s_waitcnt lgkmcnt(6)
    v_mfma_f32_32x32x16_bf16 v[32:47], v[64:67], v[128:131], v[32:47]
    ds_read_b128 v[92:95], v23 offset:3072
    s_waitcnt lgkmcnt(6)
    v_mfma_f32_32x32x16_bf16 v[32:47], v[68:71], v[132:135], v[32:47]
    ds_read_b128 v[64:67], v20 offset:4096
    buffer_store_dword v15, off, s[4:7], s44 sc1
    s_waitcnt lgkmcnt(6)
    v_mfma_f32_32x32x16_bf16 v[32:47], v[72:75], v[136:139], v[32:47]
    ds_read_b128 v[68:71], v21 offset:4096
    s_waitcnt lgkmcnt(6)
    v_mfma_f32_32x32x16_bf16 v[32:47], v[76:79], v[140:143], v[32:47]
    ds_read_b128 v[72:75], v22 offset:4096
    s_add_u32 m0, s43, 0
    s_nop 0
    buffer_load_dwordx4 v13, s[12:15], s38 offen offset:0 lds
    s_waitcnt lgkmcnt(6)
    v_mfma_f32_32x32x16_bf16 v[32:47], v[80:83], v[144:147], v[32:47]
    ds_read_b128 v[76:79], v23 offset:4096
    s_waitcnt lgkmcnt(6)
    v_mfma_f32_32x32x16_bf16 v[32:47], v[84:87], v[148:151], v[32:47]
    ds_read_b128 v[80:83], v20 offset:5120
    s_add_u32 m0, s43, 896
    s_nop 0
    buffer_load_dwordx4 v13, s[12:15], s38 offen offset:128 lds
    s_waitcnt lgkmcnt(6)
    v_mfma_f32_32x32x16_bf16 v[32:47], v[88:91], v[152:155], v[32:47]
    ds_read_b128 v[84:87], v21 offset:5120
    s_waitcnt lgkmcnt(6)
    v_mfma_f32_32x32x16_bf16 v[32:47], v[92:95], v[156:159], v[32:47]
    ds_read_b128 v[88:91], v22 offset:5120
    s_add_u32 m0, s43, 1792
    s_nop 0
    buffer_load_dwordx4 v13, s[12:15], s38 offen offset:256 lds
    s_waitcnt lgkmcnt(6)
    v_mfma_f32_32x32x16_bf16 v[32:47], v[64:67], v[160:163], v[32:47]
    ds_read_b128 v[92:95], v23 offset:5120
    s_waitcnt lgkmcnt(6)
    v_mfma_f32_32x32x16_bf16 v[32:47], v[68:71], v[164:167], v[32:47]
    ds_read_b128 v[64:67], v20 offset:6144
    s_waitcnt lgkmcnt(6)
    v_mfma_f32_32x32x16_bf16 v[32:47], v[72:75], v[168:171], v[32:47]
    ds_read_b128 v[68:71], v21 offset:6144
    s_add_u32 m0, s43, 2688
    s_nop 0
    buffer_load_dwordx4 v13, s[12:15], s38 offen offset:384 lds
    s_waitcnt lgkmcnt(6)
    v_mfma_f32_32x32x16_bf16 v[32:47], v[76:79], v[172:175], v[32:47]
    ds_read_b128 v[72:75], v22 offset:6144
    s_waitcnt lgkmcnt(6)
    v_mfma_f32_32x32x16_bf16 v[32:47], v[80:83], v[176:179], v[32:47]
    ds_read_b128 v[76:79], v23 offset:6144
    s_add_u32 m0, s43, 3584
    s_nop 0
    buffer_load_dwordx4 v13, s[12:15], s38 offen offset:512 lds
    s_waitcnt lgkmcnt(6)
    v_mfma_f32_32x32x16_bf16 v[32:47], v[84:87], v[180:183], v[32:47]
    ds_read_b128 v[80:83], v20 offset:7168
    s_waitcnt lgkmcnt(6)
    v_mfma_f32_32x32x16_bf16 v[32:47], v[88:91], v[184:187], v[32:47]
    ds_read_b128 v[84:87], v21 offset:7168
    s_add_u32 m0, s43, 4480
    s_nop 0
    buffer_load_dwordx4 v13, s[12:15], s38 offen offset:640 lds
    s_waitcnt lgkmcnt(6)
    v_mfma_f32_32x32x16_bf16 v[32:47], v[92:95], v[188:191], v[32:47]
    ds_read_b128 v[88:91], v22 offset:7168
    s_waitcnt lgkmcnt(6)
    v_mfma_f32_32x32x16_bf16 v[32:47], v[64:67], v[192:195], v[32:47]
    ds_read_b128 v[92:95], v23 offset:7168
    s_add_u32 m0, s43, 5376
    s_nop 0
    buffer_load_dwordx4 v13, s[12:15], s38 offen offset:768 lds
    s_waitcnt lgkmcnt(6)
    v_mfma_f32_32x32x16_bf16 v[32:47], v[68:71], v[196:199], v[32:47]
    ds_read_b128 v[64:67], v20 offset:8192
    s_waitcnt lgkmcnt(6)
    v_mfma_f32_32x32x16_bf16 v[32:47], v[72:75], v[200:203], v[32:47]
    ds_read_b128 v[68:71], v21 offset:8192
    s_add_u32 m0, s43, 6272
    s_nop 0
    buffer_load_dwordx4 v13, s[12:15], s38 offen offset:896 lds
    s_waitcnt lgkmcnt(6)
    v_mfma_f32_32x32x16_bf16 v[32:47], v[76:79], v[204:207], v[32:47]
    ds_read_b128 v[72:75], v22 offset:8192
    s_waitcnt lgkmcnt(6)
    v_mfma_f32_32x32x16_bf16 v[32:47], v[80:83], v[208:211], v[32:47]
    ds_read_b128 v[76:79], v23 offset:8192
    s_add_u32 m0, s43, 7168
    s_nop 0
    buffer_load_dwordx4 v13, s[12:15], s38 offen offset:1024 lds
    s_waitcnt lgkmcnt(6)
    v_mfma_f32_32x32x16_bf16 v[32:47], v[84:87], v[212:215], v[32:47]
    ds_read_b128 v[80:83], v20 offset:9216
    s_waitcnt lgkmcnt(6)
    v_mfma_f32_32x32x16_bf16 v[32:47], v[88:91], v[216:219], v[32:47]
    ds_read_b128 v[84:87], v21 offset:9216
    s_waitcnt lgkmcnt(6)
    v_mfma_f32_32x32x16_bf16 v[32:47], v[92:95], v[220:223], v[32:47]
    ds_read_b128 v[88:91], v22 offset:9216
    s_add_u32 m0, s43, 8064
    s_nop 0
    buffer_load_dwordx4 v13, s[12:15], s38 offen offset:1152 lds
    s_waitcnt lgkmcnt(6)
    v_mfma_f32_32x32x16_bf16 v[32:47], v[64:67], v[224:227], v[32:47]
    ds_read_b128 v[92:95], v23 offset:9216
    s_add_u32 s42, s42, 40960
    s_cmp_eq_u32 s42, 163840
    s_cselect_b32 s42, 0, s42
    v_add_u32 v20, s42, v16
    v_add_u32 v21, s42, v17
    v_add_u32 v22, s42, v18
    v_add_u32 v23, s42, v19
    s_waitcnt vmcnt(13)
    s_barrier
    s_waitcnt lgkmcnt(6)
    v_mfma_f32_32x32x16_bf16 v[32:47], v[68:71], v[228:231], v[32:47]
    ds_read_b128 v[64:67], v20 offset:0
    s_add_u32 s43, s42, 81920
    s_cmp_ge_u32 s43, 163840
    s_cselect_b32 s33, 163840, 0
    s_sub_u32 s43, s43, s33
    s_add_u32 s43, s43, s45
    s_waitcnt lgkmcnt(6)
    v_mfma_f32_32x32x16_bf16 v[32:47], v[72:75], v[232:235], v[32:47]
    ds_read_b128 v[68:71], v21 offset:0
    s_add_u32 s38, s38, 40960
    s_add_u32 s33, s41, 3
    s_cmp_lt_u32 s33, s40
    s_cselect_b32 s38, s38, 268435456
    s_waitcnt lgkmcnt(6)
    v_mfma_f32_32x32x16_bf16 v[32:47], v[76:79], v[236:239], v[32:47]
    ds_read_b128 v[72:75], v22 offset:0
    s_mov_b32 s46, s39
    s_add_u32 s39, s39, 65536
    s_add_u32 s41, s41, 1
    s_cmp_lt_u32 s41, s40
    s_waitcnt lgkmcnt(6)
    v_mfma_f32_32x32x16_bf16 v[32:47], v[80:83], v[240:243], v[32:47]
    ds_read_b128 v[76:79], v23 offset:0
    s_waitcnt lgkmcnt(6)
    v_mfma_f32_32x32x16_bf16 v[32:47], v[84:87], v[244:247], v[32:47]
    ds_read_b128 v[80:83], v20 offset:1024
    s_waitcnt lgkmcnt(6)
    v_mfma_f32_32x32x16_bf16 v[32:47], v[88:91], v[248:251], v[32:47]
    ds_read_b128 v[84:87], v21 offset:1024
    s_waitcnt lgkmcnt(6)
    v_mfma_f32_32x32x16_bf16 v[32:47], v[92:95], v[252:255], v[32:47]
    ds_read_b128 v[88:91], v22 offset:1024
    s_nop 9
    s_cbranch_scc0 L_bv_end0
    s_waitcnt lgkmcnt(6)
    v_mfma_f32_32x32x16_bf16 v[48:63], v[64:67], v[96:99], 0
    ds_read_b128 v[92:95], v23 offset:1024
    s_max_i32 s33, s41, 2
    s_sub_u32 s33, s33, 2
    v_mov_b32 v15, s33
    s_waitcnt lgkmcnt(6)
    v_mfma_f32_32x32x16_bf16 v[48:63], v[68:71], v[100:103], v[48:63]
    ds_read_b128 v[64:67], v20 offset:2048
    v_cvt_pk_bf16_f32 v24, v32, v33
    v_cvt_pk_bf16_f32 v25, v34, v35
    v_cvt_pk_bf16_f32 v26, v40, v41
    v_cvt_pk_bf16_f32 v27, v42, v43
    s_waitcnt lgkmcnt(6)
    v_mfma_f32_32x32x16_bf16 v[48:63], v[72:75], v[104:107], v[48:63]
    ds_read_b128 v[68:71], v21 offset:2048
    v_cvt_pk_bf16_f32 v28, v36, v37
    v_cvt_pk_bf16_f32 v29, v38, v39
    v_cvt_pk_bf16_f32 v30, v44, v45
    v_cvt_pk_bf16_f32 v31, v46, v47
    s_waitcnt lgkmcnt(6)
    v_mfma_f32_32x32x16_bf16 v[48:63], v[76:79], v[108:111], v[48:63]
    ds_read_b128 v[72:75], v22 offset:2048
    v_cndmask_b32 v24, v24, v14, s[28:29]
    v_cndmask_b32 v25, v25, v14, s[28:29]
    v_cndmask_b32 v26, v26, v14, s[28:29]
    v_cndmask_b32 v27, v27, v14, s[28:29]
    s_waitcnt lgkmcnt(6)
    v_mfma_f32_32x32x16_bf16 v[48:63], v[80:83], v[112:115], v[48:63]
    ds_read_b128 v[76:79], v23 offset:2048
    v_cndmask_b32 v28, v28, v14, s[28:29]
    v_cndmask_b32 v29, v29, v14, s[28:29]
    v_cndmask_b32 v30, v30, v14, s[28:29]
    v_cndmask_b32 v31, v31, v14, s[28:29]
    s_waitcnt lgkmcnt(6)
    v_mfma_f32_32x32x16_bf16 v[48:63], v[84:87], v[116:119], v[48:63]
    ds_read_b128 v[80:83], v20 offset:3072
    buffer_store_dwordx4 v[24:27], v9, s[4:7], s46 offen offset:0 sc1
    s_waitcnt lgkmcnt(6)
    v_mfma_f32_32x32x16_bf16 v[48:63], v[88:91], v[120:123], v[48:63]
    ds_read_b128 v[84:87], v21 offset:3072
    s_waitcnt lgkmcnt(6)
    v_mfma_f32_32x32x16_bf16 v[48:63], v[92:95], v[124:127], v[48:63]
    ds_read_b128 v[88:91], v22 offset:3072
    buffer_store_dwordx4 v[28:31], v9, s[4:7], s46 offen offset:1024 sc1
    s_waitcnt lgkmcnt(6)
    v_mfma_f32_32x32x16_bf16 v[48:63], v[64:67], v[128:131], v[48:63]
    ds_read_b128 v[92:95], v23 offset:3072
    s_waitcnt lgkmcnt(6)
    v_mfma_f32_32x32x16_bf16 v[48:63], v[68:71], v[132:135], v[48:63]
    ds_read_b128 v[64:67], v20 offset:4096
    buffer_store_dword v15, off, s[4:7], s44 sc1
    s_waitcnt lgkmcnt(6)
    v_mfma_f32_32x32x16_bf16 v[48:63], v[72:75], v[136:139], v[48:63]
    ds_read_b128 v[68:71], v21 offset:4096
    s_waitcnt lgkmcnt(6)
    v_mfma_f32_32x32x16_bf16 v[48:63], v[76:79], v[140:143], v[48:63]
    ds_read_b128 v[72:75], v22 offset:4096
    s_add_u32 m0, s43, 0
    s_nop 0
    buffer_load_dwordx4 v13, s[12:15], s38 offen offset:0 lds
    s_waitcnt lgkmcnt(6)
    v_mfma_f32_32x32x16_bf16 v[48:63], v[80:83], v[144:147], v[48:63]
    ds_read_b128 v[76:79], v23 offset:4096
    s_waitcnt lgkmcnt(6)
    v_mfma_f32_32x32x16_bf16 v[48:63], v[84:87], v[148:151], v[48:63]
    ds_read_b128 v[80:83], v20 offset:5120
    s_add_u32 m0, s43, 896
    s_nop 0
    buffer_load_dwordx4 v13, s[12:15], s38 offen offset:128 lds
    s_waitcnt lgkmcnt(6)
    v_mfma_f32_32x32x16_bf16 v[48:63], v[88:91], v[152:155], v[48:63]
    ds_read_b128 v[84:87], v21 offset:5120
    s_waitcnt lgkmcnt(6)
    v_mfma_f32_32x32x16_bf16 v[48:63], v[92:95], v[156:159], v[48:63]
    ds_read_b128 v[88:91], v22 offset:5120
    s_add_u32 m0, s43, 1792
    s_nop 0
    buffer_load_dwordx4 v13, s[12:15], s38 offen offset:256 lds
    s_waitcnt lgkmcnt(6)
    v_mfma_f32_32x32x16_bf16 v[48:63], v[64:67], v[160:163], v[48:63]
    ds_read_b128 v[92:95], v23 offset:5120
    s_waitcnt lgkmcnt(6)
    v_mfma_f32_32x32x16_bf16 v[48:63], v[68:71], v[164:167], v[48:63]
    ds_read_b128 v[64:67], v20 offset:6144
    s_waitcnt lgkmcnt(6)
    v_mfma_f32_32x32x16_bf16 v[48:63], v[72:75], v[168:171], v[48:63]
    ds_read_b128 v[68:71], v21 offset:6144
    s_add_u32 m0, s43, 2688
    s_nop 0
    buffer_load_dwordx4 v13, s[12:15], s38 offen offset:384 lds
    s_waitcnt lgkmcnt(6)
    v_mfma_f32_32x32x16_bf16 v[48:63], v[76:79], v[172:175], v[48:63]
    ds_read_b128 v[72:75], v22 offset:6144
    s_waitcnt lgkmcnt(6)
    v_mfma_f32_32x32x16_bf16 v[48:63], v[80:83], v[176:179], v[48:63]
    ds_read_b128 v[76:79], v23 offset:6144
    s_add_u32 m0, s43, 3584
    s_nop 0
    buffer_load_dwordx4 v13, s[12:15], s38 offen offset:512 lds
    s_waitcnt lgkmcnt(6)
    v_mfma_f32_32x32x16_bf16 v[48:63], v[84:87], v[180:183], v[48:63]
    ds_read_b128 v[80:83], v20 offset:7168
    s_waitcnt lgkmcnt(6)
    v_mfma_f32_32x32x16_bf16 v[48:63], v[88:91], v[184:187], v[48:63]
    ds_read_b128 v[84:87], v21 offset:7168
    s_add_u32 m0, s43, 4480
    s_nop 0
    buffer_load_dwordx4 v13, s[12:15], s38 offen offset:640 lds
    s_waitcnt lgkmcnt(6)
    v_mfma_f32_32x32x16_bf16 v[48:63], v[92:95], v[188:191], v[48:63]
    ds_read_b128 v[88:91], v22 offset:7168
    s_waitcnt lgkmcnt(6)
    v_mfma_f32_32x32x16_bf16 v[48:63], v[64:67], v[192:195], v[48:63]
    ds_read_b128 v[92:95], v23 offset:7168
    s_add_u32 m0, s43, 5376
    s_nop 0
    buffer_load_dwordx4 v13, s[12:15], s38 offen offset:768 lds
    s_waitcnt lgkmcnt(6)
    v_mfma_f32_32x32x16_bf16 v[48:63], v[68:71], v[196:199], v[48:63]
    ds_read_b128 v[64:67], v20 offset:8192
    s_waitcnt lgkmcnt(6)
    v_mfma_f32_32x32x16_bf16 v[48:63], v[72:75], v[200:203], v[48:63]
    ds_read_b128 v[68:71], v21 offset:8192
    s_add_u32 m0, s43, 6272
    s_nop 0
    buffer_load_dwordx4 v13, s[12:15], s38 offen offset:896 lds
    s_waitcnt lgkmcnt(6)
    v_mfma_f32_32x32x16_bf16 v[48:63], v[76:79], v[204:207], v[48:63]
    ds_read_b128 v[72:75], v22 offset:8192
    s_waitcnt lgkmcnt(6)
    v_mfma_f32_32x32x16_bf16 v[48:63], v[80:83], v[208:211], v[48:63]
    ds_read_b128 v[76:79], v23 offset:8192
    s_add_u32 m0, s43, 7168
    s_nop 0
    buffer_load_dwordx4 v13, s[12:15], s38 offen offset:1024 lds
    s_waitcnt lgkmcnt(6)
    v_mfma_f32_32x32x16_bf16 v[48:63], v[84:87], v[212:215], v[48:63]
    ds_read_b128 v[80:83], v20 offset:9216
    s_waitcnt lgkmcnt(6)
    v_mfma_f32_32x32x16_bf16 v[48:63], v[88:91], v[216:219], v[48:63]
    ds_read_b128 v[84:87], v21 offset:9216
    s_waitcnt lgkmcnt(6)
    v_mfma_f32_32x32x16_bf16 v[48:63], v[92:95], v[220:223], v[48:63]
    ds_read_b128 v[88:91], v22 offset:9216
    s_add_u32 m0, s43, 8064
    s_nop 0
    buffer_load_dwordx4 v13, s[12:15], s38 offen offset:1152 lds
    s_waitcnt lgkmcnt(6)
    v_mfma_f32_32x32x16_bf16 v[48:63], v[64:67], v[224:227], v[48:63]
    ds_read_b128 v[92:95], v23 offset:9216
    s_add_u32 s42, s42, 40960
    s_cmp_eq_u32 s42, 163840
    s_cselect_b32 s42, 0, s42
    v_add_u32 v20, s42, v16
    v_add_u32 v21, s42, v17
    v_add_u32 v22, s42, v18
    v_add_u32 v23, s42, v19
    s_waitcnt vmcnt(13)
    s_barrier
    s_waitcnt lgkmcnt(6)
    v_mfma_f32_32x32x16_bf16 v[48:63], v[68:71], v[228:231], v[48:63]
    ds_read_b128 v[64:67], v20 offset:0
    s_add_u32 s43, s42, 81920
    s_cmp_ge_u32 s43, 163840
    s_cselect_b32 s33, 163840, 0
    s_sub_u32 s43, s43, s33
    s_add_u32 s43, s43, s45
    s_waitcnt lgkmcnt(6)
    v_mfma_f32_32x32x16_bf16 v[48:63], v[72:75], v[232:235], v[48:63]
    ds_read_b128 v[68:71], v21 offset:0
    s_add_u32 s38, s38, 40960
    s_add_u32 s33, s41, 3
    s_cmp_lt_u32 s33, s40
    s_cselect_b32 s38, s38, 268435456
    s_waitcnt lgkmcnt(6)
    v_mfma_f32_32x32x16_bf16 v[48:63], v[76:79], v[236:239], v[48:63]
    ds_read_b128 v[72:75], v22 offset:0
    s_mov_b32 s46, s39
    s_add_u32 s39, s39, 65536
    s_add_u32 s41, s41, 1
    s_cmp_lt_u32 s41, s40
    s_waitcnt lgkmcnt(6)
    v_mfma_f32_32x32x16_bf16 v[48:63], v[80:83], v[240:243], v[48:63]
    ds_read_b128 v[76:79], v23 offset:0
    s_waitcnt lgkmcnt(6)
    v_mfma_f32_32x32x16_bf16 v[48:63], v[84:87], v[244:247], v[48:63]
    ds_read_b128 v[80:83], v20 offset:1024
    s_waitcnt lgkmcnt(6)
    v_mfma_f32_32x32x16_bf16 v[48:63], v[88:91], v[248:251], v[48:63]
    ds_read_b128 v[84:87], v21 offset:1024
    s_waitcnt lgkmcnt(6)
    v_mfma_f32_32x32x16_bf16 v[48:63], v[92:95], v[252:255], v[48:63]
    ds_read_b128 v[88:91], v22 offset:1024
    s_nop 0
    s_cbranch_scc1 L_bv_top
    s_nop 9
    v_cvt_pk_bf16_f32 v24, v48, v49
    v_cvt_pk_bf16_f32 v25, v50, v51
    v_cvt_pk_bf16_f32 v26, v56, v57
    v_cvt_pk_bf16_f32 v27, v58, v59
    v_cvt_pk_bf16_f32 v28, v52, v53
    v_cvt_pk_bf16_f32 v29, v54, v55
    v_cvt_pk_bf16_f32 v30, v60, v61
    v_cvt_pk_bf16_f32 v31, v62, v63
    v_cndmask_b32 v24, v24, v14, s[28:29]
    v_cndmask_b32 v25, v25, v14, s[28:29]
    v_cndmask_b32 v26, v26, v14, s[28:29]
    v_cndmask_b32 v27, v27, v14, s[28:29]
    v_cndmask_b32 v28, v28, v14, s[28:29]
    v_cndmask_b32 v29, v29, v14, s[28:29]
    v_cndmask_b32 v30, v30, v14, s[28:29]
    v_cndmask_b32 v31, v31, v14, s[28:29]
    buffer_store_dwordx4 v[24:27], v9, s[4:7], s46 offen offset:0 sc1
    buffer_store_dwordx4 v[28:31], v9, s[4:7], s46 offen offset:1024 sc1
    s_branch L_bv_end
L_bv_end0:
    v_cvt_pk_bf16_f32 v24, v32, v33
    v_cvt_pk_bf16_f32 v25, v34, v35
    v_cvt_pk_bf16_f32 v26, v40, v41
    v_cvt_pk_bf16_f32 v27, v42, v43
    v_cvt_pk_bf16_f32 v28, v36, v37
    v_cvt_pk_bf16_f32 v29, v38, v39
    v_cvt_pk_bf16_f32 v30, v44, v45
    v_cvt_pk_bf16_f32 v31, v46, v47
    v_cndmask_b32 v24, v24, v14, s[28:29]
    v_cndmask_b32 v25, v25, v14, s[28:29]
    v_cndmask_b32 v26, v26, v14, s[28:29]
    v_cndmask_b32 v27, v27, v14, s[28:29]
    v_cndmask_b32 v28, v28, v14, s[28:29]
    v_cndmask_b32 v29, v29, v14, s[28:29]
    v_cndmask_b32 v30, v30, v14, s[28:29]
    v_cndmask_b32 v31, v31, v14, s[28:29]
    buffer_store_dwordx4 v[24:27], v9, s[4:7], s46 offen offset:0 sc1
    buffer_store_dwordx4 v[28:31], v9, s[4:7], s46 offen offset:1024 sc1
L_bv_end:
    s_waitcnt vmcnt(0) lgkmcnt(0)
    s_barrier
    v_mov_b32 v15, s40
    buffer_store_dword v15, off, s[4:7], s44 sc1
L_b1:
    s_branch L_role_b
L_abort:
    s_endpgm
L_role_p:
    s_lshr_b32 s48, s21, 5
    s_and_b32 s49, s21, 31
    s_load_dwordx4 s[52:55], s[0:1], 16
    s_load_dwordx2 s[56:57], s[0:1], 32
    s_load_dwordx2 s[12:13], s[0:1], 0
    s_mov_b32 s14, 2621440
    s_mov_b32 s15, 0x20000
    s_mov_b32 s10, 5242880
    s_mov_b32 s11, 0x20000
    s_waitcnt lgkmcnt(0)
    s_cmp_eq_u32 s48, 0
    s_cselect_b64 s[8:9], s[52:53], s[54:55]
    s_cmp_eq_u32 s48, 2
    s_cselect_b64 s[8:9], s[56:57], s[8:9]
    s_lshl_b32 s37, s49, 8
    s_lshl_b32 s33, s3, 6
    s_add_u32 s37, s37, s33
    s_mov_b32 s47, 0
    v_mbcnt_lo_u32_b32 v10, -1, 0
    v_mbcnt_hi_u32_b32 v10, -1, v10
    v_lshrrev_b32 v11, 2, v10
    v_mul_u32_u24 v11, 8192, v11
    v_and_b32 v12, 3, v10
    v_lshl_add_u32 v13, v12, 4, v11
    s_mul_i32 s45, s3, 40960
    s_waitcnt lgkmcnt(0)
    s_barrier
    s_add_u32 m0, s45, 0
    s_add_u32 s33, s37, 0
    buffer_load_dwordx4 v13, s[8:11], s33 offen lds
    s_add_u32 m0, s45, 1024
    s_add_u32 s33, s37, 131072
    buffer_load_dwordx4 v13, s[8:11], s33 offen lds
    s_add_u32 m0, s45, 2048
    s_add_u32 s33, s37, 262144
    buffer_load_dwordx4 v13, s[8:11], s33 offen lds
    s_add_u32 m0, s45, 3072
    s_add_u32 s33, s37, 393216
    buffer_load_dwordx4 v13, s[8:11], s33 offen lds
    s_add_u32 m0, s45, 4096
    s_add_u32 s33, s37, 524288
    buffer_load_dwordx4 v13, s[8:11], s33 offen lds
    s_add_u32 m0, s45, 5120
    s_add_u32 s33, s37, 655360
    buffer_load_dwordx4 v13, s[8:11], s33 offen lds
    s_add_u32 m0, s45, 6144
    s_add_u32 s33, s37, 786432
    buffer_load_dwordx4 v13, s[8:11], s33 offen lds
    s_add_u32 m0, s45, 7168
    s_add_u32 s33, s37, 917504
    buffer_load_dwordx4 v13, s[8:11], s33 offen lds
    s_add_u32 m0, s45, 8192
    s_add_u32 s33, s37, 1048576
    buffer_load_dwordx4 v13, s[8:11], s33 offen lds
    s_add_u32 m0, s45, 9216
    s_add_u32 s33, s37, 1179648
    buffer_load_dwordx4 v13, s[8:11], s33 offen lds
    s_add_u32 m0, s45, 10240
    s_add_u32 s33, s37, 1310720
    buffer_load_dwordx4 v13, s[8:11], s33 offen lds
    s_add_u32 m0, s45, 11264
    s_add_u32 s33, s37, 1441792
    buffer_load_dwordx4 v13, s[8:11], s33 offen lds
    s_add_u32 m0, s45, 12288
    s_add_u32 s33, s37, 1572864
    buffer_load_dwordx4 v13, s[8:11], s33 offen lds
    s_add_u32 m0, s45, 13312
    s_add_u32 s33, s37, 1703936
    buffer_load_dwordx4 v13, s[8:11], s33 offen lds
    s_add_u32 m0, s45, 14336
    s_add_u32 s33, s37, 1835008
    buffer_load_dwordx4 v13, s[8:11], s33 offen lds
    s_add_u32 m0, s45, 15360
    s_add_u32 s33, s37, 1966080
    buffer_load_dwordx4 v13, s[8:11], s33 offen lds
    s_add_u32 m0, s45, 16384
    s_add_u32 s33, s37, 2097152
    buffer_load_dwordx4 v13, s[8:11], s33 offen lds
    s_add_u32 m0, s45, 17408
    s_add_u32 s33, s37, 2228224
    buffer_load_dwordx4 v13, s[8:11], s33 offen lds
    s_add_u32 m0, s45, 18432
    s_add_u32 s33, s37, 2359296
    buffer_load_dwordx4 v13, s[8:11], s33 offen lds
    s_add_u32 m0, s45, 19456
    s_add_u32 s33, s37, 2490368
    buffer_load_dwordx4 v13, s[8:11], s33 offen lds
    s_add_u32 m0, s45, 20480
    s_add_u32 s33, s37, 2621440
    buffer_load_dwordx4 v13, s[8:11], s33 offen lds
    s_add_u32 m0, s45, 21504
    s_add_u32 s33, s37, 2752512
    buffer_load_dwordx4 v13, s[8:11], s33 offen lds
    s_add_u32 m0, s45, 22528
    s_add_u32 s33, s37, 2883584
    buffer_load_dwordx4 v13, s[8:11], s33 offen lds
    s_add_u32 m0, s45, 23552
    s_add_u32 s33, s37, 3014656
    buffer_load_dwordx4 v13, s[8:11], s33 offen lds
    s_add_u32 m0, s45, 24576
    s_add_u32 s33, s37, 3145728
    buffer_load_dwordx4 v13, s[8:11], s33 offen lds
    s_add_u32 m0, s45, 25600
    s_add_u32 s33, s37, 3276800
    buffer_load_dwordx4 v13, s[8:11], s33 offen lds
    s_add_u32 m0, s45, 26624
    s_add_u32 s33, s37, 3407872
    buffer_load_dwordx4 v13, s[8:11], s33 offen lds
    s_add_u32 m0, s45, 27648
    s_add_u32 s33, s37, 3538944
    buffer_load_dwordx4 v13, s[8:11], s33 offen lds
    s_add_u32 m0, s45, 28672
    s_add_u32 s33, s37, 3670016
    buffer_load_dwordx4 v13, s[8:11], s33 offen lds
    s_add_u32 m0, s45, 29696
    s_add_u32 s33, s37, 3801088
    buffer_load_dwordx4 v13, s[8:11], s33 offen lds
    s_add_u32 m0, s45, 30720
    s_add_u32 s33, s37, 3932160
    buffer_load_dwordx4 v13, s[8:11], s33 offen lds
    s_add_u32 m0, s45, 31744
    s_add_u32 s33, s37, 4063232
    buffer_load_dwordx4 v13, s[8:11], s33 offen lds
    s_add_u32 m0, s45, 32768
    s_add_u32 s33, s37, 4194304
    buffer_load_dwordx4 v13, s[8:11], s33 offen lds
    s_add_u32 m0, s45, 33792
    s_add_u32 s33, s37, 4325376
    buffer_load_dwordx4 v13, s[8:11], s33 offen lds
    s_add_u32 m0, s45, 34816
    s_add_u32 s33, s37, 4456448
    buffer_load_dwordx4 v13, s[8:11], s33 offen lds
    s_add_u32 m0, s45, 35840
    s_add_u32 s33, s37, 4587520
    buffer_load_dwordx4 v13, s[8:11], s33 offen lds
    s_add_u32 m0, s45, 36864
    s_add_u32 s33, s37, 4718592
    buffer_load_dwordx4 v13, s[8:11], s33 offen lds
    s_add_u32 m0, s45, 37888
    s_add_u32 s33, s37, 4849664
    buffer_load_dwordx4 v13, s[8:11], s33 offen lds
    s_add_u32 m0, s45, 38912
    s_add_u32 s33, s37, 4980736
    buffer_load_dwordx4 v13, s[8:11], s33 offen lds
    s_add_u32 m0, s45, 39936
    s_add_u32 s33, s37, 5111808
    buffer_load_dwordx4 v13, s[8:11], s33 offen lds
    v_lshrrev_b32 v11, 5, v10
    v_bfe_u32 v12, v10, 2, 2
    v_lshl_add_u32 v11, v11, 3, v12
    v_lshlrev_b32 v11, 6, v11
    v_bfe_u32 v12, v10, 4, 1
    v_lshl_add_u32 v11, v12, 5, v11
    v_and_b32 v12, 3, v10
    v_lshl_add_u32 v11, v12, 3, v11
    s_add_u32 s33, s45, s47
    v_add_u32 v14, s33, v11
    s_waitcnt vmcnt(39)
    ds_read_b64_tr_b16 v[96:97], v14 offset:0
    ds_read_b64_tr_b16 v[98:99], v14 offset:256
    s_waitcnt vmcnt(38)
    ds_read_b64_tr_b16 v[100:101], v14 offset:1024
    ds_read_b64_tr_b16 v[102:103], v14 offset:1280
    s_waitcnt vmcnt(37)
    ds_read_b64_tr_b16 v[104:105], v14 offset:2048
    ds_read_b64_tr_b16 v[106:107], v14 offset:2304
    s_waitcnt vmcnt(36)
    ds_read_b64_tr_b16 v[108:109], v14 offset:3072
    ds_read_b64_tr_b16 v[110:111], v14 offset:3328
    s_waitcnt vmcnt(35)
    ds_read_b64_tr_b16 v[112:113], v14 offset:4096
    ds_read_b64_tr_b16 v[114:115], v14 offset:4352
    s_waitcnt vmcnt(34)
    ds_read_b64_tr_b16 v[116:117], v14 offset:5120
    ds_read_b64_tr_b16 v[118:119], v14 offset:5376
    s_waitcnt vmcnt(33)
    ds_read_b64_tr_b16 v[120:121], v14 offset:6144
    ds_read_b64_tr_b16 v[122:123], v14 offset:6400
    s_waitcnt vmcnt(32)
    ds_read_b64_tr_b16 v[124:125], v14 offset:7168
    ds_read_b64_tr_b16 v[126:127], v14 offset:7424
    s_waitcnt vmcnt(31)
    ds_read_b64_tr_b16 v[128:129], v14 offset:8192
    ds_read_b64_tr_b16 v[130:131], v14 offset:8448
    s_waitcnt vmcnt(30)
    ds_read_b64_tr_b16 v[132:133], v14 offset:9216
    ds_read_b64_tr_b16 v[134:135], v14 offset:9472
    s_waitcnt vmcnt(29)
    ds_read_b64_tr_b16 v[136:137], v14 offset:10240
    ds_read_b64_tr_b16 v[138:139], v14 offset:10496
    s_waitcnt vmcnt(28)
    ds_read_b64_tr_b16 v[140:141], v14 offset:11264
    ds_read_b64_tr_b16 v[142:143], v14 offset:11520
    s_waitcnt vmcnt(27)
    ds_read_b64_tr_b16 v[144:145], v14 offset:12288
    ds_read_b64_tr_b16 v[146:147], v14 offset:12544
    s_waitcnt vmcnt(26)
    ds_read_b64_tr_b16 v[148:149], v14 offset:13312
    ds_read_b64_tr_b16 v[150:151], v14 offset:13568
    s_waitcnt vmcnt(25)
    ds_read_b64_tr_b16 v[152:153], v14 offset:14336
    ds_read_b64_tr_b16 v[154:155], v14 offset:14592
    s_waitcnt vmcnt(24)
    ds_read_b64_tr_b16 v[156:157], v14 offset:15360
    ds_read_b64_tr_b16 v[158:159], v14 offset:15616
    s_waitcnt vmcnt(23)
    ds_read_b64_tr_b16 v[160:161], v14 offset:16384
    ds_read_b64_tr_b16 v[162:163], v14 offset:16640
    s_waitcnt vmcnt(22)
    ds_read_b64_tr_b16 v[164:165], v14 offset:17408
    ds_read_b64_tr_b16 v[166:167], v14 offset:17664
    s_waitcnt vmcnt(21)
    ds_read_b64_tr_b16 v[168:169], v14 offset:18432
    ds_read_b64_tr_b16 v[170:171], v14 offset:18688
    s_waitcnt vmcnt(20)
    ds_read_b64_tr_b16 v[172:173], v14 offset:19456
    ds_read_b64_tr_b16 v[174:175], v14 offset:19712
    s_waitcnt vmcnt(19)
    ds_read_b64_tr_b16 v[176:177], v14 offset:20480
    ds_read_b64_tr_b16 v[178:179], v14 offset:20736
    s_waitcnt vmcnt(18)
    ds_read_b64_tr_b16 v[180:181], v14 offset:21504
    ds_read_b64_tr_b16 v[182:183], v14 offset:21760
    s_waitcnt vmcnt(17)
    ds_read_b64_tr_b16 v[184:185], v14 offset:22528
    ds_read_b64_tr_b16 v[186:187], v14 offset:22784
    s_waitcnt vmcnt(16)
    ds_read_b64_tr_b16 v[188:189], v14 offset:23552
    ds_read_b64_tr_b16 v[190:191], v14 offset:23808
    s_waitcnt vmcnt(15)
    ds_read_b64_tr_b16 v[192:193], v14 offset:24576
    ds_read_b64_tr_b16 v[194:195], v14 offset:24832
    s_waitcnt vmcnt(14)
    ds_read_b64_tr_b16 v[196:197], v14 offset:25600
    ds_read_b64_tr_b16 v[198:199], v14 offset:25856
    s_waitcnt vmcnt(13)
    ds_read_b64_tr_b16 v[200:201], v14 offset:26624
    ds_read_b64_tr_b16 v[202:203], v14 offset:26880
    s_waitcnt vmcnt(12)
    ds_read_b64_tr_b16 v[204:205], v14 offset:27648
    ds_read_b64_tr_b16 v[206:207], v14 offset:27904
    s_waitcnt vmcnt(11)
    ds_read_b64_tr_b16 v[208:209], v14 offset:28672
    ds_read_b64_tr_b16 v[210:211], v14 offset:28928
    s_waitcnt vmcnt(10)
    ds_read_b64_tr_b16 v[212:213], v14 offset:29696
    ds_read_b64_tr_b16 v[214:215], v14 offset:29952
    s_waitcnt vmcnt(9)
    ds_read_b64_tr_b16 v[216:217], v14 offset:30720
    ds_read_b64_tr_b16 v[218:219], v14 offset:30976
    s_waitcnt vmcnt(8)
    ds_read_b64_tr_b16 v[220:221], v14 offset:31744
    ds_read_b64_tr_b16 v[222:223], v14 offset:32000
    s_waitcnt vmcnt(7)
    ds_read_b64_tr_b16 v[224:225], v14 offset:32768
    ds_read_b64_tr_b16 v[226:227], v14 offset:33024
    s_waitcnt vmcnt(6)
    ds_read_b64_tr_b16 v[228:229], v14 offset:33792
    ds_read_b64_tr_b16 v[230:231], v14 offset:34048
    s_waitcnt vmcnt(5)
    ds_read_b64_tr_b16 v[232:233], v14 offset:34816
    ds_read_b64_tr_b16 v[234:235], v14 offset:35072
    s_waitcnt vmcnt(4)
    ds_read_b64_tr_b16 v[236:237], v14 offset:35840
    ds_read_b64_tr_b16 v[238:239], v14 offset:36096
    s_waitcnt vmcnt(3)
    ds_read_b64_tr_b16 v[240:241], v14 offset:36864
    ds_read_b64_tr_b16 v[242:243], v14 offset:37120
    s_waitcnt vmcnt(2)
    ds_read_b64_tr_b16 v[244:245], v14 offset:37888
    ds_read_b64_tr_b16 v[246:247], v14 offset:38144
    s_waitcnt vmcnt(1)
    ds_read_b64_tr_b16 v[248:249], v14 offset:38912
    ds_read_b64_tr_b16 v[250:251], v14 offset:39168
    s_waitcnt vmcnt(0)
    ds_read_b64_tr_b16 v[252:253], v14 offset:39936
    ds_read_b64_tr_b16 v[254:255], v14 offset:40192
    s_waitcnt lgkmcnt(0)
    s_barrier
    v_mbcnt_lo_u32_b32 v10, -1, 0
    v_mbcnt_hi_u32_b32 v10, -1, v10
    v_lshlrev_b32 v10, 7, v10
    s_lshl_b32 s33, s30, 2
    s_add_u32 s33, s33, s3
    s_lshl_b32 s33, s33, 13
    s_lshl_b32 s34, s31, 15
    buffer_load_dword v11, v10, s[12:15], s33 offen
    s_add_u32 s33, s33, s34
    buffer_load_dword v11, v10, s[12:15], s33 offen
    s_add_u32 s33, s33, s34
    buffer_load_dword v11, v10, s[12:15], s33 offen
    s_add_u32 s33, s33, s34
    s_waitcnt vmcnt(0)
    s_mov_b32 s34, 0
    s_cmp_lg_u32 s22, 0
    s_cbranch_scc1 L_cd_10
    s_mov_b32 s32, 262144
    v_mbcnt_lo_u32_b32 v15, -1, 0
    v_mbcnt_hi_u32_b32 v15, -1, v15
    v_lshlrev_b32 v15, 2, v15
L_c_11:
    s_sleep 4
    buffer_load_dword v14, v15, s[16:19], 0 offen sc1
    s_sub_u32 s32, s32, 1
    s_cbranch_scc1 L_abort
    s_waitcnt vmcnt(0)
L_c_11_l:
    v_cmp_lt_u32 vcc, 32, v14
    v_readlane_b32 s36, v14, 48
    v_readlane_b32 s34, v14, 50
    s_and_b32 s33, vcc_lo, 0x10001
    s_and_b32 s35, vcc_hi, 0x3f
    s_or_b32 s33, s33, s35
    s_cbranch_scc1 L_recheck
    v_cmp_ne_u32 vcc, 32, v14
    s_nop 0
    s_and_b32 s33, vcc_lo, 0x10001
    s_and_b32 s35, vcc_hi, 0x3f
    s_or_b32 s33, s33, s35
    s_cbranch_scc1 L_c_11
    s_cmp_lt_u32 s36, 192
    s_cbranch_scc1 L_c_11
L_cd_10:
    s_mul_i32 s39, s48, 8192
    s_mul_i32 s33, s49, 24576
    s_add_u32 s39, s39, s33
    s_lshl_b32 s33, s3, 11
    s_add_u32 s39, s39, s33
    s_add_u32 s39, s39, 16777216
    s_lshl_b32 s44, s49, 7
    s_mul_i32 s33, s48, 4224
    s_add_u32 s44, s44, s33
    s_add_u32 s44, s44, 69206016
    s_cmp_eq_u32 s3, 0
    s_cselect_b32 s44, s44, 268435456
    s_mov_b32 s38, 0
    s_mov_b32 s40, 64
    v_mbcnt_lo_u32_b32 v10, -1, 0
    v_mbcnt_hi_u32_b32 v10, -1, v10
    v_bfe_u32 v11, v10, 4, 1
    v_lshlrev_b32 v11, 10, v11
    v_lshrrev_b32 v12, 5, v10
    v_lshl_add_u32 v11, v12, 8, v11
    v_and_b32 v12, 15, v10
    v_lshl_add_u32 v9, v12, 4, v11
    s_cmp_eq_u32 s48, 2
    s_cbranch_scc1 L_pv
    s_cmp_eq_u32 s48, 1
    s_cselect_b32 s50, 0x3e0293ee, 1.0
    v_mbcnt_lo_u32_b32 v10, -1, 0
    v_mbcnt_hi_u32_b32 v10, -1, v10
    v_lshrrev_b32 v11, 3, v10
    s_lshl_b32 s33, s3, 3
    v_add_u32 v11, s33, v11
    v_lshrrev_b32 v12, 1, v11
    v_xor_b32 v12, v12, v10
    v_and_b32 v12, 7, v12
    v_mul_u32_u24 v11, 1280, v11
    v_lshl_add_u32 v13, v12, 4, v11
    v_bfe_u32 v11, v10, 3, 2
    v_mul_u32_u24 v11, 10240, v11
    v_and_b32 v12, 7, v10
    v_lshl_add_u32 v11, v12, 7, v11
    v_bfe_u32 v12, v10, 1, 3
    v_lshrrev_b32 v15, 5, v10
    v_xor_b32 v12, v12, v15
    v_xor_b32 v15, 0, v12
    v_lshl_add_u32 v16, v15, 4, v11
    v_mov_b32 v20, v16
    v_xor_b32 v15, 2, v12
    v_lshl_add_u32 v17, v15, 4, v11
    v_mov_b32 v21, v17
    v_xor_b32 v15, 4, v12
    v_lshl_add_u32 v18, v15, 4, v11
    v_mov_b32 v22, v18
    v_xor_b32 v15, 6, v12
    v_lshl_add_u32 v19, v15, 4, v11
    v_mov_b32 v23, v19
    s_mul_i32 s45, s3, 10240
    s_add_u32 s43, s45, 0
    s_add_u32 m0, s43, 0
    s_nop 0
    buffer_load_dwordx4 v13, s[12:15], s38 offen offset:0 lds
    s_add_u32 m0, s43, 896
    s_nop 0
    buffer_load_dwordx4 v13, s[12:15], s38 offen offset:128 lds
    s_add_u32 m0, s43, 1792
    s_nop 0
    buffer_load_dwordx4 v13, s[12:15], s38 offen offset:256 lds
    s_add_u32 m0, s43, 2688
    s_nop 0
    buffer_load_dwordx4 v13, s[12:15], s38 offen offset:384 lds
    s_add_u32 m0, s43, 3584
    s_nop 0
    buffer_load_dwordx4 v13, s[12:15], s38 offen offset:512 lds
    s_add_u32 m0, s43, 4480
    s_nop 0
    buffer_load_dwordx4 v13, s[12:15], s38 offen offset:640 lds
    s_add_u32 m0, s43, 5376
    s_nop 0
    buffer_load_dwordx4 v13, s[12:15], s38 offen offset:768 lds
    s_add_u32 m0, s43, 6272
    s_nop 0
    buffer_load_dwordx4 v13, s[12:15], s38 offen offset:896 lds
    s_add_u32 m0, s43, 7168
    s_nop 0
    buffer_load_dwordx4 v13, s[12:15], s38 offen offset:1024 lds
    s_add_u32 m0, s43, 8064
    s_nop 0
    buffer_load_dwordx4 v13, s[12:15], s38 offen offset:1152 lds
    s_add_u32 s38, s38, 40960
    s_cmp_lt_u32 1, s40
    s_cselect_b32 s38, s38, 268435456
    s_add_u32 s43, s45, 40960
    s_add_u32 m0, s43, 0
    s_nop 0
    buffer_load_dwordx4 v13, s[12:15], s38 offen offset:0 lds
    s_add_u32 m0, s43, 896
    s_nop 0
    buffer_load_dwordx4 v13, s[12:15], s38 offen offset:128 lds
    s_add_u32 m0, s43, 1792
    s_nop 0
    buffer_load_dwordx4 v13, s[12:15], s38 offen offset:256 lds
    s_add_u32 m0, s43, 2688
    s_nop 0
    buffer_load_dwordx4 v13, s[12:15], s38 offen offset:384 lds
    s_add_u32 m0, s43, 3584
    s_nop 0
    buffer_load_dwordx4 v13, s[12:15], s38 offen offset:512 lds
    s_add_u32 m0, s43, 4480
    s_nop 0
    buffer_load_dwordx4 v13, s[12:15], s38 offen offset:640 lds
    s_add_u32 m0, s43, 5376
    s_nop 0
    buffer_load_dwordx4 v13, s[12:15], s38 offen offset:768 lds
    s_add_u32 m0, s43, 6272
    s_nop 0
    buffer_load_dwordx4 v13, s[12:15], s38 offen offset:896 lds
    s_add_u32 m0, s43, 7168
    s_nop 0
    buffer_load_dwordx4 v13, s[12:15], s38 offen offset:1024 lds
    s_add_u32 m0, s43, 8064
    s_nop 0
    buffer_load_dwordx4 v13, s[12:15], s38 offen offset:1152 lds
    s_add_u32 s38, s38, 40960
    s_cmp_lt_u32 2, s40
    s_cselect_b32 s38, s38, 268435456
    s_add_u32 s43, s45, 81920
    s_mov_b32 s41, 0
    s_mov_b32 s42, 0
    s_mov_b32 s46, 268435456
    s_waitcnt vmcnt(10)
    s_barrier
    ds_read_b128 v[64:67], v20 offset:0
    ds_read_b128 v[68:71], v21 offset:0
    ds_read_b128 v[72:75], v22 offset:0
    ds_read_b128 v[76:79], v23 offset:0
    ds_read_b128 v[80:83], v20 offset:1024
    ds_read_b128 v[84:87], v21 offset:1024
    ds_read_b128 v[88:91], v22 offset:1024
L_pqk_top:
    s_waitcnt lgkmcnt(6)
    v_mfma_f32_32x32x16_bf16 v[32:47], v[96:99], v[64:67], 0
    ds_read_b128 v[92:95], v23 offset:1024
    s_max_i32 s33, s41, 2
    s_sub_u32 s33, s33, 2
    v_mov_b32 v15, s33
    s_waitcnt lgkmcnt(6)
    v_mfma_f32_32x32x16_bf16 v[32:47], v[100:103], v[68:71], v[32:47]
    ds_read_b128 v[64:67], v20 offset:2048
    v_mul_f32 v48, s50, v48
    v_mul_f32 v49, s50, v49
    v_mul_f32 v50, s50, v50
    v_mul_f32 v51, s50, v51
    s_waitcnt lgkmcnt(6)
    v_mfma_f32_32x32x16_bf16 v[32:47], v[104:107], v[72:75], v[32:47]
    ds_read_b128 v[68:71], v21 offset:2048
    v_mul_f32 v52, s50, v52
    v_mul_f32 v53, s50, v53
    v_mul_f32 v54, s50, v54
    v_mul_f32 v55, s50, v55
    s_waitcnt lgkmcnt(6)
    v_mfma_f32_32x32x16_bf16 v[32:47], v[108:111], v[76:79], v[32:47]
    ds_read_b128 v[72:75], v22 offset:2048
    v_mul_f32 v56, s50, v56
    v_mul_f32 v57, s50, v57
    v_mul_f32 v58, s50, v58
    v_mul_f32 v59, s50, v59
    s_waitcnt lgkmcnt(6)
    v_mfma_f32_32x32x16_bf16 v[32:47], v[112:115], v[80:83], v[32:47]
    ds_read_b128 v[76:79], v23 offset:2048
    v_mul_f32 v60, s50, v60
    v_mul_f32 v61, s50, v61
    v_mul_f32 v62, s50, v62
    v_mul_f32 v63, s50, v63
    s_waitcnt lgkmcnt(6)
    v_mfma_f32_32x32x16_bf16 v[32:47], v[116:119], v[84:87], v[32:47]
    ds_read_b128 v[80:83], v20 offset:3072
    v_cvt_pk_bf16_f32 v24, v48, v49
    v_cvt_pk_bf16_f32 v25, v50, v51
    v_cvt_pk_bf16_f32 v26, v56, v57
    v_cvt_pk_bf16_f32 v27, v58, v59
    s_waitcnt lgkmcnt(6)
    v_mfma_f32_32x32x16_bf16 v[32:47], v[120:123], v[88:91], v[32:47]
    ds_read_b128 v[84:87], v21 offset:3072
    v_cvt_pk_bf16_f32 v28, v52, v53
    v_cvt_pk_bf16_f32 v29, v54, v55
    v_cvt_pk_bf16_f32 v30, v60, v61
    v_cvt_pk_bf16_f32 v31, v62, v63
    s_waitcnt lgkmcnt(6)
    v_mfma_f32_32x32x16_bf16 v[32:47], v[124:127], v[92:95], v[32:47]
    ds_read_b128 v[88:91], v22 offset:3072
    buffer_store_dwordx4 v[24:27], v9, s[4:7], s46 offen offset:0 sc1
    s_waitcnt lgkmcnt(6)
    v_mfma_f32_32x32x16_bf16 v[32:47], v[128:131], v[64:67], v[32:47]
    ds_read_b128 v[92:95], v23 offset:3072
    s_waitcnt lgkmcnt(6)
    v_mfma_f32_32x32x16_bf16 v[32:47], v[132:135], v[68:71], v[32:47]
    ds_read_b128 v[64:67], v20 offset:4096
    buffer_store_dwordx4 v[28:31], v9, s[4:7], s46 offen offset:512 sc1
    s_waitcnt lgkmcnt(6)
    v_mfma_f32_32x32x16_bf16 v[32:47], v[136:139], v[72:75], v[32:47]
    ds_read_b128 v[68:71], v21 offset:4096
    s_waitcnt lgkmcnt(6)
    v_mfma_f32_32x32x16_bf16 v[32:47], v[140:143], v[76:79], v[32:47]
    ds_read_b128 v[72:75], v22 offset:4096
    buffer_store_dword v15, off, s[4:7], s44 sc1
    s_waitcnt lgkmcnt(6)
    v_mfma_f32_32x32x16_bf16 v[32:47], v[144:147], v[80:83], v[32:47]
    ds_read_b128 v[76:79], v23 offset:4096
    s_waitcnt lgkmcnt(6)
    v_mfma_f32_32x32x16_bf16 v[32:47], v[148:151], v[84:87], v[32:47]
    ds_read_b128 v[80:83], v20 offset:5120
    s_add_u32 m0, s43, 0
    s_nop 0
    buffer_load_dwordx4 v13, s[12:15], s38 offen offset:0 lds
    s_waitcnt lgkmcnt(6)
    v_mfma_f32_32x32x16_bf16 v[32:47], v[152:155], v[88:91], v[32:47]
    ds_read_b128 v[84:87], v21 offset:5120
    s_waitcnt lgkmcnt(6)
    v_mfma_f32_32x32x16_bf16 v[32:47], v[156:159], v[92:95], v[32:47]
    ds_read_b128 v[88:91], v22 offset:5120
    s_add_u32 m0, s43, 896
    s_nop 0
    buffer_load_dwordx4 v13, s[12:15], s38 offen offset:128 lds
    s_waitcnt lgkmcnt(6)
    v_mfma_f32_32x32x16_bf16 v[32:47], v[160:163], v[64:67], v[32:47]
    ds_read_b128 v[92:95], v23 offset:5120
    s_waitcnt lgkmcnt(6)
    v_mfma_f32_32x32x16_bf16 v[32:47], v[164:167], v[68:71], v[32:47]
    ds_read_b128 v[64:67], v20 offset:6144
    s_add_u32 m0, s43, 1792
    s_nop 0
    buffer_load_dwordx4 v13, s[12:15], s38 offen offset:256 lds
    s_waitcnt lgkmcnt(6)
    v_mfma_f32_32x32x16_bf16 v[32:47], v[168:171], v[72:75], v[32:47]
    ds_read_b128 v[68:71], v21 offset:6144
    s_waitcnt lgkmcnt(6)
    v_mfma_f32_32x32x16_bf16 v[32:47], v[172:175], v[76:79], v[32:47]
    ds_read_b128 v[72:75], v22 offset:6144
    s_add_u32 m0, s43, 2688
    s_nop 0
    buffer_load_dwordx4 v13, s[12:15], s38 offen offset:384 lds
    s_waitcnt lgkmcnt(6)
    v_mfma_f32_32x32x16_bf16 v[32:47], v[176:179], v[80:83], v[32:47]
    ds_read_b128 v[76:79], v23 offset:6144
    s_waitcnt lgkmcnt(6)
    v_mfma_f32_32x32x16_bf16 v[32:47], v[180:183], v[84:87], v[32:47]
    ds_read_b128 v[80:83], v20 offset:7168
    s_add_u32 m0, s43, 3584
    s_nop 0
    buffer_load_dwordx4 v13, s[12:15], s38 offen offset:512 lds
    s_waitcnt lgkmcnt(6)
    v_mfma_f32_32x32x16_bf16 v[32:47], v[184:187], v[88:91], v[32:47]
    ds_read_b128 v[84:87], v21 offset:7168
    s_waitcnt lgkmcnt(6)
    v_mfma_f32_32x32x16_bf16 v[32:47], v[188:191], v[92:95], v[32:47]
    ds_read_b128 v[88:91], v22 offset:7168
    s_add_u32 m0, s43, 4480
    s_nop 0
    buffer_load_dwordx4 v13, s[12:15], s38 offen offset:640 lds
    s_waitcnt lgkmcnt(6)
    v_mfma_f32_32x32x16_bf16 v[32:47], v[192:195], v[64:67], v[32:47]
    ds_read_b128 v[92:95], v23 offset:7168
    s_waitcnt lgkmcnt(6)
    v_mfma_f32_32x32x16_bf16 v[32:47], v[196:199], v[68:71], v[32:47]
    ds_read_b128 v[64:67], v20 offset:8192
    s_add_u32 m0, s43, 5376
    s_nop 0
    buffer_load_dwordx4 v13, s[12:15], s38 offen offset:768 lds
    s_waitcnt lgkmcnt(6)
    v_mfma_f32_32x32x16_bf16 v[32:47], v[200:203], v[72:75], v[32:47]
    ds_read_b128 v[68:71], v21 offset:8192
    s_waitcnt lgkmcnt(6)
    v_mfma_f32_32x32x16_bf16 v[32:47], v[204:207], v[76:79], v[32:47]
    ds_read_b128 v[72:75], v22 offset:8192
    s_add_u32 m0, s43, 6272
    s_nop 0
    buffer_load_dwordx4 v13, s[12:15], s38 offen offset:896 lds
    s_waitcnt lgkmcnt(6)
    v_mfma_f32_32x32x16_bf16 v[32:47], v[208:211], v[80:83], v[32:47]
    ds_read_b128 v[76:79], v23 offset:8192
    s_waitcnt lgkmcnt(6)
    v_mfma_f32_32x32x16_bf16 v[32:47], v[212:215], v[84:87], v[32:47]
    ds_read_b128 v[80:83], v20 offset:9216
    s_add_u32 m0, s43, 7168
    s_nop 0
    buffer_load_dwordx4 v13, s[12:15], s38 offen offset:1024 lds
    s_waitcnt lgkmcnt(6)
    v_mfma_f32_32x32x16_bf16 v[32:47], v[216:219], v[88:91], v[32:47]
    ds_read_b128 v[84:87], v21 offset:9216
    s_waitcnt lgkmcnt(6)
    v_mfma_f32_32x32x16_bf16 v[32:47], v[220:223], v[92:95], v[32:47]
    ds_read_b128 v[88:91], v22 offset:9216
    s_add_u32 m0, s43, 8064
    s_nop 0
    buffer_load_dwordx4 v13, s[12:15], s38 offen offset:1152 lds
    s_waitcnt lgkmcnt(6)
    v_mfma_f32_32x32x16_bf16 v[32:47], v[224:227], v[64:67], v[32:47]
    ds_read_b128 v[92:95], v23 offset:9216
    s_add_u32 s42, s42, 40960
    s_cmp_eq_u32 s42, 163840
    s_cselect_b32 s42, 0, s42
    v_add_u32 v20, s42, v16
    v_add_u32 v21, s42, v17
    v_add_u32 v22, s42, v18
    v_add_u32 v23, s42, v19
    s_waitcnt vmcnt(13)
    s_barrier
    s_waitcnt lgkmcnt(6)
    v_mfma_f32_32x32x16_bf16 v[32:47], v[228:231], v[68:71], v[32:47]
    ds_read_b128 v[64:67], v20 offset:0
    s_add_u32 s43, s42, 81920
    s_cmp_ge_u32 s43, 163840
    s_cselect_b32 s33, 163840, 0
    s_sub_u32 s43, s43, s33
    s_add_u32 s43, s43, s45
    s_waitcnt lgkmcnt(6)
    v_mfma_f32_32x32x16_bf16 v[32:47], v[232:235], v[72:75], v[32:47]
    ds_read_b128 v[68:71], v21 offset:0
    s_add_u32 s38, s38, 40960
    s_add_u32 s33, s41, 3
    s_cmp_lt_u32 s33, s40
    s_cselect_b32 s38, s38, 268435456
    s_waitcnt lgkmcnt(6)
    v_mfma_f32_32x32x16_bf16 v[32:47], v[236:239], v[76:79], v[32:47]
    ds_read_b128 v[72:75], v22 offset:0
    s_mov_b32 s46, s39
    s_add_u32 s39, s39, 786432
    s_add_u32 s41, s41, 1
    s_cmp_lt_u32 s41, s40
    s_waitcnt lgkmcnt(6)
    v_mfma_f32_32x32x16_bf16 v[32:47], v[240:243], v[80:83], v[32:47]
    ds_read_b128 v[76:79], v23 offset:0
    s_waitcnt lgkmcnt(6)
    v_mfma_f32_32x32x16_bf16 v[32:47], v[244:247], v[84:87], v[32:47]
    ds_read_b128 v[80:83], v20 offset:1024
    s_waitcnt lgkmcnt(6)
    v_mfma_f32_32x32x16_bf16 v[32:47], v[248:251], v[88:91], v[32:47]
    ds_read_b128 v[84:87], v21 offset:1024
    s_waitcnt lgkmcnt(6)
    v_mfma_f32_32x32x16_bf16 v[32:47], v[252:255], v[92:95], v[32:47]
    ds_read_b128 v[88:91], v22 offset:1024
    s_nop 9
    s_cbranch_scc0 L_pqk_end0
    s_waitcnt lgkmcnt(6)
    v_mfma_f32_32x32x16_bf16 v[48:63], v[96:99], v[64:67], 0
    ds_read_b128 v[92:95], v23 offset:1024
    s_max_i32 s33, s41, 2
    s_sub_u32 s33, s33, 2
    v_mov_b32 v15, s33
    s_waitcnt lgkmcnt(6)
    v_mfma_f32_32x32x16_bf16 v[48:63], v[100:103], v[68:71], v[48:63]
    ds_read_b128 v[64:67], v20 offset:2048
    v_mul_f32 v32, s50, v32
    v_mul_f32 v33, s50, v33
    v_mul_f32 v34, s50, v34
    v_mul_f32 v35, s50, v35
    s_waitcnt lgkmcnt(6)
    v_mfma_f32_32x32x16_bf16 v[48:63], v[104:107], v[72:75], v[48:63]
    ds_read_b128 v[68:71], v21 offset:2048
    v_mul_f32 v36, s50, v36
    v_mul_f32 v37, s50, v37
    v_mul_f32 v38, s50, v38
    v_mul_f32 v39, s50, v39
    s_waitcnt lgkmcnt(6)
    v_mfma_f32_32x32x16_bf16 v[48:63], v[108:111], v[76:79], v[48:63]
    ds_read_b128 v[72:75], v22 offset:2048
    v_mul_f32 v40, s50, v40
    v_mul_f32 v41, s50, v41
    v_mul_f32 v42, s50, v42
    v_mul_f32 v43, s50, v43
    s_waitcnt lgkmcnt(6)
    v_mfma_f32_32x32x16_bf16 v[48:63], v[112:115], v[80:83], v[48:63]
    ds_read_b128 v[76:79], v23 offset:2048
    v_mul_f32 v44, s50, v44
    v_mul_f32 v45, s50, v45
    v_mul_f32 v46, s50, v46
    v_mul_f32 v47, s50, v47
    s_waitcnt lgkmcnt(6)
    v_mfma_f32_32x32x16_bf16 v[48:63], v[116:119], v[84:87], v[48:63]
    ds_read_b128 v[80:83], v20 offset:3072
    v_cvt_pk_bf16_f32 v24, v32, v33
    v_cvt_pk_bf16_f32 v25, v34, v35
    v_cvt_pk_bf16_f32 v26, v40, v41
    v_cvt_pk_bf16_f32 v27, v42, v43
    s_waitcnt lgkmcnt(6)
    v_mfma_f32_32x32x16_bf16 v[48:63], v[120:123], v[88:91], v[48:63]
    ds_read_b128 v[84:87], v21 offset:3072
    v_cvt_pk_bf16_f32 v28, v36, v37
    v_cvt_pk_bf16_f32 v29, v38, v39
    v_cvt_pk_bf16_f32 v30, v44, v45
    v_cvt_pk_bf16_f32 v31, v46, v47
    s_waitcnt lgkmcnt(6)
    v_mfma_f32_32x32x16_bf16 v[48:63], v[124:127], v[92:95], v[48:63]
    ds_read_b128 v[88:91], v22 offset:3072
    buffer_store_dwordx4 v[24:27], v9, s[4:7], s46 offen offset:0 sc1
    s_waitcnt lgkmcnt(6)
    v_mfma_f32_32x32x16_bf16 v[48:63], v[128:131], v[64:67], v[48:63]
    ds_read_b128 v[92:95], v23 offset:3072
    s_waitcnt lgkmcnt(6)
    v_mfma_f32_32x32x16_bf16 v[48:63], v[132:135], v[68:71], v[48:63]
    ds_read_b128 v[64:67], v20 offset:4096
    buffer_store_dwordx4 v[28:31], v9, s[4:7], s46 offen offset:512 sc1
    s_waitcnt lgkmcnt(6)
    v_mfma_f32_32x32x16_bf16 v[48:63], v[136:139], v[72:75], v[48:63]
    ds_read_b128 v[68:71], v21 offset:4096
    s_waitcnt lgkmcnt(6)
    v_mfma_f32_32x32x16_bf16 v[48:63], v[140:143], v[76:79], v[48:63]
    ds_read_b128 v[72:75], v22 offset:4096
    buffer_store_dword v15, off, s[4:7], s44 sc1
    s_waitcnt lgkmcnt(6)
    v_mfma_f32_32x32x16_bf16 v[48:63], v[144:147], v[80:83], v[48:63]
    ds_read_b128 v[76:79], v23 offset:4096
    s_waitcnt lgkmcnt(6)
    v_mfma_f32_32x32x16_bf16 v[48:63], v[148:151], v[84:87], v[48:63]
    ds_read_b128 v[80:83], v20 offset:5120
    s_add_u32 m0, s43, 0
    s_nop 0
    buffer_load_dwordx4 v13, s[12:15], s38 offen offset:0 lds
    s_waitcnt lgkmcnt(6)
    v_mfma_f32_32x32x16_bf16 v[48:63], v[152:155], v[88:91], v[48:63]
    ds_read_b128 v[84:87], v21 offset:5120
    s_waitcnt lgkmcnt(6)
    v_mfma_f32_32x32x16_bf16 v[48:63], v[156:159], v[92:95], v[48:63]
    ds_read_b128 v[88:91], v22 offset:5120
    s_add_u32 m0, s43, 896
    s_nop 0
    buffer_load_dwordx4 v13, s[12:15], s38 offen offset:128 lds
    s_waitcnt lgkmcnt(6)
    v_mfma_f32_32x32x16_bf16 v[48:63], v[160:163], v[64:67], v[48:63]
    ds_read_b128 v[92:95], v23 offset:5120
    s_waitcnt lgkmcnt(6)
    v_mfma_f32_32x32x16_bf16 v[48:63], v[164:167], v[68:71], v[48:63]
    ds_read_b128 v[64:67], v20 offset:6144
    s_add_u32 m0, s43, 1792
    s_nop 0
    buffer_load_dwordx4 v13, s[12:15], s38 offen offset:256 lds
    s_waitcnt lgkmcnt(6)
    v_mfma_f32_32x32x16_bf16 v[48:63], v[168:171], v[72:75], v[48:63]
    ds_read_b128 v[68:71], v21 offset:6144
    s_waitcnt lgkmcnt(6)
    v_mfma_f32_32x32x16_bf16 v[48:63], v[172:175], v[76:79], v[48:63]
    ds_read_b128 v[72:75], v22 offset:6144
    s_add_u32 m0, s43, 2688
    s_nop 0
    buffer_load_dwordx4 v13, s[12:15], s38 offen offset:384 lds
    s_waitcnt lgkmcnt(6)
    v_mfma_f32_32x32x16_bf16 v[48:63], v[176:179], v[80:83], v[48:63]
    ds_read_b128 v[76:79], v23 offset:6144
    s_waitcnt lgkmcnt(6)
    v_mfma_f32_32x32x16_bf16 v[48:63], v[180:183], v[84:87], v[48:63]
    ds_read_b128 v[80:83], v20 offset:7168
    s_add_u32 m0, s43, 3584
    s_nop 0
    buffer_load_dwordx4 v13, s[12:15], s38 offen offset:512 lds
    s_waitcnt lgkmcnt(6)
    v_mfma_f32_32x32x16_bf16 v[48:63], v[184:187], v[88:91], v[48:63]
    ds_read_b128 v[84:87], v21 offset:7168
    s_waitcnt lgkmcnt(6)
    v_mfma_f32_32x32x16_bf16 v[48:63], v[188:191], v[92:95], v[48:63]
    ds_read_b128 v[88:91], v22 offset:7168
    s_add_u32 m0, s43, 4480
    s_nop 0
    buffer_load_dwordx4 v13, s[12:15], s38 offen offset:640 lds
    s_waitcnt lgkmcnt(6)
    v_mfma_f32_32x32x16_bf16 v[48:63], v[192:195], v[64:67], v[48:63]
    ds_read_b128 v[92:95], v23 offset:7168
    s_waitcnt lgkmcnt(6)
    v_mfma_f32_32x32x16_bf16 v[48:63], v[196:199], v[68:71], v[48:63]
    ds_read_b128 v[64:67], v20 offset:8192
    s_add_u32 m0, s43, 5376
    s_nop 0
    buffer_load_dwordx4 v13, s[12:15], s38 offen offset:768 lds
    s_waitcnt lgkmcnt(6)
    v_mfma_f32_32x32x16_bf16 v[48:63], v[200:203], v[72:75], v[48:63]
    ds_read_b128 v[68:71], v21 offset:8192
    s_waitcnt lgkmcnt(6)
    v_mfma_f32_32x32x16_bf16 v[48:63], v[204:207], v[76:79], v[48:63]
    ds_read_b128 v[72:75], v22 offset:8192
    s_add_u32 m0, s43, 6272
    s_nop 0
    buffer_load_dwordx4 v13, s[12:15], s38 offen offset:896 lds
    s_waitcnt lgkmcnt(6)
    v_mfma_f32_32x32x16_bf16 v[48:63], v[208:211], v[80:83], v[48:63]
    ds_read_b128 v[76:79], v23 offset:8192
    s_waitcnt lgkmcnt(6)
    v_mfma_f32_32x32x16_bf16 v[48:63], v[212:215], v[84:87], v[48:63]
    ds_read_b128 v[80:83], v20 offset:9216
    s_add_u32 m0, s43, 7168
    s_nop 0
    buffer_load_dwordx4 v13, s[12:15], s38 offen offset:1024 lds
    s_waitcnt lgkmcnt(6)
    v_mfma_f32_32x32x16_bf16 v[48:63], v[216:219], v[88:91], v[48:63]
    ds_read_b128 v[84:87], v21 offset:9216
    s_waitcnt lgkmcnt(6)
    v_mfma_f32_32x32x16_bf16 v[48:63], v[220:223], v[92:95], v[48:63]
    ds_read_b128 v[88:91], v22 offset:9216
    s_add_u32 m0, s43, 8064
    s_nop 0
    buffer_load_dwordx4 v13, s[12:15], s38 offen offset:1152 lds
    s_waitcnt lgkmcnt(6)
    v_mfma_f32_32x32x16_bf16 v[48:63], v[224:227], v[64:67], v[48:63]
    ds_read_b128 v[92:95], v23 offset:9216
    s_add_u32 s42, s42, 40960
    s_cmp_eq_u32 s42, 163840
    s_cselect_b32 s42, 0, s42
    v_add_u32 v20, s42, v16
    v_add_u32 v21, s42, v17
    v_add_u32 v22, s42, v18
    v_add_u32 v23, s42, v19
    s_waitcnt vmcnt(13)
    s_barrier
    s_waitcnt lgkmcnt(6)
    v_mfma_f32_32x32x16_bf16 v[48:63], v[228:231], v[68:71], v[48:63]
    ds_read_b128 v[64:67], v20 offset:0
    s_add_u32 s43, s42, 81920
    s_cmp_ge_u32 s43, 163840
    s_cselect_b32 s33, 163840, 0
    s_sub_u32 s43, s43, s33
    s_add_u32 s43, s43, s45
    s_waitcnt lgkmcnt(6)
    v_mfma_f32_32x32x16_bf16 v[48:63], v[232:235], v[72:75], v[48:63]
    ds_read_b128 v[68:71], v21 offset:0
    s_add_u32 s38, s38, 40960
    s_add_u32 s33, s41, 3
    s_cmp_lt_u32 s33, s40
    s_cselect_b32 s38, s38, 268435456
    s_waitcnt lgkmcnt(6)
    v_mfma_f32_32x32x16_bf16 v[48:63], v[236:239], v[76:79], v[48:63]
    ds_read_b128 v[72:75], v22 offset:0
    s_mov_b32 s46, s39
    s_add_u32 s39, s39, 786432
    s_add_u32 s41, s41, 1
    s_cmp_lt_u32 s41, s40
    s_waitcnt lgkmcnt(6)
    v_mfma_f32_32x32x16_bf16 v[48:63], v[240:243], v[80:83], v[48:63]
    ds_read_b128 v[76:79], v23 offset:0
    s_waitcnt lgkmcnt(6)
    v_mfma_f32_32x32x16_bf16 v[48:63], v[244:247], v[84:87], v[48:63]
    ds_read_b128 v[80:83], v20 offset:1024
    s_waitcnt lgkmcnt(6)
    v_mfma_f32_32x32x16_bf16 v[48:63], v[248:251], v[88:91], v[48:63]
    ds_read_b128 v[84:87], v21 offset:1024
    s_waitcnt lgkmcnt(6)
    v_mfma_f32_32x32x16_bf16 v[48:63], v[252:255], v[92:95], v[48:63]
    ds_read_b128 v[88:91], v22 offset:1024
    s_nop 0
    s_cbranch_scc1 L_pqk_top
    s_nop 9
    v_mul_f32 v48, s50, v48
    v_mul_f32 v49, s50, v49
    v_mul_f32 v50, s50, v50
    v_mul_f32 v51, s50, v51
    v_mul_f32 v52, s50, v52
    v_mul_f32 v53, s50, v53
    v_mul_f32 v54, s50, v54
    v_mul_f32 v55, s50, v55
    v_mul_f32 v56, s50, v56
    v_mul_f32 v57, s50, v57
    v_mul_f32 v58, s50, v58
    v_mul_f32 v59, s50, v59
    v_mul_f32 v60, s50, v60
    v_mul_f32 v61, s50, v61
    v_mul_f32 v62, s50, v62
    v_mul_f32 v63, s50, v63
    v_cvt_pk_bf16_f32 v24, v48, v49
    v_cvt_pk_bf16_f32 v25, v50, v51
    v_cvt_pk_bf16_f32 v26, v56, v57
    v_cvt_pk_bf16_f32 v27, v58, v59
    v_cvt_pk_bf16_f32 v28, v52, v53
    v_cvt_pk_bf16_f32 v29, v54, v55
    v_cvt_pk_bf16_f32 v30, v60, v61
    v_cvt_pk_bf16_f32 v31, v62, v63
    buffer_store_dwordx4 v[24:27], v9, s[4:7], s46 offen offset:0 sc1
    buffer_store_dwordx4 v[28:31], v9, s[4:7], s46 offen offset:512 sc1
    s_branch L_pqk_end
L_pqk_end0:
    v_mul_f32 v32, s50, v32
    v_mul_f32 v33, s50, v33
    v_mul_f32 v34, s50, v34
    v_mul_f32 v35, s50, v35
    v_mul_f32 v36, s50, v36
    v_mul_f32 v37, s50, v37
    v_mul_f32 v38, s50, v38
    v_mul_f32 v39, s50, v39
    v_mul_f32 v40, s50, v40
    v_mul_f32 v41, s50, v41
    v_mul_f32 v42, s50, v42
    v_mul_f32 v43, s50, v43
    v_mul_f32 v44, s50, v44
    v_mul_f32 v45, s50, v45
    v_mul_f32 v46, s50, v46
    v_mul_f32 v47, s50, v47
    v_cvt_pk_bf16_f32 v24, v32, v33
    v_cvt_pk_bf16_f32 v25, v34, v35
    v_cvt_pk_bf16_f32 v26, v40, v41
    v_cvt_pk_bf16_f32 v27, v42, v43
    v_cvt_pk_bf16_f32 v28, v36, v37
    v_cvt_pk_bf16_f32 v29, v38, v39
    v_cvt_pk_bf16_f32 v30, v44, v45
    v_cvt_pk_bf16_f32 v31, v46, v47
    buffer_store_dwordx4 v[24:27], v9, s[4:7], s46 offen offset:0 sc1
    buffer_store_dwordx4 v[28:31], v9, s[4:7], s46 offen offset:512 sc1
L_pqk_end:
    s_waitcnt vmcnt(0) lgkmcnt(0)
    s_barrier
    v_mov_b32 v15, s40
    buffer_store_dword v15, off, s[4:7], s44 sc1
    s_branch L_pdone
L_pv:
    v_mbcnt_lo_u32_b32 v10, -1, 0
    v_mbcnt_hi_u32_b32 v10, -1, v10
    v_lshrrev_b32 v11, 3, v10
    s_lshl_b32 s33, s3, 3
    v_add_u32 v11, s33, v11
    v_lshrrev_b32 v12, 1, v11
    v_xor_b32 v12, v12, v10
    v_and_b32 v12, 7, v12
    v_mul_u32_u24 v11, 1280, v11
    v_lshl_add_u32 v13, v12, 4, v11
    v_bfe_u32 v11, v10, 3, 2
    v_mul_u32_u24 v11, 10240, v11
    v_and_b32 v12, 7, v10
    v_lshl_add_u32 v11, v12, 7, v11
    v_bfe_u32 v12, v10, 1, 3
    v_lshrrev_b32 v15, 5, v10
    v_xor_b32 v12, v12, v15
    v_xor_b32 v15, 0, v12
    v_lshl_add_u32 v16, v15, 4, v11
    v_mov_b32 v20, v16
    v_xor_b32 v15, 2, v12
    v_lshl_add_u32 v17, v15, 4, v11
    v_mov_b32 v21, v17
    v_xor_b32 v15, 4, v12
    v_lshl_add_u32 v18, v15, 4, v11
    v_mov_b32 v22, v18
    v_xor_b32 v15, 6, v12
    v_lshl_add_u32 v19, v15, 4, v11
    v_mov_b32 v23, v19
    s_mul_i32 s45, s3, 10240
    s_add_u32 s43, s45, 0
    s_add_u32 m0, s43, 0
    s_nop 0
    buffer_load_dwordx4 v13, s[12:15], s38 offen offset:0 lds
    s_add_u32 m0, s43, 896
    s_nop 0
    buffer_load_dwordx4 v13, s[12:15], s38 offen offset:128 lds
    s_add_u32 m0, s43, 1792
    s_nop 0
    buffer_load_dwordx4 v13, s[12:15], s38 offen offset:256 lds
    s_add_u32 m0, s43, 2688
    s_nop 0
    buffer_load_dwordx4 v13, s[12:15], s38 offen offset:384 lds
    s_add_u32 m0, s43, 3584
    s_nop 0
    buffer_load_dwordx4 v13, s[12:15], s38 offen offset:512 lds
    s_add_u32 m0, s43, 4480
    s_nop 0
    buffer_load_dwordx4 v13, s[12:15], s38 offen offset:640 lds
    s_add_u32 m0, s43, 5376
    s_nop 0
    buffer_load_dwordx4 v13, s[12:15], s38 offen offset:768 lds
    s_add_u32 m0, s43, 6272
    s_nop 0
    buffer_load_dwordx4 v13, s[12:15], s38 offen offset:896 lds
    s_add_u32 m0, s43, 7168
    s_nop 0
    buffer_load_dwordx4 v13, s[12:15], s38 offen offset:1024 lds
    s_add_u32 m0, s43, 8064
    s_nop 0
    buffer_load_dwordx4 v13, s[12:15], s38 offen offset:1152 lds
    s_add_u32 s38, s38, 40960
    s_cmp_lt_u32 1, s40
    s_cselect_b32 s38, s38, 268435456
    s_add_u32 s43, s45, 40960
    s_add_u32 m0, s43, 0
    s_nop 0
    buffer_load_dwordx4 v13, s[12:15], s38 offen offset:0 lds
    s_add_u32 m0, s43, 896
    s_nop 0
    buffer_load_dwordx4 v13, s[12:15], s38 offen offset:128 lds
    s_add_u32 m0, s43, 1792
    s_nop 0
    buffer_load_dwordx4 v13, s[12:15], s38 offen offset:256 lds
    s_add_u32 m0, s43, 2688
    s_nop 0
    buffer_load_dwordx4 v13, s[12:15], s38 offen offset:384 lds
    s_add_u32 m0, s43, 3584
    s_nop 0
    buffer_load_dwordx4 v13, s[12:15], s38 offen offset:512 lds
    s_add_u32 m0, s43, 4480
    s_nop 0
    buffer_load_dwordx4 v13, s[12:15], s38 offen offset:640 lds
    s_add_u32 m0, s43, 5376
    s_nop 0
    buffer_load_dwordx4 v13, s[12:15], s38 offen offset:768 lds
    s_add_u32 m0, s43, 6272
    s_nop 0
    buffer_load_dwordx4 v13, s[12:15], s38 offen offset:896 lds
    s_add_u32 m0, s43, 7168
    s_nop 0
    buffer_load_dwordx4 v13, s[12:15], s38 offen offset:1024 lds
    s_add_u32 m0, s43, 8064
    s_nop 0
    buffer_load_dwordx4 v13, s[12:15], s38 offen offset:1152 lds
    s_add_u32 s38, s38, 40960
    s_cmp_lt_u32 2, s40
    s_cselect_b32 s38, s38, 268435456
    s_add_u32 s43, s45, 81920
    s_mov_b32 s41, 0
    s_mov_b32 s42, 0
    s_mov_b32 s46, 268435456
    s_waitcnt vmcnt(10)
    s_barrier
    ds_read_b128 v[64:67], v20 offset:0
    ds_read_b128 v[68:71], v21 offset:0
    ds_read_b128 v[72:75], v22 offset:0
    ds_read_b128 v[76:79], v23 offset:0
    ds_read_b128 v[80:83], v20 offset:1024
    ds_read_b128 v[84:87], v21 offset:1024
    ds_read_b128 v[88:91], v22 offset:1024
L_pv_top:
    s_waitcnt lgkmcnt(6)
    v_mfma_f32_32x32x16_bf16 v[32:47], v[64:67], v[96:99], 0
    ds_read_b128 v[92:95], v23 offset:1024
    s_max_i32 s33, s41, 2
    s_sub_u32 s33, s33, 2
    v_mov_b32 v15, s33
    s_waitcnt lgkmcnt(6)
    v_mfma_f32_32x32x16_bf16 v[32:47], v[68:71], v[100:103], v[32:47]
    ds_read_b128 v[64:67], v20 offset:2048
    v_cvt_pk_bf16_f32 v24, v48, v49
    v_cvt_pk_bf16_f32 v25, v50, v51
    v_cvt_pk_bf16_f32 v26, v56, v57
    v_cvt_pk_bf16_f32 v27, v58, v59
    s_waitcnt lgkmcnt(6)
    v_mfma_f32_32x32x16_bf16 v[32:47], v[72:75], v[104:107], v[32:47]
    ds_read_b128 v[68:71], v21 offset:2048
    v_cvt_pk_bf16_f32 v28, v52, v53
    v_cvt_pk_bf16_f32 v29, v54, v55
    v_cvt_pk_bf16_f32 v30, v60, v61
    v_cvt_pk_bf16_f32 v31, v62, v63
    s_waitcnt lgkmcnt(6)
    v_mfma_f32_32x32x16_bf16 v[32:47], v[76:79], v[108:111], v[32:47]
    ds_read_b128 v[72:75], v22 offset:2048
    buffer_store_dwordx4 v[24:27], v9, s[4:7], s46 offen offset:0 sc1
    s_waitcnt lgkmcnt(6)
    v_mfma_f32_32x32x16_bf16 v[32:47], v[80:83], v[112:115], v[32:47]
    ds_read_b128 v[76:79], v23 offset:2048
    s_waitcnt lgkmcnt(6)
    v_mfma_f32_32x32x16_bf16 v[32:47], v[84:87], v[116:119], v[32:47]
    ds_read_b128 v[80:83], v20 offset:3072
    buffer_store_dwordx4 v[28:31], v9, s[4:7], s46 offen offset:512 sc1
    s_waitcnt lgkmcnt(6)
    v_mfma_f32_32x32x16_bf16 v[32:47], v[88:91], v[120:123], v[32:47]
    ds_read_b128 v[84:87], v21 offset:3072
    s_waitcnt lgkmcnt(6)
    v_mfma_f32_32x32x16_bf16 v[32:47], v[92:95], v[124:127], v[32:47]
    ds_read_b128 v[88:91], v22 offset:3072
    buffer_store_dword v15, off, s[4:7], s44 sc1
    s_waitcnt lgkmcnt(6)
    v_mfma_f32_32x32x16_bf16 v[32:47], v[64:67], v[128:131], v[32:47]
    ds_read_b128 v[92:95], v23 offset:3072
    s_waitcnt lgkmcnt(6)
    v_mfma_f32_32x32x16_bf16 v[32:47], v[68:71], v[132:135], v[32:47]
    ds_read_b128 v[64:67], v20 offset:4096
    s_waitcnt lgkmcnt(6)
    v_mfma_f32_32x32x16_bf16 v[32:47], v[72:75], v[136:139], v[32:47]
    ds_read_b128 v[68:71], v21 offset:4096
    s_add_u32 m0, s43, 0
    s_nop 0
    buffer_load_dwordx4 v13, s[12:15], s38 offen offset:0 lds
    s_waitcnt lgkmcnt(6)
    v_mfma_f32_32x32x16_bf16 v[32:47], v[76:79], v[140:143], v[32:47]
    ds_read_b128 v[72:75], v22 offset:4096
    s_waitcnt lgkmcnt(6)
    v_mfma_f32_32x32x16_bf16 v[32:47], v[80:83], v[144:147], v[32:47]
    ds_read_b128 v[76:79], v23 offset:4096
    s_add_u32 m0, s43, 896
    s_nop 0
    buffer_load_dwordx4 v13, s[12:15], s38 offen offset:128 lds
    s_waitcnt lgkmcnt(6)
    v_mfma_f32_32x32x16_bf16 v[32:47], v[84:87], v[148:151], v[32:47]
    ds_read_b128 v[80:83], v20 offset:5120
    s_waitcnt lgkmcnt(6)
    v_mfma_f32_32x32x16_bf16 v[32:47], v[88:91], v[152:155], v[32:47]
    ds_read_b128 v[84:87], v21 offset:5120
    s_add_u32 m0, s43, 1792
    s_nop 0
    buffer_load_dwordx4 v13, s[12:15], s38 offen offset:256 lds
    s_waitcnt lgkmcnt(6)
    v_mfma_f32_32x32x16_bf16 v[32:47], v[92:95], v[156:159], v[32:47]
    ds_read_b128 v[88:91], v22 offset:5120
    s_waitcnt lgkmcnt(6)
    v_mfma_f32_32x32x16_bf16 v[32:47], v[64:67], v[160:163], v[32:47]
    ds_read_b128 v[92:95], v23 offset:5120
    s_waitcnt lgkmcnt(6)
    v_mfma_f32_32x32x16_bf16 v[32:47], v[68:71], v[164:167], v[32:47]
    ds_read_b128 v[64:67], v20 offset:6144
    s_add_u32 m0, s43, 2688
    s_nop 0
    buffer_load_dwordx4 v13, s[12:15], s38 offen offset:384 lds
    s_waitcnt lgkmcnt(6)
    v_mfma_f32_32x32x16_bf16 v[32:47], v[72:75], v[168:171], v[32:47]
    ds_read_b128 v[68:71], v21 offset:6144
    s_waitcnt lgkmcnt(6)
    v_mfma_f32_32x32x16_bf16 v[32:47], v[76:79], v[172:175], v[32:47]
    ds_read_b128 v[72:75], v22 offset:6144
    s_add_u32 m0, s43, 3584
    s_nop 0
    buffer_load_dwordx4 v13, s[12:15], s38 offen offset:512 lds
    s_waitcnt lgkmcnt(6)
    v_mfma_f32_32x32x16_bf16 v[32:47], v[80:83], v[176:179], v[32:47]
    ds_read_b128 v[76:79], v23 offset:6144
    s_waitcnt lgkmcnt(6)
    v_mfma_f32_32x32x16_bf16 v[32:47], v[84:87], v[180:183], v[32:47]
    ds_read_b128 v[80:83], v20 offset:7168
    s_add_u32 m0, s43, 4480
    s_nop 0
    buffer_load_dwordx4 v13, s[12:15], s38 offen offset:640 lds
    s_waitcnt lgkmcnt(6)
    v_mfma_f32_32x32x16_bf16 v[32:47], v[88:91], v[184:187], v[32:47]
    ds_read_b128 v[84:87], v21 offset:7168
    s_waitcnt lgkmcnt(6)
    v_mfma_f32_32x32x16_bf16 v[32:47], v[92:95], v[188:191], v[32:47]
    ds_read_b128 v[88:91], v22 offset:7168
    s_waitcnt lgkmcnt(6)
    v_mfma_f32_32x32x16_bf16 v[32:47], v[64:67], v[192:195], v[32:47]
    ds_read_b128 v[92:95], v23 offset:7168
    s_add_u32 m0, s43, 5376
    s_nop 0
    buffer_load_dwordx4 v13, s[12:15], s38 offen offset:768 lds
    s_waitcnt lgkmcnt(6)
    v_mfma_f32_32x32x16_bf16 v[32:47], v[68:71], v[196:199], v[32:47]
    ds_read_b128 v[64:67], v20 offset:8192
    s_waitcnt lgkmcnt(6)
    v_mfma_f32_32x32x16_bf16 v[32:47], v[72:75], v[200:203], v[32:47]
    ds_read_b128 v[68:71], v21 offset:8192
    s_add_u32 m0, s43, 6272
    s_nop 0
    buffer_load_dwordx4 v13, s[12:15], s38 offen offset:896 lds
    s_waitcnt lgkmcnt(6)
    v_mfma_f32_32x32x16_bf16 v[32:47], v[76:79], v[204:207], v[32:47]
    ds_read_b128 v[72:75], v22 offset:8192
    s_waitcnt lgkmcnt(6)
    v_mfma_f32_32x32x16_bf16 v[32:47], v[80:83], v[208:211], v[32:47]
    ds_read_b128 v[76:79], v23 offset:8192
    s_add_u32 m0, s43, 7168
    s_nop 0
    buffer_load_dwordx4 v13, s[12:15], s38 offen offset:1024 lds
    s_waitcnt lgkmcnt(6)
    v_mfma_f32_32x32x16_bf16 v[32:47], v[84:87], v[212:215], v[32:47]
    ds_read_b128 v[80:83], v20 offset:9216
    s_waitcnt lgkmcnt(6)
    v_mfma_f32_32x32x16_bf16 v[32:47], v[88:91], v[216:219], v[32:47]
    ds_read_b128 v[84:87], v21 offset:9216
    s_waitcnt lgkmcnt(6)
    v_mfma_f32_32x32x16_bf16 v[32:47], v[92:95], v[220:223], v[32:47]
    ds_read_b128 v[88:91], v22 offset:9216
    s_add_u32 m0, s43, 8064
    s_nop 0
    buffer_load_dwordx4 v13, s[12:15], s38 offen offset:1152 lds
    s_waitcnt lgkmcnt(6)
    v_mfma_f32_32x32x16_bf16 v[32:47], v[64:67], v[224:227], v[32:47]
    ds_read_b128 v[92:95], v23 offset:9216
    s_add_u32 s42, s42, 40960
    s_cmp_eq_u32 s42, 163840
    s_cselect_b32 s42, 0, s42
    v_add_u32 v20, s42, v16
    v_add_u32 v21, s42, v17
    v_add_u32 v22, s42, v18
    v_add_u32 v23, s42, v19
    s_waitcnt vmcnt(13)
    s_barrier
    s_waitcnt lgkmcnt(6)
    v_mfma_f32_32x32x16_bf16 v[32:47], v[68:71], v[228:231], v[32:47]
    ds_read_b128 v[64:67], v20 offset:0
    s_add_u32 s43, s42, 81920
    s_cmp_ge_u32 s43, 163840
    s_cselect_b32 s33, 163840, 0
    s_sub_u32 s43, s43, s33
    s_add_u32 s43, s43, s45
    s_waitcnt lgkmcnt(6)
    v_mfma_f32_32x32x16_bf16 v[32:47], v[72:75], v[232:235], v[32:47]
    ds_read_b128 v[68:71], v21 offset:0
    s_add_u32 s38, s38, 40960
    s_add_u32 s33, s41, 3
    s_cmp_lt_u32 s33, s40
    s_cselect_b32 s38, s38, 268435456
    s_waitcnt lgkmcnt(6)
    v_mfma_f32_32x32x16_bf16 v[32:47], v[76:79], v[236:239], v[32:47]
    ds_read_b128 v[72:75], v22 offset:0
    s_mov_b32 s46, s39
    s_add_u32 s39, s39, 786432
    s_add_u32 s41, s41, 1
    s_cmp_lt_u32 s41, s40
    s_waitcnt lgkmcnt(6)
    v_mfma_f32_32x32x16_bf16 v[32:47], v[80:83], v[240:243], v[32:47]
    ds_read_b128 v[76:79], v23 offset:0
    s_waitcnt lgkmcnt(6)
    v_mfma_f32_32x32x16_bf16 v[32:47], v[84:87], v[244:247], v[32:47]
    ds_read_b128 v[80:83], v20 offset:1024
    s_waitcnt lgkmcnt(6)
    v_mfma_f32_32x32x16_bf16 v[32:47], v[88:91], v[248:251], v[32:47]
    ds_read_b128 v[84:87], v21 offset:1024
    s_waitcnt lgkmcnt(6)
    v_mfma_f32_32x32x16_bf16 v[32:47], v[92:95], v[252:255], v[32:47]
    ds_read_b128 v[88:91], v22 offset:1024
    s_nop 9
    s_cbranch_scc0 L_pv_end0
    s_waitcnt lgkmcnt(6)
    v_mfma_f32_32x32x16_bf16 v[48:63], v[64:67], v[96:99], 0
    ds_read_b128 v[92:95], v23 offset:1024
    s_max_i32 s33, s41, 2
    s_sub_u32 s33, s33, 2
    v_mov_b32 v15, s33
    s_waitcnt lgkmcnt(6)
    v_mfma_f32_32x32x16_bf16 v[48:63], v[68:71], v[100:103], v[48:63]
    ds_read_b128 v[64:67], v20 offset:2048
    v_cvt_pk_bf16_f32 v24, v32, v33
    v_cvt_pk_bf16_f32 v25, v34, v35
    v_cvt_pk_bf16_f32 v26, v40, v41
    v_cvt_pk_bf16_f32 v27, v42, v43
    s_waitcnt lgkmcnt(6)
    v_mfma_f32_32x32x16_bf16 v[48:63], v[72:75], v[104:107], v[48:63]
    ds_read_b128 v[68:71], v21 offset:2048
    v_cvt_pk_bf16_f32 v28, v36, v37
    v_cvt_pk_bf16_f32 v29, v38, v39
    v_cvt_pk_bf16_f32 v30, v44, v45
    v_cvt_pk_bf16_f32 v31, v46, v47
    s_waitcnt lgkmcnt(6)
    v_mfma_f32_32x32x16_bf16 v[48:63], v[76:79], v[108:111], v[48:63]
    ds_read_b128 v[72:75], v22 offset:2048
    buffer_store_dwordx4 v[24:27], v9, s[4:7], s46 offen offset:0 sc1
    s_waitcnt lgkmcnt(6)
    v_mfma_f32_32x32x16_bf16 v[48:63], v[80:83], v[112:115], v[48:63]
    ds_read_b128 v[76:79], v23 offset:2048
    s_waitcnt lgkmcnt(6)
    v_mfma_f32_32x32x16_bf16 v[48:63], v[84:87], v[116:119], v[48:63]
    ds_read_b128 v[80:83], v20 offset:3072
    buffer_store_dwordx4 v[28:31], v9, s[4:7], s46 offen offset:512 sc1
    s_waitcnt lgkmcnt(6)
    v_mfma_f32_32x32x16_bf16 v[48:63], v[88:91], v[120:123], v[48:63]
    ds_read_b128 v[84:87], v21 offset:3072
    s_waitcnt lgkmcnt(6)
    v_mfma_f32_32x32x16_bf16 v[48:63], v[92:95], v[124:127], v[48:63]
    ds_read_b128 v[88:91], v22 offset:3072
    buffer_store_dword v15, off, s[4:7], s44 sc1
    s_waitcnt lgkmcnt(6)
    v_mfma_f32_32x32x16_bf16 v[48:63], v[64:67], v[128:131], v[48:63]
    ds_read_b128 v[92:95], v23 offset:3072
    s_waitcnt lgkmcnt(6)
    v_mfma_f32_32x32x16_bf16 v[48:63], v[68:71], v[132:135], v[48:63]
    ds_read_b128 v[64:67], v20 offset:4096
    s_waitcnt lgkmcnt(6)
    v_mfma_f32_32x32x16_bf16 v[48:63], v[72:75], v[136:139], v[48:63]
    ds_read_b128 v[68:71], v21 offset:4096
    s_add_u32 m0, s43, 0
    s_nop 0
    buffer_load_dwordx4 v13, s[12:15], s38 offen offset:0 lds
    s_waitcnt lgkmcnt(6)
    v_mfma_f32_32x32x16_bf16 v[48:63], v[76:79], v[140:143], v[48:63]
    ds_read_b128 v[72:75], v22 offset:4096
    s_waitcnt lgkmcnt(6)
    v_mfma_f32_32x32x16_bf16 v[48:63], v[80:83], v[144:147], v[48:63]
    ds_read_b128 v[76:79], v23 offset:4096
    s_add_u32 m0, s43, 896
    s_nop 0
    buffer_load_dwordx4 v13, s[12:15], s38 offen offset:128 lds
    s_waitcnt lgkmcnt(6)
    v_mfma_f32_32x32x16_bf16 v[48:63], v[84:87], v[148:151], v[48:63]
    ds_read_b128 v[80:83], v20 offset:5120
    s_waitcnt lgkmcnt(6)
    v_mfma_f32_32x32x16_bf16 v[48:63], v[88:91], v[152:155], v[48:63]
    ds_read_b128 v[84:87], v21 offset:5120
    s_add_u32 m0, s43, 1792
    s_nop 0
    buffer_load_dwordx4 v13, s[12:15], s38 offen offset:256 lds
    s_waitcnt lgkmcnt(6)
    v_mfma_f32_32x32x16_bf16 v[48:63], v[92:95], v[156:159], v[48:63]
    ds_read_b128 v[88:91], v22 offset:5120
    s_waitcnt lgkmcnt(6)
    v_mfma_f32_32x32x16_bf16 v[48:63], v[64:67], v[160:163], v[48:63]
    ds_read_b128 v[92:95], v23 offset:5120
    s_waitcnt lgkmcnt(6)
    v_mfma_f32_32x32x16_bf16 v[48:63], v[68:71], v[164:167], v[48:63]
    ds_read_b128 v[64:67], v20 offset:6144
    s_add_u32 m0, s43, 2688
    s_nop 0
    buffer_load_dwordx4 v13, s[12:15], s38 offen offset:384 lds
    s_waitcnt lgkmcnt(6)
    v_mfma_f32_32x32x16_bf16 v[48:63], v[72:75], v[168:171], v[48:63]
    ds_read_b128 v[68:71], v21 offset:6144
    s_waitcnt lgkmcnt(6)
    v_mfma_f32_32x32x16_bf16 v[48:63], v[76:79], v[172:175], v[48:63]
    ds_read_b128 v[72:75], v22 offset:6144
    s_add_u32 m0, s43, 3584
    s_nop 0
    buffer_load_dwordx4 v13, s[12:15], s38 offen offset:512 lds
    s_waitcnt lgkmcnt(6)
    v_mfma_f32_32x32x16_bf16 v[48:63], v[80:83], v[176:179], v[48:63]
    ds_read_b128 v[76:79], v23 offset:6144
    s_waitcnt lgkmcnt(6)
    v_mfma_f32_32x32x16_bf16 v[48:63], v[84:87], v[180:183], v[48:63]
    ds_read_b128 v[80:83], v20 offset:7168
    s_add_u32 m0, s43, 4480
    s_nop 0
    buffer_load_dwordx4 v13, s[12:15], s38 offen offset:640 lds
    s_waitcnt lgkmcnt(6)
    v_mfma_f32_32x32x16_bf16 v[48:63], v[88:91], v[184:187], v[48:63]
    ds_read_b128 v[84:87], v21 offset:7168
    s_waitcnt lgkmcnt(6)
    v_mfma_f32_32x32x16_bf16 v[48:63], v[92:95], v[188:191], v[48:63]
    ds_read_b128 v[88:91], v22 offset:7168
    s_waitcnt lgkmcnt(6)
    v_mfma_f32_32x32x16_bf16 v[48:63], v[64:67], v[192:195], v[48:63]
    ds_read_b128 v[92:95], v23 offset:7168
    s_add_u32 m0, s43, 5376
    s_nop 0
    buffer_load_dwordx4 v13, s[12:15], s38 offen offset:768 lds
    s_waitcnt lgkmcnt(6)
    v_mfma_f32_32x32x16_bf16 v[48:63], v[68:71], v[196:199], v[48:63]
    ds_read_b128 v[64:67], v20 offset:8192
    s_waitcnt lgkmcnt(6)
    v_mfma_f32_32x32x16_bf16 v[48:63], v[72:75], v[200:203], v[48:63]
    ds_read_b128 v[68:71], v21 offset:8192
    s_add_u32 m0, s43, 6272
    s_nop 0
    buffer_load_dwordx4 v13, s[12:15], s38 offen offset:896 lds
    s_waitcnt lgkmcnt(6)
    v_mfma_f32_32x32x16_bf16 v[48:63], v[76:79], v[204:207], v[48:63]
    ds_read_b128 v[72:75], v22 offset:8192
    s_waitcnt lgkmcnt(6)
    v_mfma_f32_32x32x16_bf16 v[48:63], v[80:83], v[208:211], v[48:63]
    ds_read_b128 v[76:79], v23 offset:8192
    s_add_u32 m0, s43, 7168
    s_nop 0
    buffer_load_dwordx4 v13, s[12:15], s38 offen offset:1024 lds
    s_waitcnt lgkmcnt(6)
    v_mfma_f32_32x32x16_bf16 v[48:63], v[84:87], v[212:215], v[48:63]
    ds_read_b128 v[80:83], v20 offset:9216
    s_waitcnt lgkmcnt(6)
    v_mfma_f32_32x32x16_bf16 v[48:63], v[88:91], v[216:219], v[48:63]
    ds_read_b128 v[84:87], v21 offset:9216
    s_waitcnt lgkmcnt(6)
    v_mfma_f32_32x32x16_bf16 v[48:63], v[92:95], v[220:223], v[48:63]
    ds_read_b128 v[88:91], v22 offset:9216
    s_add_u32 m0, s43, 8064
    s_nop 0
    buffer_load_dwordx4 v13, s[12:15], s38 offen offset:1152 lds
    s_waitcnt lgkmcnt(6)
    v_mfma_f32_32x32x16_bf16 v[48:63], v[64:67], v[224:227], v[48:63]
    ds_read_b128 v[92:95], v23 offset:9216
    s_add_u32 s42, s42, 40960
    s_cmp_eq_u32 s42, 163840
    s_cselect_b32 s42, 0, s42
    v_add_u32 v20, s42, v16
    v_add_u32 v21, s42, v17
    v_add_u32 v22, s42, v18
    v_add_u32 v23, s42, v19
    s_waitcnt vmcnt(13)
    s_barrier
    s_waitcnt lgkmcnt(6)
    v_mfma_f32_32x32x16_bf16 v[48:63], v[68:71], v[228:231], v[48:63]
    ds_read_b128 v[64:67], v20 offset:0
    s_add_u32 s43, s42, 81920
    s_cmp_ge_u32 s43, 163840
    s_cselect_b32 s33, 163840, 0
    s_sub_u32 s43, s43, s33
    s_add_u32 s43, s43, s45
    s_waitcnt lgkmcnt(6)
    v_mfma_f32_32x32x16_bf16 v[48:63], v[72:75], v[232:235], v[48:63]
    ds_read_b128 v[68:71], v21 offset:0
    s_add_u32 s38, s38, 40960
    s_add_u32 s33, s41, 3
    s_cmp_lt_u32 s33, s40
    s_cselect_b32 s38, s38, 268435456
    s_waitcnt lgkmcnt(6)
    v_mfma_f32_32x32x16_bf16 v[48:63], v[76:79], v[236:239], v[48:63]
    ds_read_b128 v[72:75], v22 offset:0
    s_mov_b32 s46, s39
    s_add_u32 s39, s39, 786432
    s_add_u32 s41, s41, 1
    s_cmp_lt_u32 s41, s40
    s_waitcnt lgkmcnt(6)
    v_mfma_f32_32x32x16_bf16 v[48:63], v[80:83], v[240:243], v[48:63]
    ds_read_b128 v[76:79], v23 offset:0
    s_waitcnt lgkmcnt(6)
    v_mfma_f32_32x32x16_bf16 v[48:63], v[84:87], v[244:247], v[48:63]
    ds_read_b128 v[80:83], v20 offset:1024
    s_waitcnt lgkmcnt(6)
    v_mfma_f32_32x32x16_bf16 v[48:63], v[88:91], v[248:251], v[48:63]
    ds_read_b128 v[84:87], v21 offset:1024
    s_waitcnt lgkmcnt(6)
    v_mfma_f32_32x32x16_bf16 v[48:63], v[92:95], v[252:255], v[48:63]
    ds_read_b128 v[88:91], v22 offset:1024
    s_nop 0
    s_cbranch_scc1 L_pv_top
    s_nop 9
    v_cvt_pk_bf16_f32 v24, v48, v49
    v_cvt_pk_bf16_f32 v25, v50, v51
    v_cvt_pk_bf16_f32 v26, v56, v57
    v_cvt_pk_bf16_f32 v27, v58, v59
    v_cvt_pk_bf16_f32 v28, v52, v53
    v_cvt_pk_bf16_f32 v29, v54, v55
    v_cvt_pk_bf16_f32 v30, v60, v61
    v_cvt_pk_bf16_f32 v31, v62, v63
    buffer_store_dwordx4 v[24:27], v9, s[4:7], s46 offen offset:0 sc1
    buffer_store_dwordx4 v[28:31], v9, s[4:7], s46 offen offset:512 sc1
    s_branch L_pv_end
L_pv_end0:
    v_cvt_pk_bf16_f32 v24, v32, v33
    v_cvt_pk_bf16_f32 v25, v34, v35
    v_cvt_pk_bf16_f32 v26, v40, v41
    v_cvt_pk_bf16_f32 v27, v42, v43
    v_cvt_pk_bf16_f32 v28, v36, v37
    v_cvt_pk_bf16_f32 v29, v38, v39
    v_cvt_pk_bf16_f32 v30, v44, v45
    v_cvt_pk_bf16_f32 v31, v46, v47
    buffer_store_dwordx4 v[24:27], v9, s[4:7], s46 offen offset:0 sc1
    buffer_store_dwordx4 v[28:31], v9, s[4:7], s46 offen offset:512 sc1
L_pv_end:
    s_waitcnt vmcnt(0) lgkmcnt(0)
    s_barrier
    v_mov_b32 v15, s40
    buffer_store_dword v15, off, s[4:7], s44 sc1
L_pdone:
L_role_b:
    s_lshl_b32 s33, s21, 2
    s_add_u32 s33, s33, s3
    s_and_b32 s48, s33, 31
    s_lshr_b32 s49, s33, 5
    s_mov_b32 s51, 0x3ea52b5c
    v_mbcnt_lo_u32_b32 v200, -1, 0
    v_mbcnt_hi_u32_b32 v200, -1, v200
    v_lshlrev_b32 v10, 4, v200
    v_and_b32 v201, 31, v200
    v_lshrrev_b32 v202, 5, v200
    v_lshlrev_b32 v11, 2, v202
    v_sub_u32 v11, v201, v11
    v_mul_u32_u24 v12, 1280, v201
    v_lshl_add_u32 v12, v202, 3, v12
    v_mov_b32 v13, 0xf149f2ca
    s_lshr_b32 s54, s48, 2
    s_lshl_b32 s54, s54, 7
    s_add_u32 s54, s54, 69229568
    s_mov_b32 s53, 0
    v_min_u32 v14, 32, v10
    v_lshlrev_b32 v14, 6, v14
    s_min_u32 s35, s49, 63
    s_cmp_lt_u32 s35, s53
    s_cbranch_scc1 L_ab_ok_13
    s_mov_b32 s32, 262144
L_ab_p_12:
    buffer_load_dword v15, v14, s[4:7], s54 offen sc1
    s_sub_u32 s32, s32, 1
    s_cbranch_scc1 L_abort
    s_waitcnt vmcnt(0)
    v_readlane_b32 s33, v15, 0
    v_readlane_b32 s34, v15, 1
    v_readlane_b32 s53, v15, 2
    s_min_u32 s33, s33, s34
    s_min_u32 s53, s53, s33
    s_cmp_lt_u32 s35, s53
    s_cbranch_scc0 L_ab_p_12
L_ab_ok_13:
    s_lshl_b32 s52, s49, 5
    s_add_u32 s52, s52, s48
    s_lshl_b32 s52, s52, 11
    s_cmp_lt_u32 s49, 64
    s_cselect_b32 s52, s52, 268435456
    s_add_u32 s33, s52, 100663296
    buffer_load_dwordx4 v[176:179], v10, s[4:7], s33 offen offset:0 sc1
    buffer_load_dwordx4 v[180:183], v10, s[4:7], s33 offen offset:1024 sc1
    s_add_u32 s33, s52, 104333312
    s_cmp_ge_u32 s49, 8
    s_cselect_b32 s33, s33, 268435456
    buffer_load_dwordx4 a[0:3], v10, s[4:7], s33 offen offset:0 sc1
    buffer_load_dwordx4 a[4:7], v10, s[4:7], s33 offen offset:1024 sc1
    s_add_u32 s33, s52, 104398848
    s_cmp_ge_u32 s49, 7
    s_cselect_b32 s33, s33, 268435456
    buffer_load_dwordx4 a[8:11], v10, s[4:7], s33 offen offset:0 sc1
    buffer_load_dwordx4 a[12:15], v10, s[4:7], s33 offen offset:1024 sc1
    s_add_u32 s33, s52, 104464384
    s_cmp_ge_u32 s49, 6
    s_cselect_b32 s33, s33, 268435456
    buffer_load_dwordx4 a[16:19], v10, s[4:7], s33 offen offset:0 sc1
    buffer_load_dwordx4 a[20:23], v10, s[4:7], s33 offen offset:1024 sc1
    s_add_u32 s33, s52, 104529920
    s_cmp_ge_u32 s49, 5
    s_cselect_b32 s33, s33, 268435456
    buffer_load_dwordx4 a[24:27], v10, s[4:7], s33 offen offset:0 sc1
    buffer_load_dwordx4 a[28:31], v10, s[4:7], s33 offen offset:1024 sc1
    s_add_u32 s33, s52, 104595456
    s_cmp_ge_u32 s49, 4
    s_cselect_b32 s33, s33, 268435456
    buffer_load_dwordx4 a[32:35], v10, s[4:7], s33 offen offset:0 sc1
    buffer_load_dwordx4 a[36:39], v10, s[4:7], s33 offen offset:1024 sc1
    s_add_u32 s33, s52, 104660992
    s_cmp_ge_u32 s49, 3
    s_cselect_b32 s33, s33, 268435456
    buffer_load_dwordx4 a[40:43], v10, s[4:7], s33 offen offset:0 sc1
    buffer_load_dwordx4 a[44:47], v10, s[4:7], s33 offen offset:1024 sc1
    s_add_u32 s33, s52, 104726528
    s_cmp_ge_u32 s49, 2
    s_cselect_b32 s33, s33, 268435456
    buffer_load_dwordx4 a[48:51], v10, s[4:7], s33 offen offset:0 sc1
    buffer_load_dwordx4 a[52:55], v10, s[4:7], s33 offen offset:1024 sc1
    s_add_u32 s33, s52, 104792064
    s_cmp_ge_u32 s49, 1
    s_cselect_b32 s33, s33, 268435456
    buffer_load_dwordx4 a[56:59], v10, s[4:7], s33 offen offset:0 sc1
    buffer_load_dwordx4 a[60:63], v10, s[4:7], s33 offen offset:1024 sc1
    s_add_u32 s33, s52, 104857600
    s_cmp_ge_u32 s49, 0
    s_cselect_b32 s33, s33, 268435456
    buffer_load_dwordx4 a[64:67], v10, s[4:7], s33 offen offset:0 sc1
    buffer_load_dwordx4 a[68:71], v10, s[4:7], s33 offen offset:1024 sc1
L_ab_job:
    s_add_u32 s33, s52, 108527616
    s_cmp_ge_u32 s49, 8
    s_cselect_b32 s33, s33, 268435456
    buffer_load_dwordx4 a[72:75], v10, s[4:7], s33 offen offset:0 sc1
    buffer_load_dwordx4 a[76:79], v10, s[4:7], s33 offen offset:1024 sc1
    s_add_u32 s33, s52, 108593152
    s_cmp_ge_u32 s49, 7
    s_cselect_b32 s33, s33, 268435456
    buffer_load_dwordx4 a[80:83], v10, s[4:7], s33 offen offset:0 sc1
    buffer_load_dwordx4 a[84:87], v10, s[4:7], s33 offen offset:1024 sc1
    s_add_u32 s33, s52, 108658688
    s_cmp_ge_u32 s49, 6
    s_cselect_b32 s33, s33, 268435456
    buffer_load_dwordx4 a[88:91], v10, s[4:7], s33 offen offset:0 sc1
    buffer_load_dwordx4 a[92:95], v10, s[4:7], s33 offen offset:1024 sc1
    s_add_u32 s33, s52, 108724224
    s_cmp_ge_u32 s49, 5
    s_cselect_b32 s33, s33, 268435456
    buffer_load_dwordx4 a[96:99], v10, s[4:7], s33 offen offset:0 sc1
    buffer_load_dwordx4 a[100:103], v10, s[4:7], s33 offen offset:1024 sc1
    s_add_u32 s33, s52, 108789760
    s_cmp_ge_u32 s49, 4
    s_cselect_b32 s33, s33, 268435456
    buffer_load_dwordx4 a[104:107], v10, s[4:7], s33 offen offset:0 sc1
    buffer_load_dwordx4 a[108:111], v10, s[4:7], s33 offen offset:1024 sc1
    s_add_u32 s33, s52, 108855296
    s_cmp_ge_u32 s49, 3
    s_cselect_b32 s33, s33, 268435456
    buffer_load_dwordx4 a[112:115], v10, s[4:7], s33 offen offset:0 sc1
    buffer_load_dwordx4 a[116:119], v10, s[4:7], s33 offen offset:1024 sc1
    s_add_u32 s33, s52, 108920832
    s_cmp_ge_u32 s49, 2
    s_cselect_b32 s33, s33, 268435456
    buffer_load_dwordx4 a[120:123], v10, s[4:7], s33 offen offset:0 sc1
    buffer_load_dwordx4 a[124:127], v10, s[4:7], s33 offen offset:1024 sc1
    s_add_u32 s33, s52, 108986368
    s_cmp_ge_u32 s49, 1
    s_cselect_b32 s33, s33, 268435456
    buffer_load_dwordx4 a[128:131], v10, s[4:7], s33 offen offset:0 sc1
    buffer_load_dwordx4 a[132:135], v10, s[4:7], s33 offen offset:1024 sc1
    s_add_u32 s33, s52, 109051904
    s_cmp_ge_u32 s49, 0
    s_cselect_b32 s33, s33, 268435456
    buffer_load_dwordx4 a[136:139], v10, s[4:7], s33 offen offset:0 sc1
    buffer_load_dwordx4 a[140:143], v10, s[4:7], s33 offen offset:1024 sc1
    s_waitcnt vmcnt(18)
    v_mfma_f32_32x32x16_bf16 v[32:47], a[0:3], v[176:179], 0
    v_mfma_f32_32x32x16_bf16 v[32:47], a[4:7], v[180:183], v[32:47]
    v_mfma_f32_32x32x16_bf16 v[48:63], a[8:11], v[176:179], 0
    v_mfma_f32_32x32x16_bf16 v[48:63], a[12:15], v[180:183], v[48:63]
    v_mfma_f32_32x32x16_bf16 v[64:79], a[16:19], v[176:179], 0
    v_mfma_f32_32x32x16_bf16 v[64:79], a[20:23], v[180:183], v[64:79]
    v_mfma_f32_32x32x16_bf16 v[80:95], a[24:27], v[176:179], 0
    v_mfma_f32_32x32x16_bf16 v[80:95], a[28:31], v[180:183], v[80:95]
    v_mfma_f32_32x32x16_bf16 v[96:111], a[32:35], v[176:179], 0
    v_mfma_f32_32x32x16_bf16 v[96:111], a[36:39], v[180:183], v[96:111]
    v_mfma_f32_32x32x16_bf16 v[112:127], a[40:43], v[176:179], 0
    v_mfma_f32_32x32x16_bf16 v[112:127], a[44:47], v[180:183], v[112:127]
    v_mfma_f32_32x32x16_bf16 v[128:143], a[48:51], v[176:179], 0
    v_mfma_f32_32x32x16_bf16 v[128:143], a[52:55], v[180:183], v[128:143]
    v_mfma_f32_32x32x16_bf16 v[144:159], a[56:59], v[176:179], 0
    v_mfma_f32_32x32x16_bf16 v[144:159], a[60:63], v[180:183], v[144:159]
    v_mfma_f32_32x32x16_bf16 v[160:175], a[64:67], v[176:179], 0
    v_mfma_f32_32x32x16_bf16 v[160:175], a[68:71], v[180:183], v[160:175]
    s_add_u32 s50, s49, 15
    v_cmp_le_i32 vcc, 0, v11
    s_nop 1
    v_cndmask_b32 v32, v32, v13, vcc
    s_nop 6
    v_cndmask_b32 v160, v13, v160, vcc
    v_cmp_le_i32 vcc, 1, v11
    s_nop 1
    v_cndmask_b32 v33, v33, v13, vcc
    v_cndmask_b32 v161, v13, v161, vcc
    v_cmp_le_i32 vcc, 2, v11
    s_nop 1
    v_cndmask_b32 v34, v34, v13, vcc
    v_cndmask_b32 v162, v13, v162, vcc
    v_cmp_le_i32 vcc, 3, v11
    s_nop 1
    v_cndmask_b32 v35, v35, v13, vcc
    v_cndmask_b32 v163, v13, v163, vcc
    v_cmp_le_i32 vcc, 8, v11
    s_nop 1
    v_cndmask_b32 v36, v36, v13, vcc
    v_cndmask_b32 v164, v13, v164, vcc
    v_cmp_le_i32 vcc, 9, v11
    s_nop 1
    v_cndmask_b32 v37, v37, v13, vcc
    v_cndmask_b32 v165, v13, v165, vcc
    v_cmp_le_i32 vcc, 10, v11
    s_nop 1
    v_cndmask_b32 v38, v38, v13, vcc
    v_cndmask_b32 v166, v13, v166, vcc
    v_cmp_le_i32 vcc, 11, v11
    s_nop 1
    v_cndmask_b32 v39, v39, v13, vcc
    v_cndmask_b32 v167, v13, v167, vcc
    v_cmp_le_i32 vcc, 16, v11
    s_nop 1
    v_cndmask_b32 v40, v40, v13, vcc
    v_cndmask_b32 v168, v13, v168, vcc
    v_cmp_le_i32 vcc, 17, v11
    s_nop 1
    v_cndmask_b32 v41, v41, v13, vcc
    v_cndmask_b32 v169, v13, v169, vcc
    v_cmp_le_i32 vcc, 18, v11
    s_nop 1
    v_cndmask_b32 v42, v42, v13, vcc
    v_cndmask_b32 v170, v13, v170, vcc
    v_cmp_le_i32 vcc, 19, v11
    s_nop 1
    v_cndmask_b32 v43, v43, v13, vcc
    v_cndmask_b32 v171, v13, v171, vcc
    v_cmp_le_i32 vcc, 24, v11
    s_nop 1
    v_cndmask_b32 v44, v44, v13, vcc
    v_cndmask_b32 v172, v13, v172, vcc
    v_cmp_le_i32 vcc, 25, v11
    s_nop 1
    v_cndmask_b32 v45, v45, v13, vcc
    v_cndmask_b32 v173, v13, v173, vcc
    v_cmp_le_i32 vcc, 26, v11
    s_nop 1
    v_cndmask_b32 v46, v46, v13, vcc
    v_cndmask_b32 v174, v13, v174, vcc
    v_cmp_le_i32 vcc, 27, v11
    s_nop 1
    v_cndmask_b32 v47, v47, v13, vcc
    v_cndmask_b32 v175, v13, v175, vcc
    s_cmp_ge_u32 s49, 8
    s_cbranch_scc1 L_ab_full
    s_cmp_ge_u32 s49, 8
    s_cbranch_scc1 L_ab_full
    v_mov_b32 v32, v13
    v_mov_b32 v33, v13
    v_mov_b32 v34, v13
    v_mov_b32 v35, v13
    v_mov_b32 v36, v13
    v_mov_b32 v37, v13
    v_mov_b32 v38, v13
    v_mov_b32 v39, v13
    v_mov_b32 v40, v13
    v_mov_b32 v41, v13
    v_mov_b32 v42, v13
    v_mov_b32 v43, v13
    v_mov_b32 v44, v13
    v_mov_b32 v45, v13
    v_mov_b32 v46, v13
    v_mov_b32 v47, v13
    s_cmp_ge_u32 s49, 7
    s_cbranch_scc1 L_ab_full
    v_mov_b32 v48, v13
    v_mov_b32 v49, v13
    v_mov_b32 v50, v13
    v_mov_b32 v51, v13
    v_mov_b32 v52, v13
    v_mov_b32 v53, v13
    v_mov_b32 v54, v13
    v_mov_b32 v55, v13
    v_mov_b32 v56, v13
    v_mov_b32 v57, v13
    v_mov_b32 v58, v13
    v_mov_b32 v59, v13
    v_mov_b32 v60, v13
    v_mov_b32 v61, v13
    v_mov_b32 v62, v13
    v_mov_b32 v63, v13
    s_cmp_ge_u32 s49, 6
    s_cbranch_scc1 L_ab_full
    v_mov_b32 v64, v13
    v_mov_b32 v65, v13
    v_mov_b32 v66, v13
    v_mov_b32 v67, v13
    v_mov_b32 v68, v13
    v_mov_b32 v69, v13
    v_mov_b32 v70, v13
    v_mov_b32 v71, v13
    v_mov_b32 v72, v13
    v_mov_b32 v73, v13
    v_mov_b32 v74, v13
    v_mov_b32 v75, v13
    v_mov_b32 v76, v13
    v_mov_b32 v77, v13
    v_mov_b32 v78, v13
    v_mov_b32 v79, v13
    s_cmp_ge_u32 s49, 5
    s_cbranch_scc1 L_ab_full
    v_mov_b32 v80, v13
    v_mov_b32 v81, v13
    v_mov_b32 v82, v13
    v_mov_b32 v83, v13
    v_mov_b32 v84, v13
    v_mov_b32 v85, v13
    v_mov_b32 v86, v13
    v_mov_b32 v87, v13
    v_mov_b32 v88, v13
    v_mov_b32 v89, v13
    v_mov_b32 v90, v13
    v_mov_b32 v91, v13
    v_mov_b32 v92, v13
    v_mov_b32 v93, v13
    v_mov_b32 v94, v13
    v_mov_b32 v95, v13
    s_cmp_ge_u32 s49, 4
    s_cbranch_scc1 L_ab_full
    v_mov_b32 v96, v13
    v_mov_b32 v97, v13
    v_mov_b32 v98, v13
    v_mov_b32 v99, v13
    v_mov_b32 v100, v13
    v_mov_b32 v101, v13
    v_mov_b32 v102, v13
    v_mov_b32 v103, v13
    v_mov_b32 v104, v13
    v_mov_b32 v105, v13
    v_mov_b32 v106, v13
    v_mov_b32 v107, v13
    v_mov_b32 v108, v13
    v_mov_b32 v109, v13
    v_mov_b32 v110, v13
    v_mov_b32 v111, v13
    s_cmp_ge_u32 s49, 3
    s_cbranch_scc1 L_ab_full
    v_mov_b32 v112, v13
    v_mov_b32 v113, v13
    v_mov_b32 v114, v13
    v_mov_b32 v115, v13
    v_mov_b32 v116, v13
    v_mov_b32 v117, v13
    v_mov_b32 v118, v13
    v_mov_b32 v119, v13
    v_mov_b32 v120, v13
    v_mov_b32 v121, v13
    v_mov_b32 v122, v13
    v_mov_b32 v123, v13
    v_mov_b32 v124, v13
    v_mov_b32 v125, v13
    v_mov_b32 v126, v13
    v_mov_b32 v127, v13
    s_cmp_ge_u32 s49, 2
    s_cbranch_scc1 L_ab_full
    v_mov_b32 v128, v13
    v_mov_b32 v129, v13
    v_mov_b32 v130, v13
    v_mov_b32 v131, v13
    v_mov_b32 v132, v13
    v_mov_b32 v133, v13
    v_mov_b32 v134, v13
    v_mov_b32 v135, v13
    v_mov_b32 v136, v13
    v_mov_b32 v137, v13
    v_mov_b32 v138, v13
    v_mov_b32 v139, v13
    v_mov_b32 v140, v13
    v_mov_b32 v141, v13
    v_mov_b32 v142, v13
    v_mov_b32 v143, v13
    s_cmp_ge_u32 s49, 1
    s_cbranch_scc1 L_ab_full
    v_mov_b32 v144, v13
    v_mov_b32 v145, v13
    v_mov_b32 v146, v13
    v_mov_b32 v147, v13
    v_mov_b32 v148, v13
    v_mov_b32 v149, v13
    v_mov_b32 v150, v13
    v_mov_b32 v151, v13
    v_mov_b32 v152, v13
    v_mov_b32 v153, v13
    v_mov_b32 v154, v13
    v_mov_b32 v155, v13
    v_mov_b32 v156, v13
    v_mov_b32 v157, v13
    v_mov_b32 v158, v13
    v_mov_b32 v159, v13
L_ab_full:
    v_max3_f32 v200, v32, v33, v34
    v_max3_f32 v201, v35, v36, v37
    v_max3_f32 v201, v201, v38, v39
    v_max3_f32 v200, v200, v40, v41
    v_max3_f32 v201, v201, v42, v43
    v_max3_f32 v200, v200, v44, v45
    v_max3_f32 v201, v201, v46, v47
    v_max3_f32 v200, v200, v48, v49
    v_max3_f32 v201, v201, v50, v51
    v_max3_f32 v200, v200, v52, v53
    v_max3_f32 v201, v201, v54, v55
    v_max3_f32 v200, v200, v56, v57
    v_max3_f32 v201, v201, v58, v59
    v_max3_f32 v200, v200, v60, v61
    v_max3_f32 v201, v201, v62, v63
    v_max3_f32 v200, v200, v64, v65
    v_max3_f32 v201, v201, v66, v67
    v_max3_f32 v200, v200, v68, v69
    v_max3_f32 v201, v201, v70, v71
    v_max3_f32 v200, v200, v72, v73
    v_max3_f32 v201, v201, v74, v75
    v_max3_f32 v200, v200, v76, v77
    v_max3_f32 v201, v201, v78, v79
    v_max3_f32 v200, v200, v80, v81
    v_max3_f32 v201, v201, v82, v83
    v_max3_f32 v200, v200, v84, v85
    v_max3_f32 v201, v201, v86, v87
    v_max3_f32 v200, v200, v88, v89
    v_max3_f32 v201, v201, v90, v91
    v_max3_f32 v200, v200, v92, v93
    v_max3_f32 v201, v201, v94, v95
    v_max3_f32 v200, v200, v96, v97
    v_max3_f32 v201, v201, v98, v99
    v_max3_f32 v200, v200, v100, v101
    v_max3_f32 v201, v201, v102, v103
    v_max3_f32 v200, v200, v104, v105
    v_max3_f32 v201, v201, v106, v107
    v_max3_f32 v200, v200, v108, v109
    v_max3_f32 v201, v201, v110, v111
    v_max3_f32 v200, v200, v112, v113
    v_max3_f32 v201, v201, v114, v115
    v_max3_f32 v200, v200, v116, v117
    v_max3_f32 v201, v201, v118, v119
    v_max3_f32 v200, v200, v120, v121
    v_max3_f32 v201, v201, v122, v123
    v_max3_f32 v200, v200, v124, v125
    v_max3_f32 v201, v201, v126, v127
    v_max3_f32 v200, v200, v128, v129
    v_max3_f32 v201, v201, v130, v131
    v_max3_f32 v200, v200, v132, v133
    v_max3_f32 v201, v201, v134, v135
    v_max3_f32 v200, v200, v136, v137
    v_max3_f32 v201, v201, v138, v139
    v_max3_f32 v200, v200, v140, v141
    v_max3_f32 v201, v201, v142, v143
    v_max3_f32 v200, v200, v144, v145
    v_max3_f32 v201, v201, v146, v147
    v_max3_f32 v200, v200, v148, v149
    v_max3_f32 v201, v201, v150, v151
    v_max3_f32 v200, v200, v152, v153
    v_max3_f32 v201, v201, v154, v155
    v_max3_f32 v200, v200, v156, v157
    v_max3_f32 v201, v201, v158, v159
    v_max3_f32 v200, v200, v160, v161
    v_max3_f32 v201, v201, v162, v163
    v_max3_f32 v200, v200, v164, v165
    v_max3_f32 v201, v201, v166, v167
    v_max3_f32 v200, v200, v168, v169
    v_max3_f32 v201, v201, v170, v171
    v_max3_f32 v200, v200, v172, v173
    v_max3_f32 v201, v201, v174, v175
    v_max_f32 v202, v200, v201
    v_max_f32 v203, v200, v201
    s_nop 1
    v_permlane32_swap_b32 v202, v203
    v_max_f32 v200, v202, v203
    v_mul_f32 v200, s51, v200
    s_min_u32 s35, s50, 63
    s_cmp_lt_u32 s35, s53
    s_cbranch_scc1 L_ab_ok_15
    s_mov_b32 s32, 262144
L_ab_p_14:
    buffer_load_dword v15, v14, s[4:7], s54 offen sc1
    s_sub_u32 s32, s32, 1
    s_cbranch_scc1 L_abort
    s_waitcnt vmcnt(0)
    v_readlane_b32 s33, v15, 0
    v_readlane_b32 s34, v15, 1
    v_readlane_b32 s53, v15, 2
    s_min_u32 s33, s33, s34
    s_min_u32 s53, s53, s33
    s_cmp_lt_u32 s35, s53
    s_cbranch_scc0 L_ab_p_14
L_ab_ok_15:
    s_lshl_b32 s52, s50, 5
    s_add_u32 s52, s52, s48
    s_lshl_b32 s52, s52, 11
    s_cmp_lt_u32 s50, 64
    s_cselect_b32 s52, s52, 268435456
    s_add_u32 s33, s52, 100663296
    buffer_load_dwordx4 v[176:179], v10, s[4:7], s33 offen offset:0 sc1
    buffer_load_dwordx4 v[180:183], v10, s[4:7], s33 offen offset:1024 sc1
    s_add_u32 s33, s52, 104333312
    s_cmp_ge_u32 s50, 8
    s_cselect_b32 s33, s33, 268435456
    buffer_load_dwordx4 a[0:3], v10, s[4:7], s33 offen offset:0 sc1
    buffer_load_dwordx4 a[4:7], v10, s[4:7], s33 offen offset:1024 sc1
    s_add_u32 s33, s52, 104398848
    s_cmp_ge_u32 s50, 7
    s_cselect_b32 s33, s33, 268435456
    buffer_load_dwordx4 a[8:11], v10, s[4:7], s33 offen offset:0 sc1
    buffer_load_dwordx4 a[12:15], v10, s[4:7], s33 offen offset:1024 sc1
    s_add_u32 s33, s52, 104464384
    s_cmp_ge_u32 s50, 6
    s_cselect_b32 s33, s33, 268435456
    buffer_load_dwordx4 a[16:19], v10, s[4:7], s33 offen offset:0 sc1
    buffer_load_dwordx4 a[20:23], v10, s[4:7], s33 offen offset:1024 sc1
    s_add_u32 s33, s52, 104529920
    s_cmp_ge_u32 s50, 5
    s_cselect_b32 s33, s33, 268435456
    buffer_load_dwordx4 a[24:27], v10, s[4:7], s33 offen offset:0 sc1
    buffer_load_dwordx4 a[28:31], v10, s[4:7], s33 offen offset:1024 sc1
    s_add_u32 s33, s52, 104595456
    s_cmp_ge_u32 s50, 4
    s_cselect_b32 s33, s33, 268435456
    buffer_load_dwordx4 a[32:35], v10, s[4:7], s33 offen offset:0 sc1
    buffer_load_dwordx4 a[36:39], v10, s[4:7], s33 offen offset:1024 sc1
    s_add_u32 s33, s52, 104660992
    s_cmp_ge_u32 s50, 3
    s_cselect_b32 s33, s33, 268435456
    buffer_load_dwordx4 a[40:43], v10, s[4:7], s33 offen offset:0 sc1
    buffer_load_dwordx4 a[44:47], v10, s[4:7], s33 offen offset:1024 sc1
    s_add_u32 s33, s52, 104726528
    s_cmp_ge_u32 s50, 2
    s_cselect_b32 s33, s33, 268435456
    buffer_load_dwordx4 a[48:51], v10, s[4:7], s33 offen offset:0 sc1
    buffer_load_dwordx4 a[52:55], v10, s[4:7], s33 offen offset:1024 sc1
    s_add_u32 s33, s52, 104792064
    s_cmp_ge_u32 s50, 1
    s_cselect_b32 s33, s33, 268435456
    buffer_load_dwordx4 a[56:59], v10, s[4:7], s33 offen offset:0 sc1
    buffer_load_dwordx4 a[60:63], v10, s[4:7], s33 offen offset:1024 sc1
    s_add_u32 s33, s52, 104857600
    s_cmp_ge_u32 s50, 0
    s_cselect_b32 s33, s33, 268435456
    buffer_load_dwordx4 a[64:67], v10, s[4:7], s33 offen offset:0 sc1
    buffer_load_dwordx4 a[68:71], v10, s[4:7], s33 offen offset:1024 sc1
    v_fma_f32 v32, v32, s51, -v200
    v_fma_f32 v33, v33, s51, -v200
    v_fma_f32 v34, v34, s51, -v200
    v_fma_f32 v35, v35, s51, -v200
    v_fma_f32 v36, v36, s51, -v200
    v_fma_f32 v37, v37, s51, -v200
    v_fma_f32 v38, v38, s51, -v200
    v_fma_f32 v39, v39, s51, -v200
    v_fma_f32 v40, v40, s51, -v200
    v_fma_f32 v41, v41, s51, -v200
    v_fma_f32 v42, v42, s51, -v200
    v_fma_f32 v43, v43, s51, -v200
    v_fma_f32 v44, v44, s51, -v200
    v_fma_f32 v45, v45, s51, -v200
    v_fma_f32 v46, v46, s51, -v200
    v_fma_f32 v47, v47, s51, -v200
    v_exp_f32 v32, v32
    v_exp_f32 v33, v33
    v_exp_f32 v34, v34
    v_exp_f32 v35, v35
    v_exp_f32 v36, v36
    v_exp_f32 v37, v37
    v_exp_f32 v38, v38
    v_exp_f32 v39, v39
    v_exp_f32 v40, v40
    v_exp_f32 v41, v41
    v_exp_f32 v42, v42
    v_exp_f32 v43, v43
    v_exp_f32 v44, v44
    v_exp_f32 v45, v45
    v_exp_f32 v46, v46
    v_exp_f32 v47, v47
    v_cvt_pk_bf16_f32 v32, v32, v33
    v_cvt_pk_bf16_f32 v33, v34, v35
    v_cvt_pk_bf16_f32 v34, v40, v41
    v_cvt_pk_bf16_f32 v35, v42, v43
    v_cvt_pk_bf16_f32 v36, v36, v37
    v_cvt_pk_bf16_f32 v37, v38, v39
    v_cvt_pk_bf16_f32 v38, v44, v45
    v_cvt_pk_bf16_f32 v39, v46, v47
    s_waitcnt vmcnt(37)
    v_mfma_f32_32x32x16_bf16 v[184:199], a[72:75], v[32:35], 0
    s_waitcnt vmcnt(36)
    v_mfma_f32_32x32x16_bf16 v[184:199], a[76:79], v[36:39], v[184:199]
    v_fma_f32 v48, v48, s51, -v200
    v_fma_f32 v49, v49, s51, -v200
    v_fma_f32 v50, v50, s51, -v200
    v_fma_f32 v51, v51, s51, -v200
    v_fma_f32 v52, v52, s51, -v200
    v_fma_f32 v53, v53, s51, -v200
    v_fma_f32 v54, v54, s51, -v200
    v_fma_f32 v55, v55, s51, -v200
    v_fma_f32 v56, v56, s51, -v200
    v_fma_f32 v57, v57, s51, -v200
    v_fma_f32 v58, v58, s51, -v200
    v_fma_f32 v59, v59, s51, -v200
    v_fma_f32 v60, v60, s51, -v200
    v_fma_f32 v61, v61, s51, -v200
    v_fma_f32 v62, v62, s51, -v200
    v_fma_f32 v63, v63, s51, -v200
    v_exp_f32 v48, v48
    v_exp_f32 v49, v49
    v_exp_f32 v50, v50
    v_exp_f32 v51, v51
    v_exp_f32 v52, v52
    v_exp_f32 v53, v53
    v_exp_f32 v54, v54
    v_exp_f32 v55, v55
    v_exp_f32 v56, v56
    v_exp_f32 v57, v57
    v_exp_f32 v58, v58
    v_exp_f32 v59, v59
    v_exp_f32 v60, v60
    v_exp_f32 v61, v61
    v_exp_f32 v62, v62
    v_exp_f32 v63, v63
    v_cvt_pk_bf16_f32 v48, v48, v49
    v_cvt_pk_bf16_f32 v49, v50, v51
    v_cvt_pk_bf16_f32 v50, v56, v57
    v_cvt_pk_bf16_f32 v51, v58, v59
    v_cvt_pk_bf16_f32 v52, v52, v53
    v_cvt_pk_bf16_f32 v53, v54, v55
    v_cvt_pk_bf16_f32 v54, v60, v61
    v_cvt_pk_bf16_f32 v55, v62, v63
    s_waitcnt vmcnt(35)
    v_mfma_f32_32x32x16_bf16 v[184:199], a[80:83], v[48:51], v[184:199]
    s_waitcnt vmcnt(34)
    v_mfma_f32_32x32x16_bf16 v[184:199], a[84:87], v[52:55], v[184:199]
    v_fma_f32 v64, v64, s51, -v200
    v_fma_f32 v65, v65, s51, -v200
    v_fma_f32 v66, v66, s51, -v200
    v_fma_f32 v67, v67, s51, -v200
    v_fma_f32 v68, v68, s51, -v200
    v_fma_f32 v69, v69, s51, -v200
    v_fma_f32 v70, v70, s51, -v200
    v_fma_f32 v71, v71, s51, -v200
    v_fma_f32 v72, v72, s51, -v200
    v_fma_f32 v73, v73, s51, -v200
    v_fma_f32 v74, v74, s51, -v200
    v_fma_f32 v75, v75, s51, -v200
    v_fma_f32 v76, v76, s51, -v200
    v_fma_f32 v77, v77, s51, -v200
    v_fma_f32 v78, v78, s51, -v200
    v_fma_f32 v79, v79, s51, -v200
    v_exp_f32 v64, v64
    v_exp_f32 v65, v65
    v_exp_f32 v66, v66
    v_exp_f32 v67, v67
    v_exp_f32 v68, v68
    v_exp_f32 v69, v69
    v_exp_f32 v70, v70
    v_exp_f32 v71, v71
    v_exp_f32 v72, v72
    v_exp_f32 v73, v73
    v_exp_f32 v74, v74
    v_exp_f32 v75, v75
    v_exp_f32 v76, v76
    v_exp_f32 v77, v77
    v_exp_f32 v78, v78
    v_exp_f32 v79, v79
    v_cvt_pk_bf16_f32 v64, v64, v65
    v_cvt_pk_bf16_f32 v65, v66, v67
    v_cvt_pk_bf16_f32 v66, v72, v73
    v_cvt_pk_bf16_f32 v67, v74, v75
    v_cvt_pk_bf16_f32 v68, v68, v69
    v_cvt_pk_bf16_f32 v69, v70, v71
    v_cvt_pk_bf16_f32 v70, v76, v77
    v_cvt_pk_bf16_f32 v71, v78, v79
    s_waitcnt vmcnt(33)
    v_mfma_f32_32x32x16_bf16 v[184:199], a[88:91], v[64:67], v[184:199]
    s_waitcnt vmcnt(32)
    v_mfma_f32_32x32x16_bf16 v[184:199], a[92:95], v[68:71], v[184:199]
    v_fma_f32 v80, v80, s51, -v200
    v_fma_f32 v81, v81, s51, -v200
    v_fma_f32 v82, v82, s51, -v200
    v_fma_f32 v83, v83, s51, -v200
    v_fma_f32 v84, v84, s51, -v200
    v_fma_f32 v85, v85, s51, -v200
    v_fma_f32 v86, v86, s51, -v200
    v_fma_f32 v87, v87, s51, -v200
    v_fma_f32 v88, v88, s51, -v200
    v_fma_f32 v89, v89, s51, -v200
    v_fma_f32 v90, v90, s51, -v200
    v_fma_f32 v91, v91, s51, -v200
    v_fma_f32 v92, v92, s51, -v200
    v_fma_f32 v93, v93, s51, -v200
    v_fma_f32 v94, v94, s51, -v200
    v_fma_f32 v95, v95, s51, -v200
    v_exp_f32 v80, v80
    v_exp_f32 v81, v81
    v_exp_f32 v82, v82
    v_exp_f32 v83, v83
    v_exp_f32 v84, v84
    v_exp_f32 v85, v85
    v_exp_f32 v86, v86
    v_exp_f32 v87, v87
    v_exp_f32 v88, v88
    v_exp_f32 v89, v89
    v_exp_f32 v90, v90
    v_exp_f32 v91, v91
    v_exp_f32 v92, v92
    v_exp_f32 v93, v93
    v_exp_f32 v94, v94
    v_exp_f32 v95, v95
    v_cvt_pk_bf16_f32 v80, v80, v81
    v_cvt_pk_bf16_f32 v81, v82, v83
    v_cvt_pk_bf16_f32 v82, v88, v89
    v_cvt_pk_bf16_f32 v83, v90, v91
    v_cvt_pk_bf16_f32 v84, v84, v85
    v_cvt_pk_bf16_f32 v85, v86, v87
    v_cvt_pk_bf16_f32 v86, v92, v93
    v_cvt_pk_bf16_f32 v87, v94, v95
    s_waitcnt vmcnt(31)
    v_mfma_f32_32x32x16_bf16 v[184:199], a[96:99], v[80:83], v[184:199]
    s_waitcnt vmcnt(30)
    v_mfma_f32_32x32x16_bf16 v[184:199], a[100:103], v[84:87], v[184:199]
    v_fma_f32 v96, v96, s51, -v200
    v_fma_f32 v97, v97, s51, -v200
    v_fma_f32 v98, v98, s51, -v200
    v_fma_f32 v99, v99, s51, -v200
    v_fma_f32 v100, v100, s51, -v200
    v_fma_f32 v101, v101, s51, -v200
    v_fma_f32 v102, v102, s51, -v200
    v_fma_f32 v103, v103, s51, -v200
    v_fma_f32 v104, v104, s51, -v200
    v_fma_f32 v105, v105, s51, -v200
    v_fma_f32 v106, v106, s51, -v200
    v_fma_f32 v107, v107, s51, -v200
    v_fma_f32 v108, v108, s51, -v200
    v_fma_f32 v109, v109, s51, -v200
    v_fma_f32 v110, v110, s51, -v200
    v_fma_f32 v111, v111, s51, -v200
    v_exp_f32 v96, v96
    v_exp_f32 v97, v97
    v_exp_f32 v98, v98
    v_exp_f32 v99, v99
    v_exp_f32 v100, v100
    v_exp_f32 v101, v101
    v_exp_f32 v102, v102
    v_exp_f32 v103, v103
    v_exp_f32 v104, v104
    v_exp_f32 v105, v105
    v_exp_f32 v106, v106
    v_exp_f32 v107, v107
    v_exp_f32 v108, v108
    v_exp_f32 v109, v109
    v_exp_f32 v110, v110
    v_exp_f32 v111, v111
    v_cvt_pk_bf16_f32 v96, v96, v97
    v_cvt_pk_bf16_f32 v97, v98, v99
    v_cvt_pk_bf16_f32 v98, v104, v105
    v_cvt_pk_bf16_f32 v99, v106, v107
    v_cvt_pk_bf16_f32 v100, v100, v101
    v_cvt_pk_bf16_f32 v101, v102, v103
    v_cvt_pk_bf16_f32 v102, v108, v109
    v_cvt_pk_bf16_f32 v103, v110, v111
    s_waitcnt vmcnt(29)
    v_mfma_f32_32x32x16_bf16 v[184:199], a[104:107], v[96:99], v[184:199]
    s_waitcnt vmcnt(28)
    v_mfma_f32_32x32x16_bf16 v[184:199], a[108:111], v[100:103], v[184:199]
    v_fma_f32 v112, v112, s51, -v200
    v_fma_f32 v113, v113, s51, -v200
    v_fma_f32 v114, v114, s51, -v200
    v_fma_f32 v115, v115, s51, -v200
    v_fma_f32 v116, v116, s51, -v200
    v_fma_f32 v117, v117, s51, -v200
    v_fma_f32 v118, v118, s51, -v200
    v_fma_f32 v119, v119, s51, -v200
    v_fma_f32 v120, v120, s51, -v200
    v_fma_f32 v121, v121, s51, -v200
    v_fma_f32 v122, v122, s51, -v200
    v_fma_f32 v123, v123, s51, -v200
    v_fma_f32 v124, v124, s51, -v200
    v_fma_f32 v125, v125, s51, -v200
    v_fma_f32 v126, v126, s51, -v200
    v_fma_f32 v127, v127, s51, -v200
    v_exp_f32 v112, v112
    v_exp_f32 v113, v113
    v_exp_f32 v114, v114
    v_exp_f32 v115, v115
    v_exp_f32 v116, v116
    v_exp_f32 v117, v117
    v_exp_f32 v118, v118
    v_exp_f32 v119, v119
    v_exp_f32 v120, v120
    v_exp_f32 v121, v121
    v_exp_f32 v122, v122
    v_exp_f32 v123, v123
    v_exp_f32 v124, v124
    v_exp_f32 v125, v125
    v_exp_f32 v126, v126
    v_exp_f32 v127, v127
    v_cvt_pk_bf16_f32 v112, v112, v113
    v_cvt_pk_bf16_f32 v113, v114, v115
    v_cvt_pk_bf16_f32 v114, v120, v121
    v_cvt_pk_bf16_f32 v115, v122, v123
    v_cvt_pk_bf16_f32 v116, v116, v117
    v_cvt_pk_bf16_f32 v117, v118, v119
    v_cvt_pk_bf16_f32 v118, v124, v125
    v_cvt_pk_bf16_f32 v119, v126, v127
    s_waitcnt vmcnt(27)
    v_mfma_f32_32x32x16_bf16 v[184:199], a[112:115], v[112:115], v[184:199]
    s_waitcnt vmcnt(26)
    v_mfma_f32_32x32x16_bf16 v[184:199], a[116:119], v[116:119], v[184:199]
    v_fma_f32 v128, v128, s51, -v200
    v_fma_f32 v129, v129, s51, -v200
    v_fma_f32 v130, v130, s51, -v200
    v_fma_f32 v131, v131, s51, -v200
    v_fma_f32 v132, v132, s51, -v200
    v_fma_f32 v133, v133, s51, -v200
    v_fma_f32 v134, v134, s51, -v200
    v_fma_f32 v135, v135, s51, -v200
    v_fma_f32 v136, v136, s51, -v200
    v_fma_f32 v137, v137, s51, -v200
    v_fma_f32 v138, v138, s51, -v200
    v_fma_f32 v139, v139, s51, -v200
    v_fma_f32 v140, v140, s51, -v200
    v_fma_f32 v141, v141, s51, -v200
    v_fma_f32 v142, v142, s51, -v200
    v_fma_f32 v143, v143, s51, -v200
    v_exp_f32 v128, v128
    v_exp_f32 v129, v129
    v_exp_f32 v130, v130
    v_exp_f32 v131, v131
    v_exp_f32 v132, v132
    v_exp_f32 v133, v133
    v_exp_f32 v134, v134
    v_exp_f32 v135, v135
    v_exp_f32 v136, v136
    v_exp_f32 v137, v137
    v_exp_f32 v138, v138
    v_exp_f32 v139, v139
    v_exp_f32 v140, v140
    v_exp_f32 v141, v141
    v_exp_f32 v142, v142
    v_exp_f32 v143, v143
    v_cvt_pk_bf16_f32 v128, v128, v129
    v_cvt_pk_bf16_f32 v129, v130, v131
    v_cvt_pk_bf16_f32 v130, v136, v137
    v_cvt_pk_bf16_f32 v131, v138, v139
    v_cvt_pk_bf16_f32 v132, v132, v133
    v_cvt_pk_bf16_f32 v133, v134, v135
    v_cvt_pk_bf16_f32 v134, v140, v141
    v_cvt_pk_bf16_f32 v135, v142, v143
    s_waitcnt vmcnt(25)
    v_mfma_f32_32x32x16_bf16 v[184:199], a[120:123], v[128:131], v[184:199]
    s_waitcnt vmcnt(24)
    v_mfma_f32_32x32x16_bf16 v[184:199], a[124:127], v[132:135], v[184:199]
    v_fma_f32 v144, v144, s51, -v200
    v_fma_f32 v145, v145, s51, -v200
    v_fma_f32 v146, v146, s51, -v200
    v_fma_f32 v147, v147, s51, -v200
    v_fma_f32 v148, v148, s51, -v200
    v_fma_f32 v149, v149, s51, -v200
    v_fma_f32 v150, v150, s51, -v200
    v_fma_f32 v151, v151, s51, -v200
    v_fma_f32 v152, v152, s51, -v200
    v_fma_f32 v153, v153, s51, -v200
    v_fma_f32 v154, v154, s51, -v200
    v_fma_f32 v155, v155, s51, -v200
    v_fma_f32 v156, v156, s51, -v200
    v_fma_f32 v157, v157, s51, -v200
    v_fma_f32 v158, v158, s51, -v200
    v_fma_f32 v159, v159, s51, -v200
    v_exp_f32 v144, v144
    v_exp_f32 v145, v145
    v_exp_f32 v146, v146
    v_exp_f32 v147, v147
    v_exp_f32 v148, v148
    v_exp_f32 v149, v149
    v_exp_f32 v150, v150
    v_exp_f32 v151, v151
    v_exp_f32 v152, v152
    v_exp_f32 v153, v153
    v_exp_f32 v154, v154
    v_exp_f32 v155, v155
    v_exp_f32 v156, v156
    v_exp_f32 v157, v157
    v_exp_f32 v158, v158
    v_exp_f32 v159, v159
    v_cvt_pk_bf16_f32 v144, v144, v145
    v_cvt_pk_bf16_f32 v145, v146, v147
    v_cvt_pk_bf16_f32 v146, v152, v153
    v_cvt_pk_bf16_f32 v147, v154, v155
    v_cvt_pk_bf16_f32 v148, v148, v149
    v_cvt_pk_bf16_f32 v149, v150, v151
    v_cvt_pk_bf16_f32 v150, v156, v157
    v_cvt_pk_bf16_f32 v151, v158, v159
    s_waitcnt vmcnt(23)
    v_mfma_f32_32x32x16_bf16 v[184:199], a[128:131], v[144:147], v[184:199]
    s_waitcnt vmcnt(22)
    v_mfma_f32_32x32x16_bf16 v[184:199], a[132:135], v[148:151], v[184:199]
    v_fma_f32 v160, v160, s51, -v200
    v_fma_f32 v161, v161, s51, -v200
    v_fma_f32 v162, v162, s51, -v200
    v_fma_f32 v163, v163, s51, -v200
    v_fma_f32 v164, v164, s51, -v200
    v_fma_f32 v165, v165, s51, -v200
    v_fma_f32 v166, v166, s51, -v200
    v_fma_f32 v167, v167, s51, -v200
    v_fma_f32 v168, v168, s51, -v200
    v_fma_f32 v169, v169, s51, -v200
    v_fma_f32 v170, v170, s51, -v200
    v_fma_f32 v171, v171, s51, -v200
    v_fma_f32 v172, v172, s51, -v200
    v_fma_f32 v173, v173, s51, -v200
    v_fma_f32 v174, v174, s51, -v200
    v_fma_f32 v175, v175, s51, -v200
    v_exp_f32 v160, v160
    v_exp_f32 v161, v161
    v_exp_f32 v162, v162
    v_exp_f32 v163, v163
    v_exp_f32 v164, v164
    v_exp_f32 v165, v165
    v_exp_f32 v166, v166
    v_exp_f32 v167, v167
    v_exp_f32 v168, v168
    v_exp_f32 v169, v169
    v_exp_f32 v170, v170
    v_exp_f32 v171, v171
    v_exp_f32 v172, v172
    v_exp_f32 v173, v173
    v_exp_f32 v174, v174
    v_exp_f32 v175, v175
    v_cvt_pk_bf16_f32 v160, v160, v161
    v_cvt_pk_bf16_f32 v161, v162, v163
    v_cvt_pk_bf16_f32 v162, v168, v169
    v_cvt_pk_bf16_f32 v163, v170, v171
    v_cvt_pk_bf16_f32 v164, v164, v165
    v_cvt_pk_bf16_f32 v165, v166, v167
    v_cvt_pk_bf16_f32 v166, v172, v173
    v_cvt_pk_bf16_f32 v167, v174, v175
    s_waitcnt vmcnt(21)
    v_mfma_f32_32x32x16_bf16 v[184:199], a[136:139], v[160:163], v[184:199]
    s_waitcnt vmcnt(20)
    v_mfma_f32_32x32x16_bf16 v[184:199], a[140:143], v[164:167], v[184:199]
    s_mul_i32 s33, s49, 40960
    s_mul_i32 s34, s48, 40
    s_add_u32 s33, s33, s34
    s_add_u32 s33, s33, 113246208
    s_nop 7
    v_rcp_f32 v200, v196
    s_nop 0
    v_mul_f32 v184, v184, v200
    v_mul_f32 v185, v185, v200
    v_mul_f32 v186, v186, v200
    v_mul_f32 v187, v187, v200
    v_mul_f32 v188, v188, v200
    v_mul_f32 v189, v189, v200
    v_mul_f32 v190, v190, v200
    v_mul_f32 v191, v191, v200
    v_mul_f32 v192, v192, v200
    v_mul_f32 v193, v193, v200
    v_mul_f32 v194, v194, v200
    v_mul_f32 v195, v195, v200
    v_cvt_pk_bf16_f32 v204, v184, v185
    v_cvt_pk_bf16_f32 v205, v186, v187
    v_cvt_pk_bf16_f32 v206, v188, v189
    v_cvt_pk_bf16_f32 v207, v190, v191
    v_cvt_pk_bf16_f32 v208, v192, v193
    v_cvt_pk_bf16_f32 v209, v194, v195
    buffer_store_dwordx2 v[204:205], v12, s[4:7], s33 offen offset:0 sc1
    buffer_store_dwordx2 v[206:207], v12, s[4:7], s33 offen offset:16 sc1
    s_mov_b32 exec_hi, 0
    buffer_store_dwordx2 v[208:209], v12, s[4:7], s33 offen offset:32 sc1
    s_mov_b32 exec_hi, -1
    s_add_u32 s49, s49, 15
    s_cmp_lt_u32 s49, 64
    s_cbranch_scc1 L_ab_job
    s_waitcnt vmcnt(0)
    s_barrier
    v_mbcnt_lo_u32_b32 v14, -1, 0
    v_mbcnt_hi_u32_b32 v14, -1, v14
    v_or_b32 v14, s3, v14
    v_cmp_eq_u32 vcc, 0, v14
    v_mov_b32 v14, 0x1000
    v_mov_b32 v15, 208
    v_cndmask_b32 v14, v14, v15, vcc
    v_mov_b32 v15, 1
    buffer_atomic_add v15, v14, s[16:19], 0 offen
    s_cmp_ge_u32 s21, 110
    s_cbranch_scc1 L_b_done
    s_mul_i32 s50, s21, 205
    s_lshr_b32 s50, s50, 10
    s_mul_i32 s33, s50, 5
    s_sub_u32 s51, s21, s33
    s_load_dwordx2 s[8:9], s[0:1], 72
    s_mov_b32 s10, 819200
    s_mov_b32 s11, 0x20000
    s_load_dwordx2 s[24:25], s[0:1], 80
    s_mov_b32 s26, 5242880
    s_mov_b32 s27, 0x20000
    s_lshl_b32 s37, s51, 8
    s_lshl_b32 s33, s3, 6
    s_add_u32 s37, s37, s33
    s_mov_b32 s47, 0
    v_mbcnt_lo_u32_b32 v10, -1, 0
    v_mbcnt_hi_u32_b32 v10, -1, v10
    v_lshrrev_b32 v11, 2, v10
    v_mul_u32_u24 v11, 1280, v11
    v_and_b32 v12, 3, v10
    v_lshl_add_u32 v13, v12, 4, v11
    s_mul_i32 s45, s3, 40960
    s_waitcnt lgkmcnt(0)
    s_barrier
    s_add_u32 m0, s45, 0
    s_add_u32 s33, s37, 0
    buffer_load_dwordx4 v13, s[8:11], s33 offen lds
    s_add_u32 m0, s45, 1024
    s_add_u32 s33, s37, 20480
    buffer_load_dwordx4 v13, s[8:11], s33 offen lds
    s_add_u32 m0, s45, 2048
    s_add_u32 s33, s37, 40960
    buffer_load_dwordx4 v13, s[8:11], s33 offen lds
    s_add_u32 m0, s45, 3072
    s_add_u32 s33, s37, 61440
    buffer_load_dwordx4 v13, s[8:11], s33 offen lds
    s_add_u32 m0, s45, 4096
    s_add_u32 s33, s37, 81920
    buffer_load_dwordx4 v13, s[8:11], s33 offen lds
    s_add_u32 m0, s45, 5120
    s_add_u32 s33, s37, 102400
    buffer_load_dwordx4 v13, s[8:11], s33 offen lds
    s_add_u32 m0, s45, 6144
    s_add_u32 s33, s37, 122880
    buffer_load_dwordx4 v13, s[8:11], s33 offen lds
    s_add_u32 m0, s45, 7168
    s_add_u32 s33, s37, 143360
    buffer_load_dwordx4 v13, s[8:11], s33 offen lds
    s_add_u32 m0, s45, 8192
    s_add_u32 s33, s37, 163840
    buffer_load_dwordx4 v13, s[8:11], s33 offen lds
    s_add_u32 m0, s45, 9216
    s_add_u32 s33, s37, 184320
    buffer_load_dwordx4 v13, s[8:11], s33 offen lds
    s_add_u32 m0, s45, 10240
    s_add_u32 s33, s37, 204800
    buffer_load_dwordx4 v13, s[8:11], s33 offen lds
    s_add_u32 m0, s45, 11264
    s_add_u32 s33, s37, 225280
    buffer_load_dwordx4 v13, s[8:11], s33 offen lds
    s_add_u32 m0, s45, 12288
    s_add_u32 s33, s37, 245760
    buffer_load_dwordx4 v13, s[8:11], s33 offen lds
    s_add_u32 m0, s45, 13312
    s_add_u32 s33, s37, 266240
    buffer_load_dwordx4 v13, s[8:11], s33 offen lds
    s_add_u32 m0, s45, 14336
    s_add_u32 s33, s37, 286720
    buffer_load_dwordx4 v13, s[8:11], s33 offen lds
    s_add_u32 m0, s45, 15360
    s_add_u32 s33, s37, 307200
    buffer_load_dwordx4 v13, s[8:11], s33 offen lds
    s_add_u32 m0, s45, 16384
    s_add_u32 s33, s37, 327680
    buffer_load_dwordx4 v13, s[8:11], s33 offen lds
    s_add_u32 m0, s45, 17408
    s_add_u32 s33, s37, 348160
    buffer_load_dwordx4 v13, s[8:11], s33 offen lds
    s_add_u32 m0, s45, 18432
    s_add_u32 s33, s37, 368640
    buffer_load_dwordx4 v13, s[8:11], s33 offen lds
    s_add_u32 m0, s45, 19456
    s_add_u32 s33, s37, 389120
    buffer_load_dwordx4 v13, s[8:11], s33 offen lds
    s_add_u32 m0, s45, 20480
    s_add_u32 s33, s37, 409600
    buffer_load_dwordx4 v13, s[8:11], s33 offen lds
    s_add_u32 m0, s45, 21504
    s_add_u32 s33, s37, 430080
    buffer_load_dwordx4 v13, s[8:11], s33 offen lds
    s_add_u32 m0, s45, 22528
    s_add_u32 s33, s37, 450560
    buffer_load_dwordx4 v13, s[8:11], s33 offen lds
    s_add_u32 m0, s45, 23552
    s_add_u32 s33, s37, 471040
    buffer_load_dwordx4 v13, s[8:11], s33 offen lds
    s_add_u32 m0, s45, 24576
    s_add_u32 s33, s37, 491520
    buffer_load_dwordx4 v13, s[8:11], s33 offen lds
    s_add_u32 m0, s45, 25600
    s_add_u32 s33, s37, 512000
    buffer_load_dwordx4 v13, s[8:11], s33 offen lds
    s_add_u32 m0, s45, 26624
    s_add_u32 s33, s37, 532480
    buffer_load_dwordx4 v13, s[8:11], s33 offen lds
    s_add_u32 m0, s45, 27648
    s_add_u32 s33, s37, 552960
    buffer_load_dwordx4 v13, s[8:11], s33 offen lds
    s_add_u32 m0, s45, 28672
    s_add_u32 s33, s37, 573440
    buffer_load_dwordx4 v13, s[8:11], s33 offen lds
    s_add_u32 m0, s45, 29696
    s_add_u32 s33, s37, 593920
    buffer_load_dwordx4 v13, s[8:11], s33 offen lds
    s_add_u32 m0, s45, 30720
    s_add_u32 s33, s37, 614400
    buffer_load_dwordx4 v13, s[8:11], s33 offen lds
    s_add_u32 m0, s45, 31744
    s_add_u32 s33, s37, 634880
    buffer_load_dwordx4 v13, s[8:11], s33 offen lds
    s_add_u32 m0, s45, 32768
    s_add_u32 s33, s37, 655360
    buffer_load_dwordx4 v13, s[8:11], s33 offen lds
    s_add_u32 m0, s45, 33792
    s_add_u32 s33, s37, 675840
    buffer_load_dwordx4 v13, s[8:11], s33 offen lds
    s_add_u32 m0, s45, 34816
    s_add_u32 s33, s37, 696320
    buffer_load_dwordx4 v13, s[8:11], s33 offen lds
    s_add_u32 m0, s45, 35840
    s_add_u32 s33, s37, 716800
    buffer_load_dwordx4 v13, s[8:11], s33 offen lds
    s_add_u32 m0, s45, 36864
    s_add_u32 s33, s37, 737280
    buffer_load_dwordx4 v13, s[8:11], s33 offen lds
    s_add_u32 m0, s45, 37888
    s_add_u32 s33, s37, 757760
    buffer_load_dwordx4 v13, s[8:11], s33 offen lds
    s_add_u32 m0, s45, 38912
    s_add_u32 s33, s37, 778240
    buffer_load_dwordx4 v13, s[8:11], s33 offen lds
    s_add_u32 m0, s45, 39936
    s_add_u32 s33, s37, 798720
    buffer_load_dwordx4 v13, s[8:11], s33 offen lds
    v_lshrrev_b32 v11, 5, v10
    v_bfe_u32 v12, v10, 2, 2
    v_lshl_add_u32 v11, v11, 3, v12
    v_lshlrev_b32 v11, 6, v11
    v_bfe_u32 v12, v10, 4, 1
    v_lshl_add_u32 v11, v12, 5, v11
    v_and_b32 v12, 3, v10
    v_lshl_add_u32 v11, v12, 3, v11
    s_add_u32 s33, s45, s47
    v_add_u32 v14, s33, v11
    s_waitcnt vmcnt(39)
    ds_read_b64_tr_b16 v[96:97], v14 offset:0
    ds_read_b64_tr_b16 v[98:99], v14 offset:256
    s_waitcnt vmcnt(38)
    ds_read_b64_tr_b16 v[100:101], v14 offset:1024
    ds_read_b64_tr_b16 v[102:103], v14 offset:1280
    s_waitcnt vmcnt(37)
    ds_read_b64_tr_b16 v[104:105], v14 offset:2048
    ds_read_b64_tr_b16 v[106:107], v14 offset:2304
    s_waitcnt vmcnt(36)
    ds_read_b64_tr_b16 v[108:109], v14 offset:3072
    ds_read_b64_tr_b16 v[110:111], v14 offset:3328
    s_waitcnt vmcnt(35)
    ds_read_b64_tr_b16 v[112:113], v14 offset:4096
    ds_read_b64_tr_b16 v[114:115], v14 offset:4352
    s_waitcnt vmcnt(34)
    ds_read_b64_tr_b16 v[116:117], v14 offset:5120
    ds_read_b64_tr_b16 v[118:119], v14 offset:5376
    s_waitcnt vmcnt(33)
    ds_read_b64_tr_b16 v[120:121], v14 offset:6144
    ds_read_b64_tr_b16 v[122:123], v14 offset:6400
    s_waitcnt vmcnt(32)
    ds_read_b64_tr_b16 v[124:125], v14 offset:7168
    ds_read_b64_tr_b16 v[126:127], v14 offset:7424
    s_waitcnt vmcnt(31)
    ds_read_b64_tr_b16 v[128:129], v14 offset:8192
    ds_read_b64_tr_b16 v[130:131], v14 offset:8448
    s_waitcnt vmcnt(30)
    ds_read_b64_tr_b16 v[132:133], v14 offset:9216
    ds_read_b64_tr_b16 v[134:135], v14 offset:9472
    s_waitcnt vmcnt(29)
    ds_read_b64_tr_b16 v[136:137], v14 offset:10240
    ds_read_b64_tr_b16 v[138:139], v14 offset:10496
    s_waitcnt vmcnt(28)
    ds_read_b64_tr_b16 v[140:141], v14 offset:11264
    ds_read_b64_tr_b16 v[142:143], v14 offset:11520
    s_waitcnt vmcnt(27)
    ds_read_b64_tr_b16 v[144:145], v14 offset:12288
    ds_read_b64_tr_b16 v[146:147], v14 offset:12544
    s_waitcnt vmcnt(26)
    ds_read_b64_tr_b16 v[148:149], v14 offset:13312
    ds_read_b64_tr_b16 v[150:151], v14 offset:13568
    s_waitcnt vmcnt(25)
    ds_read_b64_tr_b16 v[152:153], v14 offset:14336
    ds_read_b64_tr_b16 v[154:155], v14 offset:14592
    s_waitcnt vmcnt(24)
    ds_read_b64_tr_b16 v[156:157], v14 offset:15360
    ds_read_b64_tr_b16 v[158:159], v14 offset:15616
    s_waitcnt vmcnt(23)
    ds_read_b64_tr_b16 v[160:161], v14 offset:16384
    ds_read_b64_tr_b16 v[162:163], v14 offset:16640
    s_waitcnt vmcnt(22)
    ds_read_b64_tr_b16 v[164:165], v14 offset:17408
    ds_read_b64_tr_b16 v[166:167], v14 offset:17664
    s_waitcnt vmcnt(21)
    ds_read_b64_tr_b16 v[168:169], v14 offset:18432
    ds_read_b64_tr_b16 v[170:171], v14 offset:18688
    s_waitcnt vmcnt(20)
    ds_read_b64_tr_b16 v[172:173], v14 offset:19456
    ds_read_b64_tr_b16 v[174:175], v14 offset:19712
    s_waitcnt vmcnt(19)
    ds_read_b64_tr_b16 v[176:177], v14 offset:20480
    ds_read_b64_tr_b16 v[178:179], v14 offset:20736
    s_waitcnt vmcnt(18)
    ds_read_b64_tr_b16 v[180:181], v14 offset:21504
    ds_read_b64_tr_b16 v[182:183], v14 offset:21760
    s_waitcnt vmcnt(17)
    ds_read_b64_tr_b16 v[184:185], v14 offset:22528
    ds_read_b64_tr_b16 v[186:187], v14 offset:22784
    s_waitcnt vmcnt(16)
    ds_read_b64_tr_b16 v[188:189], v14 offset:23552
    ds_read_b64_tr_b16 v[190:191], v14 offset:23808
    s_waitcnt vmcnt(15)
    ds_read_b64_tr_b16 v[192:193], v14 offset:24576
    ds_read_b64_tr_b16 v[194:195], v14 offset:24832
    s_waitcnt vmcnt(14)
    ds_read_b64_tr_b16 v[196:197], v14 offset:25600
    ds_read_b64_tr_b16 v[198:199], v14 offset:25856
    s_waitcnt vmcnt(13)
    ds_read_b64_tr_b16 v[200:201], v14 offset:26624
    ds_read_b64_tr_b16 v[202:203], v14 offset:26880
    s_waitcnt vmcnt(12)
    ds_read_b64_tr_b16 v[204:205], v14 offset:27648
    ds_read_b64_tr_b16 v[206:207], v14 offset:27904
    s_waitcnt vmcnt(11)
    ds_read_b64_tr_b16 v[208:209], v14 offset:28672
    ds_read_b64_tr_b16 v[210:211], v14 offset:28928
    s_waitcnt vmcnt(10)
    ds_read_b64_tr_b16 v[212:213], v14 offset:29696
    ds_read_b64_tr_b16 v[214:215], v14 offset:29952
    s_waitcnt vmcnt(9)
    ds_read_b64_tr_b16 v[216:217], v14 offset:30720
    ds_read_b64_tr_b16 v[218:219], v14 offset:30976
    s_waitcnt vmcnt(8)
    ds_read_b64_tr_b16 v[220:221], v14 offset:31744
    ds_read_b64_tr_b16 v[222:223], v14 offset:32000
    s_waitcnt vmcnt(7)
    ds_read_b64_tr_b16 v[224:225], v14 offset:32768
    ds_read_b64_tr_b16 v[226:227], v14 offset:33024
    s_waitcnt vmcnt(6)
    ds_read_b64_tr_b16 v[228:229], v14 offset:33792
    ds_read_b64_tr_b16 v[230:231], v14 offset:34048
    s_waitcnt vmcnt(5)
    ds_read_b64_tr_b16 v[232:233], v14 offset:34816
    ds_read_b64_tr_b16 v[234:235], v14 offset:35072
    s_waitcnt vmcnt(4)
    ds_read_b64_tr_b16 v[236:237], v14 offset:35840
    ds_read_b64_tr_b16 v[238:239], v14 offset:36096
    s_waitcnt vmcnt(3)
    ds_read_b64_tr_b16 v[240:241], v14 offset:36864
    ds_read_b64_tr_b16 v[242:243], v14 offset:37120
    s_waitcnt vmcnt(2)
    ds_read_b64_tr_b16 v[244:245], v14 offset:37888
    ds_read_b64_tr_b16 v[246:247], v14 offset:38144
    s_waitcnt vmcnt(1)
    ds_read_b64_tr_b16 v[248:249], v14 offset:38912
    ds_read_b64_tr_b16 v[250:251], v14 offset:39168
    s_waitcnt vmcnt(0)
    ds_read_b64_tr_b16 v[252:253], v14 offset:39936
    ds_read_b64_tr_b16 v[254:255], v14 offset:40192
    s_waitcnt lgkmcnt(0)
    s_barrier
    s_mov_b32 s32, 262144
L_aw_16:
    buffer_load_dword v14, off, s[16:19], 0 offset:208 sc1
    s_sub_u32 s32, s32, 1
    s_cbranch_scc1 L_abort
    s_waitcnt vmcnt(0)
    v_readfirstlane_b32 s33, v14
    s_sleep 4
    s_cmp_lt_u32 s33, 120
    s_cbranch_scc1 L_aw_16
    s_mul_i32 s38, s50, 122880
    s_add_u32 s38, s38, 113246208
    s_mul_i32 s33, s50, 3
    s_sub_u32 s40, 64, s33
    s_min_u32 s40, s40, 3
    s_mul_i32 s39, s50, 245760
    s_add_u32 s39, s39, s37
    s_add_u32 s39, s39, 1280
    v_mbcnt_lo_u32_b32 v10, -1, 0
    v_mbcnt_hi_u32_b32 v10, -1, v10
    v_and_b32 v11, 31, v10
    v_mul_u32_u24 v11, 2560, v11
    v_lshrrev_b32 v12, 5, v10
    v_lshl_add_u32 v9, v12, 3, v11
    v_mbcnt_lo_u32_b32 v10, -1, 0
    v_mbcnt_hi_u32_b32 v10, -1, v10
    v_lshrrev_b32 v11, 3, v10
    s_lshl_b32 s33, s3, 3
    v_add_u32 v11, s33, v11
    v_lshrrev_b32 v12, 1, v11
    v_xor_b32 v12, v12, v10
    v_and_b32 v12, 7, v12
    v_mul_u32_u24 v11, 1280, v11
    v_lshl_add_u32 v13, v12, 4, v11
    v_bfe_u32 v11, v10, 3, 2
    v_mul_u32_u24 v11, 10240, v11
    v_and_b32 v12, 7, v10
    v_lshl_add_u32 v11, v12, 7, v11
    v_bfe_u32 v12, v10, 1, 3
    v_lshrrev_b32 v15, 5, v10
    v_xor_b32 v12, v12, v15
    v_xor_b32 v15, 0, v12
    v_lshl_add_u32 v16, v15, 4, v11
    v_mov_b32 v20, v16
    v_xor_b32 v15, 2, v12
    v_lshl_add_u32 v17, v15, 4, v11
    v_mov_b32 v21, v17
    v_xor_b32 v15, 4, v12
    v_lshl_add_u32 v18, v15, 4, v11
    v_mov_b32 v22, v18
    v_xor_b32 v15, 6, v12
    v_lshl_add_u32 v19, v15, 4, v11
    v_mov_b32 v23, v19
    s_mul_i32 s45, s3, 10240
    s_add_u32 s43, s45, 0
    s_add_u32 m0, s43, 0
    s_nop 0
    buffer_load_dwordx4 v13, s[4:7], s38 offen offset:0 sc1 lds
    s_add_u32 m0, s43, 896
    s_nop 0
    buffer_load_dwordx4 v13, s[4:7], s38 offen offset:128 sc1 lds
    s_add_u32 m0, s43, 1792
    s_nop 0
    buffer_load_dwordx4 v13, s[4:7], s38 offen offset:256 sc1 lds
    s_add_u32 m0, s43, 2688
    s_nop 0
    buffer_load_dwordx4 v13, s[4:7], s38 offen offset:384 sc1 lds
    s_add_u32 m0, s43, 3584
    s_nop 0
    buffer_load_dwordx4 v13, s[4:7], s38 offen offset:512 sc1 lds
    s_add_u32 m0, s43, 4480
    s_nop 0
    buffer_load_dwordx4 v13, s[4:7], s38 offen offset:640 sc1 lds
    s_add_u32 m0, s43, 5376
    s_nop 0
    buffer_load_dwordx4 v13, s[4:7], s38 offen offset:768 sc1 lds
    s_add_u32 m0, s43, 6272
    s_nop 0
    buffer_load_dwordx4 v13, s[4:7], s38 offen offset:896 sc1 lds
    s_add_u32 m0, s43, 7168
    s_nop 0
    buffer_load_dwordx4 v13, s[4:7], s38 offen offset:1024 sc1 lds
    s_add_u32 m0, s43, 8064
    s_nop 0
    buffer_load_dwordx4 v13, s[4:7], s38 offen offset:1152 sc1 lds
    s_add_u32 s38, s38, 40960
    s_cmp_lt_u32 1, s40
    s_cselect_b32 s38, s38, 268435456
    s_add_u32 s43, s45, 40960
    s_add_u32 m0, s43, 0
    s_nop 0
    buffer_load_dwordx4 v13, s[4:7], s38 offen offset:0 sc1 lds
    s_add_u32 m0, s43, 896
    s_nop 0
    buffer_load_dwordx4 v13, s[4:7], s38 offen offset:128 sc1 lds
    s_add_u32 m0, s43, 1792
    s_nop 0
    buffer_load_dwordx4 v13, s[4:7], s38 offen offset:256 sc1 lds
    s_add_u32 m0, s43, 2688
    s_nop 0
    buffer_load_dwordx4 v13, s[4:7], s38 offen offset:384 sc1 lds
    s_add_u32 m0, s43, 3584
    s_nop 0
    buffer_load_dwordx4 v13, s[4:7], s38 offen offset:512 sc1 lds
    s_add_u32 m0, s43, 4480
    s_nop 0
    buffer_load_dwordx4 v13, s[4:7], s38 offen offset:640 sc1 lds
    s_add_u32 m0, s43, 5376
    s_nop 0
    buffer_load_dwordx4 v13, s[4:7], s38 offen offset:768 sc1 lds
    s_add_u32 m0, s43, 6272
    s_nop 0
    buffer_load_dwordx4 v13, s[4:7], s38 offen offset:896 sc1 lds
    s_add_u32 m0, s43, 7168
    s_nop 0
    buffer_load_dwordx4 v13, s[4:7], s38 offen offset:1024 sc1 lds
    s_add_u32 m0, s43, 8064
    s_nop 0
    buffer_load_dwordx4 v13, s[4:7], s38 offen offset:1152 sc1 lds
    s_add_u32 s38, s38, 40960
    s_cmp_lt_u32 2, s40
    s_cselect_b32 s38, s38, 268435456
    s_add_u32 s43, s45, 81920
    s_mov_b32 s41, 0
    s_mov_b32 s42, 0
    s_mov_b32 s46, 268435456
    s_waitcnt vmcnt(10)
    s_barrier
    ds_read_b128 v[64:67], v20 offset:0
    ds_read_b128 v[68:71], v21 offset:0
    ds_read_b128 v[72:75], v22 offset:0
    ds_read_b128 v[76:79], v23 offset:0
    ds_read_b128 v[80:83], v20 offset:1024
    ds_read_b128 v[84:87], v21 offset:1024
    ds_read_b128 v[88:91], v22 offset:1024
L_bo_top:
    s_waitcnt lgkmcnt(6)
    v_mfma_f32_32x32x16_bf16 v[32:47], v[96:99], v[64:67], 0
    ds_read_b128 v[92:95], v23 offset:1024
    s_waitcnt lgkmcnt(6)
    v_mfma_f32_32x32x16_bf16 v[32:47], v[100:103], v[68:71], v[32:47]
    ds_read_b128 v[64:67], v20 offset:2048
    v_cvt_pk_bf16_f32 v24, v48, v49
    v_cvt_pk_bf16_f32 v25, v50, v51
    v_cvt_pk_bf16_f32 v26, v52, v53
    v_cvt_pk_bf16_f32 v27, v54, v55
    s_waitcnt lgkmcnt(6)
    v_mfma_f32_32x32x16_bf16 v[32:47], v[104:107], v[72:75], v[32:47]
    ds_read_b128 v[68:71], v21 offset:2048
    v_cvt_pk_bf16_f32 v28, v56, v57
    v_cvt_pk_bf16_f32 v29, v58, v59
    v_cvt_pk_bf16_f32 v30, v60, v61
    v_cvt_pk_bf16_f32 v31, v62, v63
    s_waitcnt lgkmcnt(6)
    v_mfma_f32_32x32x16_bf16 v[32:47], v[108:111], v[76:79], v[32:47]
    ds_read_b128 v[72:75], v22 offset:2048
    buffer_store_dwordx2 v[24:25], v9, s[24:27], s46 offen offset:0
    s_waitcnt lgkmcnt(6)
    v_mfma_f32_32x32x16_bf16 v[32:47], v[112:115], v[80:83], v[32:47]
    ds_read_b128 v[76:79], v23 offset:2048
    s_waitcnt lgkmcnt(6)
    v_mfma_f32_32x32x16_bf16 v[32:47], v[116:119], v[84:87], v[32:47]
    ds_read_b128 v[80:83], v20 offset:3072
    buffer_store_dwordx2 v[26:27], v9, s[24:27], s46 offen offset:16
    s_waitcnt lgkmcnt(6)
    v_mfma_f32_32x32x16_bf16 v[32:47], v[120:123], v[88:91], v[32:47]
    ds_read_b128 v[84:87], v21 offset:3072
    s_waitcnt lgkmcnt(6)
    v_mfma_f32_32x32x16_bf16 v[32:47], v[124:127], v[92:95], v[32:47]
    ds_read_b128 v[88:91], v22 offset:3072
    buffer_store_dwordx2 v[28:29], v9, s[24:27], s46 offen offset:32
    s_waitcnt lgkmcnt(6)
    v_mfma_f32_32x32x16_bf16 v[32:47], v[128:131], v[64:67], v[32:47]
    ds_read_b128 v[92:95], v23 offset:3072
    s_waitcnt lgkmcnt(6)
    v_mfma_f32_32x32x16_bf16 v[32:47], v[132:135], v[68:71], v[32:47]
    ds_read_b128 v[64:67], v20 offset:4096
    buffer_store_dwordx2 v[30:31], v9, s[24:27], s46 offen offset:48
    s_waitcnt lgkmcnt(6)
    v_mfma_f32_32x32x16_bf16 v[32:47], v[136:139], v[72:75], v[32:47]
    ds_read_b128 v[68:71], v21 offset:4096
    s_waitcnt lgkmcnt(6)
    v_mfma_f32_32x32x16_bf16 v[32:47], v[140:143], v[76:79], v[32:47]
    ds_read_b128 v[72:75], v22 offset:4096
    s_add_u32 m0, s43, 0
    s_nop 0
    buffer_load_dwordx4 v13, s[4:7], s38 offen offset:0 sc1 lds
    s_waitcnt lgkmcnt(6)
    v_mfma_f32_32x32x16_bf16 v[32:47], v[144:147], v[80:83], v[32:47]
    ds_read_b128 v[76:79], v23 offset:4096
    s_waitcnt lgkmcnt(6)
    v_mfma_f32_32x32x16_bf16 v[32:47], v[148:151], v[84:87], v[32:47]
    ds_read_b128 v[80:83], v20 offset:5120
    s_add_u32 m0, s43, 896
    s_nop 0
    buffer_load_dwordx4 v13, s[4:7], s38 offen offset:128 sc1 lds
    s_waitcnt lgkmcnt(6)
    v_mfma_f32_32x32x16_bf16 v[32:47], v[152:155], v[88:91], v[32:47]
    ds_read_b128 v[84:87], v21 offset:5120
    s_waitcnt lgkmcnt(6)
    v_mfma_f32_32x32x16_bf16 v[32:47], v[156:159], v[92:95], v[32:47]
    ds_read_b128 v[88:91], v22 offset:5120
    s_add_u32 m0, s43, 1792
    s_nop 0
    buffer_load_dwordx4 v13, s[4:7], s38 offen offset:256 sc1 lds
    s_waitcnt lgkmcnt(6)
    v_mfma_f32_32x32x16_bf16 v[32:47], v[160:163], v[64:67], v[32:47]
    ds_read_b128 v[92:95], v23 offset:5120
    s_waitcnt lgkmcnt(6)
    v_mfma_f32_32x32x16_bf16 v[32:47], v[164:167], v[68:71], v[32:47]
    ds_read_b128 v[64:67], v20 offset:6144
    s_waitcnt lgkmcnt(6)
    v_mfma_f32_32x32x16_bf16 v[32:47], v[168:171], v[72:75], v[32:47]
    ds_read_b128 v[68:71], v21 offset:6144
    s_add_u32 m0, s43, 2688
    s_nop 0
    buffer_load_dwordx4 v13, s[4:7], s38 offen offset:384 sc1 lds
    s_waitcnt lgkmcnt(6)
    v_mfma_f32_32x32x16_bf16 v[32:47], v[172:175], v[76:79], v[32:47]
    ds_read_b128 v[72:75], v22 offset:6144
    s_waitcnt lgkmcnt(6)
    v_mfma_f32_32x32x16_bf16 v[32:47], v[176:179], v[80:83], v[32:47]
    ds_read_b128 v[76:79], v23 offset:6144
    s_add_u32 m0, s43, 3584
    s_nop 0
    buffer_load_dwordx4 v13, s[4:7], s38 offen offset:512 sc1 lds
    s_waitcnt lgkmcnt(6)
    v_mfma_f32_32x32x16_bf16 v[32:47], v[180:183], v[84:87], v[32:47]
    ds_read_b128 v[80:83], v20 offset:7168
    s_waitcnt lgkmcnt(6)
    v_mfma_f32_32x32x16_bf16 v[32:47], v[184:187], v[88:91], v[32:47]
    ds_read_b128 v[84:87], v21 offset:7168
    s_add_u32 m0, s43, 4480
    s_nop 0
    buffer_load_dwordx4 v13, s[4:7], s38 offen offset:640 sc1 lds
    s_waitcnt lgkmcnt(6)
    v_mfma_f32_32x32x16_bf16 v[32:47], v[188:191], v[92:95], v[32:47]
    ds_read_b128 v[88:91], v22 offset:7168
    s_waitcnt lgkmcnt(6)
    v_mfma_f32_32x32x16_bf16 v[32:47], v[192:195], v[64:67], v[32:47]
    ds_read_b128 v[92:95], v23 offset:7168
    s_add_u32 m0, s43, 5376
    s_nop 0
    buffer_load_dwordx4 v13, s[4:7], s38 offen offset:768 sc1 lds
    s_waitcnt lgkmcnt(6)
    v_mfma_f32_32x32x16_bf16 v[32:47], v[196:199], v[68:71], v[32:47]
    ds_read_b128 v[64:67], v20 offset:8192
    s_waitcnt lgkmcnt(6)
    v_mfma_f32_32x32x16_bf16 v[32:47], v[200:203], v[72:75], v[32:47]
    ds_read_b128 v[68:71], v21 offset:8192
    s_add_u32 m0, s43, 6272
    s_nop 0
    buffer_load_dwordx4 v13, s[4:7], s38 offen offset:896 sc1 lds
    s_waitcnt lgkmcnt(6)
    v_mfma_f32_32x32x16_bf16 v[32:47], v[204:207], v[76:79], v[32:47]
    ds_read_b128 v[72:75], v22 offset:8192
    s_waitcnt lgkmcnt(6)
    v_mfma_f32_32x32x16_bf16 v[32:47], v[208:211], v[80:83], v[32:47]
    ds_read_b128 v[76:79], v23 offset:8192
    s_add_u32 m0, s43, 7168
    s_nop 0
    buffer_load_dwordx4 v13, s[4:7], s38 offen offset:1024 sc1 lds
    s_waitcnt lgkmcnt(6)
    v_mfma_f32_32x32x16_bf16 v[32:47], v[212:215], v[84:87], v[32:47]
    ds_read_b128 v[80:83], v20 offset:9216
    s_waitcnt lgkmcnt(6)
    v_mfma_f32_32x32x16_bf16 v[32:47], v[216:219], v[88:91], v[32:47]
    ds_read_b128 v[84:87], v21 offset:9216
    s_waitcnt lgkmcnt(6)
    v_mfma_f32_32x32x16_bf16 v[32:47], v[220:223], v[92:95], v[32:47]
    ds_read_b128 v[88:91], v22 offset:9216
    s_add_u32 m0, s43, 8064
    s_nop 0
    buffer_load_dwordx4 v13, s[4:7], s38 offen offset:1152 sc1 lds
    s_waitcnt lgkmcnt(6)
    v_mfma_f32_32x32x16_bf16 v[32:47], v[224:227], v[64:67], v[32:47]
    ds_read_b128 v[92:95], v23 offset:9216
    s_add_u32 s42, s42, 40960
    s_cmp_eq_u32 s42, 163840
    s_cselect_b32 s42, 0, s42
    v_add_u32 v20, s42, v16
    v_add_u32 v21, s42, v17
    v_add_u32 v22, s42, v18
    v_add_u32 v23, s42, v19
    s_waitcnt vmcnt(14)
    s_barrier
    s_waitcnt lgkmcnt(6)
    v_mfma_f32_32x32x16_bf16 v[32:47], v[228:231], v[68:71], v[32:47]
    ds_read_b128 v[64:67], v20 offset:0
    s_add_u32 s43, s42, 81920
    s_cmp_ge_u32 s43, 163840
    s_cselect_b32 s33, 163840, 0
    s_sub_u32 s43, s43, s33
    s_add_u32 s43, s43, s45
    s_waitcnt lgkmcnt(6)
    v_mfma_f32_32x32x16_bf16 v[32:47], v[232:235], v[72:75], v[32:47]
    ds_read_b128 v[68:71], v21 offset:0
    s_add_u32 s38, s38, 40960
    s_add_u32 s33, s41, 3
    s_cmp_lt_u32 s33, s40
    s_cselect_b32 s38, s38, 268435456
    s_waitcnt lgkmcnt(6)
    v_mfma_f32_32x32x16_bf16 v[32:47], v[236:239], v[76:79], v[32:47]
    ds_read_b128 v[72:75], v22 offset:0
    s_mov_b32 s46, s39
    s_add_u32 s39, s39, 81920
    s_add_u32 s41, s41, 1
    s_cmp_lt_u32 s41, s40
    s_waitcnt lgkmcnt(6)
    v_mfma_f32_32x32x16_bf16 v[32:47], v[240:243], v[80:83], v[32:47]
    ds_read_b128 v[76:79], v23 offset:0
    s_waitcnt lgkmcnt(6)
    v_mfma_f32_32x32x16_bf16 v[32:47], v[244:247], v[84:87], v[32:47]
    ds_read_b128 v[80:83], v20 offset:1024
    s_waitcnt lgkmcnt(6)
    v_mfma_f32_32x32x16_bf16 v[32:47], v[248:251], v[88:91], v[32:47]
    ds_read_b128 v[84:87], v21 offset:1024
    s_waitcnt lgkmcnt(6)
    v_mfma_f32_32x32x16_bf16 v[32:47], v[252:255], v[92:95], v[32:47]
    ds_read_b128 v[88:91], v22 offset:1024
    s_nop 9
    s_cbranch_scc0 L_bo_end0
    s_waitcnt lgkmcnt(6)
    v_mfma_f32_32x32x16_bf16 v[48:63], v[96:99], v[64:67], 0
    ds_read_b128 v[92:95], v23 offset:1024
    s_waitcnt lgkmcnt(6)
    v_mfma_f32_32x32x16_bf16 v[48:63], v[100:103], v[68:71], v[48:63]
    ds_read_b128 v[64:67], v20 offset:2048
    v_cvt_pk_bf16_f32 v24, v32, v33
    v_cvt_pk_bf16_f32 v25, v34, v35
    v_cvt_pk_bf16_f32 v26, v36, v37
    v_cvt_pk_bf16_f32 v27, v38, v39
    s_waitcnt lgkmcnt(6)
    v_mfma_f32_32x32x16_bf16 v[48:63], v[104:107], v[72:75], v[48:63]
    ds_read_b128 v[68:71], v21 offset:2048
    v_cvt_pk_bf16_f32 v28, v40, v41
    v_cvt_pk_bf16_f32 v29, v42, v43
    v_cvt_pk_bf16_f32 v30, v44, v45
    v_cvt_pk_bf16_f32 v31, v46, v47
    s_waitcnt lgkmcnt(6)
    v_mfma_f32_32x32x16_bf16 v[48:63], v[108:111], v[76:79], v[48:63]
    ds_read_b128 v[72:75], v22 offset:2048
    buffer_store_dwordx2 v[24:25], v9, s[24:27], s46 offen offset:0
    s_waitcnt lgkmcnt(6)
    v_mfma_f32_32x32x16_bf16 v[48:63], v[112:115], v[80:83], v[48:63]
    ds_read_b128 v[76:79], v23 offset:2048
    s_waitcnt lgkmcnt(6)
    v_mfma_f32_32x32x16_bf16 v[48:63], v[116:119], v[84:87], v[48:63]
    ds_read_b128 v[80:83], v20 offset:3072
    buffer_store_dwordx2 v[26:27], v9, s[24:27], s46 offen offset:16
    s_waitcnt lgkmcnt(6)
    v_mfma_f32_32x32x16_bf16 v[48:63], v[120:123], v[88:91], v[48:63]
    ds_read_b128 v[84:87], v21 offset:3072
    s_waitcnt lgkmcnt(6)
    v_mfma_f32_32x32x16_bf16 v[48:63], v[124:127], v[92:95], v[48:63]
    ds_read_b128 v[88:91], v22 offset:3072
    buffer_store_dwordx2 v[28:29], v9, s[24:27], s46 offen offset:32
    s_waitcnt lgkmcnt(6)
    v_mfma_f32_32x32x16_bf16 v[48:63], v[128:131], v[64:67], v[48:63]
    ds_read_b128 v[92:95], v23 offset:3072
    s_waitcnt lgkmcnt(6)
    v_mfma_f32_32x32x16_bf16 v[48:63], v[132:135], v[68:71], v[48:63]
    ds_read_b128 v[64:67], v20 offset:4096
    buffer_store_dwordx2 v[30:31], v9, s[24:27], s46 offen offset:48
    s_waitcnt lgkmcnt(6)
    v_mfma_f32_32x32x16_bf16 v[48:63], v[136:139], v[72:75], v[48:63]
    ds_read_b128 v[68:71], v21 offset:4096
    s_waitcnt lgkmcnt(6)
    v_mfma_f32_32x32x16_bf16 v[48:63], v[140:143], v[76:79], v[48:63]
    ds_read_b128 v[72:75], v22 offset:4096
    s_add_u32 m0, s43, 0
    s_nop 0
    buffer_load_dwordx4 v13, s[4:7], s38 offen offset:0 sc1 lds
    s_waitcnt lgkmcnt(6)
    v_mfma_f32_32x32x16_bf16 v[48:63], v[144:147], v[80:83], v[48:63]
    ds_read_b128 v[76:79], v23 offset:4096
    s_waitcnt lgkmcnt(6)
    v_mfma_f32_32x32x16_bf16 v[48:63], v[148:151], v[84:87], v[48:63]
    ds_read_b128 v[80:83], v20 offset:5120
    s_add_u32 m0, s43, 896
    s_nop 0
    buffer_load_dwordx4 v13, s[4:7], s38 offen offset:128 sc1 lds
    s_waitcnt lgkmcnt(6)
    v_mfma_f32_32x32x16_bf16 v[48:63], v[152:155], v[88:91], v[48:63]
    ds_read_b128 v[84:87], v21 offset:5120
    s_waitcnt lgkmcnt(6)
    v_mfma_f32_32x32x16_bf16 v[48:63], v[156:159], v[92:95], v[48:63]
    ds_read_b128 v[88:91], v22 offset:5120
    s_add_u32 m0, s43, 1792
    s_nop 0
    buffer_load_dwordx4 v13, s[4:7], s38 offen offset:256 sc1 lds
    s_waitcnt lgkmcnt(6)
    v_mfma_f32_32x32x16_bf16 v[48:63], v[160:163], v[64:67], v[48:63]
    ds_read_b128 v[92:95], v23 offset:5120
    s_waitcnt lgkmcnt(6)
    v_mfma_f32_32x32x16_bf16 v[48:63], v[164:167], v[68:71], v[48:63]
    ds_read_b128 v[64:67], v20 offset:6144
    s_waitcnt lgkmcnt(6)
    v_mfma_f32_32x32x16_bf16 v[48:63], v[168:171], v[72:75], v[48:63]
    ds_read_b128 v[68:71], v21 offset:6144
    s_add_u32 m0, s43, 2688
    s_nop 0
    buffer_load_dwordx4 v13, s[4:7], s38 offen offset:384 sc1 lds
    s_waitcnt lgkmcnt(6)
    v_mfma_f32_32x32x16_bf16 v[48:63], v[172:175], v[76:79], v[48:63]
    ds_read_b128 v[72:75], v22 offset:6144
    s_waitcnt lgkmcnt(6)
    v_mfma_f32_32x32x16_bf16 v[48:63], v[176:179], v[80:83], v[48:63]
    ds_read_b128 v[76:79], v23 offset:6144
    s_add_u32 m0, s43, 3584
    s_nop 0
    buffer_load_dwordx4 v13, s[4:7], s38 offen offset:512 sc1 lds
    s_waitcnt lgkmcnt(6)
    v_mfma_f32_32x32x16_bf16 v[48:63], v[180:183], v[84:87], v[48:63]
    ds_read_b128 v[80:83], v20 offset:7168
    s_waitcnt lgkmcnt(6)
    v_mfma_f32_32x32x16_bf16 v[48:63], v[184:187], v[88:91], v[48:63]
    ds_read_b128 v[84:87], v21 offset:7168
    s_add_u32 m0, s43, 4480
    s_nop 0
    buffer_load_dwordx4 v13, s[4:7], s38 offen offset:640 sc1 lds
    s_waitcnt lgkmcnt(6)
    v_mfma_f32_32x32x16_bf16 v[48:63], v[188:191], v[92:95], v[48:63]
    ds_read_b128 v[88:91], v22 offset:7168
    s_waitcnt lgkmcnt(6)
    v_mfma_f32_32x32x16_bf16 v[48:63], v[192:195], v[64:67], v[48:63]
    ds_read_b128 v[92:95], v23 offset:7168
    s_add_u32 m0, s43, 5376
    s_nop 0
    buffer_load_dwordx4 v13, s[4:7], s38 offen offset:768 sc1 lds
    s_waitcnt lgkmcnt(6)
    v_mfma_f32_32x32x16_bf16 v[48:63], v[196:199], v[68:71], v[48:63]
    ds_read_b128 v[64:67], v20 offset:8192
    s_waitcnt lgkmcnt(6)
    v_mfma_f32_32x32x16_bf16 v[48:63], v[200:203], v[72:75], v[48:63]
    ds_read_b128 v[68:71], v21 offset:8192
    s_add_u32 m0, s43, 6272
    s_nop 0
    buffer_load_dwordx4 v13, s[4:7], s38 offen offset:896 sc1 lds
    s_waitcnt lgkmcnt(6)
    v_mfma_f32_32x32x16_bf16 v[48:63], v[204:207], v[76:79], v[48:63]
    ds_read_b128 v[72:75], v22 offset:8192
    s_waitcnt lgkmcnt(6)
    v_mfma_f32_32x32x16_bf16 v[48:63], v[208:211], v[80:83], v[48:63]
    ds_read_b128 v[76:79], v23 offset:8192
    s_add_u32 m0, s43, 7168
    s_nop 0
    buffer_load_dwordx4 v13, s[4:7], s38 offen offset:1024 sc1 lds
    s_waitcnt lgkmcnt(6)
    v_mfma_f32_32x32x16_bf16 v[48:63], v[212:215], v[84:87], v[48:63]
    ds_read_b128 v[80:83], v20 offset:9216
    s_waitcnt lgkmcnt(6)
    v_mfma_f32_32x32x16_bf16 v[48:63], v[216:219], v[88:91], v[48:63]
    ds_read_b128 v[84:87], v21 offset:9216
    s_waitcnt lgkmcnt(6)
    v_mfma_f32_32x32x16_bf16 v[48:63], v[220:223], v[92:95], v[48:63]
    ds_read_b128 v[88:91], v22 offset:9216
    s_add_u32 m0, s43, 8064
    s_nop 0
    buffer_load_dwordx4 v13, s[4:7], s38 offen offset:1152 sc1 lds
    s_waitcnt lgkmcnt(6)
    v_mfma_f32_32x32x16_bf16 v[48:63], v[224:227], v[64:67], v[48:63]
    ds_read_b128 v[92:95], v23 offset:9216
    s_add_u32 s42, s42, 40960
    s_cmp_eq_u32 s42, 163840
    s_cselect_b32 s42, 0, s42
    v_add_u32 v20, s42, v16
    v_add_u32 v21, s42, v17
    v_add_u32 v22, s42, v18
    v_add_u32 v23, s42, v19
    s_waitcnt vmcnt(14)
    s_barrier
    s_waitcnt lgkmcnt(6)
    v_mfma_f32_32x32x16_bf16 v[48:63], v[228:231], v[68:71], v[48:63]
    ds_read_b128 v[64:67], v20 offset:0
    s_add_u32 s43, s42, 81920
    s_cmp_ge_u32 s43, 163840
    s_cselect_b32 s33, 163840, 0
    s_sub_u32 s43, s43, s33
    s_add_u32 s43, s43, s45
    s_waitcnt lgkmcnt(6)
    v_mfma_f32_32x32x16_bf16 v[48:63], v[232:235], v[72:75], v[48:63]
    ds_read_b128 v[68:71], v21 offset:0
    s_add_u32 s38, s38, 40960
    s_add_u32 s33, s41, 3
    s_cmp_lt_u32 s33, s40
    s_cselect_b32 s38, s38, 268435456
    s_waitcnt lgkmcnt(6)
    v_mfma_f32_32x32x16_bf16 v[48:63], v[236:239], v[76:79], v[48:63]
    ds_read_b128 v[72:75], v22 offset:0
    s_mov_b32 s46, s39
    s_add_u32 s39, s39, 81920
    s_add_u32 s41, s41, 1
    s_cmp_lt_u32 s41, s40
    s_waitcnt lgkmcnt(6)
    v_mfma_f32_32x32x16_bf16 v[48:63], v[240:243], v[80:83], v[48:63]
    ds_read_b128 v[76:79], v23 offset:0
    s_waitcnt lgkmcnt(6)
    v_mfma_f32_32x32x16_bf16 v[48:63], v[244:247], v[84:87], v[48:63]
    ds_read_b128 v[80:83], v20 offset:1024
    s_waitcnt lgkmcnt(6)
    v_mfma_f32_32x32x16_bf16 v[48:63], v[248:251], v[88:91], v[48:63]
    ds_read_b128 v[84:87], v21 offset:1024
    s_waitcnt lgkmcnt(6)
    v_mfma_f32_32x32x16_bf16 v[48:63], v[252:255], v[92:95], v[48:63]
    ds_read_b128 v[88:91], v22 offset:1024
    s_nop 3
    s_cbranch_scc1 L_bo_top
    s_nop 9
    v_cvt_pk_bf16_f32 v24, v48, v49
    v_cvt_pk_bf16_f32 v25, v50, v51
    v_cvt_pk_bf16_f32 v26, v52, v53
    v_cvt_pk_bf16_f32 v27, v54, v55
    v_cvt_pk_bf16_f32 v28, v56, v57
    v_cvt_pk_bf16_f32 v29, v58, v59
    v_cvt_pk_bf16_f32 v30, v60, v61
    v_cvt_pk_bf16_f32 v31, v62, v63
    buffer_store_dwordx2 v[24:25], v9, s[24:27], s46 offen offset:0
    buffer_store_dwordx2 v[26:27], v9, s[24:27], s46 offen offset:16
    buffer_store_dwordx2 v[28:29], v9, s[24:27], s46 offen offset:32
    buffer_store_dwordx2 v[30:31], v9, s[24:27], s46 offen offset:48
    s_branch L_bo_end
L_bo_end0:
    v_cvt_pk_bf16_f32 v24, v32, v33
    v_cvt_pk_bf16_f32 v25, v34, v35
    v_cvt_pk_bf16_f32 v26, v36, v37
    v_cvt_pk_bf16_f32 v27, v38, v39
    v_cvt_pk_bf16_f32 v28, v40, v41
    v_cvt_pk_bf16_f32 v29, v42, v43
    v_cvt_pk_bf16_f32 v30, v44, v45
    v_cvt_pk_bf16_f32 v31, v46, v47
    buffer_store_dwordx2 v[24:25], v9, s[24:27], s46 offen offset:0
    buffer_store_dwordx2 v[26:27], v9, s[24:27], s46 offen offset:16
    buffer_store_dwordx2 v[28:29], v9, s[24:27], s46 offen offset:32
    buffer_store_dwordx2 v[30:31], v9, s[24:27], s46 offen offset:48
L_bo_end:
    s_waitcnt vmcnt(0) lgkmcnt(0)
L_b_done:
    s_mul_i32 s39, s21, 205
    s_lshr_b32 s39, s39, 12
    s_mul_i32 s33, s39, 20
    s_sub_u32 s40, s21, s33
    s_lshl_b32 s33, s39, 1
    s_sub_u32 s33, s33, 3
    s_cmp_ge_u32 s39, 4
    s_cselect_b32 s39, s33, s39
    s_load_dwordx2 s[8:9], s[0:1], 40
    s_mov_b32 s10, 5242880
    s_mov_b32 s11, 0x20000
    s_load_dwordx2 s[24:25], s[0:1], 80
    s_mov_b32 s26, 5242880
    s_mov_b32 s27, 0x20000
    v_mbcnt_lo_u32_b32 v20, -1, 0
    v_mbcnt_hi_u32_b32 v20, -1, v20
    v_lshrrev_b32 v21, 4, v20
    v_and_b32 v22, 15, v20
    v_lshrrev_b32 v6, 2, v20
    v_mul_u32_u24 v6, 1280, v6
    v_and_b32 v7, 3, v20
    v_lshl_add_u32 v23, v7, 4, v6
    s_mul_i32 s37, s3, 40960
    s_mul_i32 s38, s3, 1310720
    s_lshl_b32 s33, s40, 6
    s_add_u32 s38, s38, s33
    v_lshlrev_b32 v8, 3, v7
    v_add_u32 v8, s37, v8
    v_lshrrev_b32 v6, 3, v22
    v_lshlrev_b32 v6, 5, v6
    v_and_b32 v7, 1, v21
    v_lshl_add_u32 v6, v7, 4, v6
    v_lshrrev_b32 v7, 1, v21
    v_lshl_add_u32 v6, v7, 2, v6
    v_bfe_u32 v7, v22, 2, 1
    v_add_u32 v6, v6, v7
    v_lshl_add_u32 v24, v6, 6, v8
    s_waitcnt lgkmcnt(0)
    s_barrier
    s_add_u32 m0, s37, 0
    s_add_u32 s33, s38, 0
    buffer_load_dwordx4 v23, s[8:11], s33 offen lds
    s_add_u32 m0, s37, 1024
    s_add_u32 s33, s38, 20480
    buffer_load_dwordx4 v23, s[8:11], s33 offen lds
    s_add_u32 m0, s37, 2048
    s_add_u32 s33, s38, 40960
    buffer_load_dwordx4 v23, s[8:11], s33 offen lds
    s_add_u32 m0, s37, 3072
    s_add_u32 s33, s38, 61440
    buffer_load_dwordx4 v23, s[8:11], s33 offen lds
    s_add_u32 m0, s37, 4096
    s_add_u32 s33, s38, 81920
    buffer_load_dwordx4 v23, s[8:11], s33 offen lds
    s_add_u32 m0, s37, 5120
    s_add_u32 s33, s38, 102400
    buffer_load_dwordx4 v23, s[8:11], s33 offen lds
    s_add_u32 m0, s37, 6144
    s_add_u32 s33, s38, 122880
    buffer_load_dwordx4 v23, s[8:11], s33 offen lds
    s_add_u32 m0, s37, 7168
    s_add_u32 s33, s38, 143360
    buffer_load_dwordx4 v23, s[8:11], s33 offen lds
    s_add_u32 m0, s37, 8192
    s_add_u32 s33, s38, 163840
    buffer_load_dwordx4 v23, s[8:11], s33 offen lds
    s_add_u32 m0, s37, 9216
    s_add_u32 s33, s38, 184320
    buffer_load_dwordx4 v23, s[8:11], s33 offen lds
    s_add_u32 m0, s37, 10240
    s_add_u32 s33, s38, 204800
    buffer_load_dwordx4 v23, s[8:11], s33 offen lds
    s_add_u32 m0, s37, 11264
    s_add_u32 s33, s38, 225280
    buffer_load_dwordx4 v23, s[8:11], s33 offen lds
    s_add_u32 m0, s37, 12288
    s_add_u32 s33, s38, 245760
    buffer_load_dwordx4 v23, s[8:11], s33 offen lds
    s_add_u32 m0, s37, 13312
    s_add_u32 s33, s38, 266240
    buffer_load_dwordx4 v23, s[8:11], s33 offen lds
    s_add_u32 m0, s37, 14336
    s_add_u32 s33, s38, 286720
    buffer_load_dwordx4 v23, s[8:11], s33 offen lds
    s_add_u32 m0, s37, 15360
    s_add_u32 s33, s38, 307200
    buffer_load_dwordx4 v23, s[8:11], s33 offen lds
    s_add_u32 m0, s37, 16384
    s_add_u32 s33, s38, 327680
    buffer_load_dwordx4 v23, s[8:11], s33 offen lds
    s_add_u32 m0, s37, 17408
    s_add_u32 s33, s38, 348160
    buffer_load_dwordx4 v23, s[8:11], s33 offen lds
    s_add_u32 m0, s37, 18432
    s_add_u32 s33, s38, 368640
    buffer_load_dwordx4 v23, s[8:11], s33 offen lds
    s_add_u32 m0, s37, 19456
    s_add_u32 s33, s38, 389120
    buffer_load_dwordx4 v23, s[8:11], s33 offen lds
    s_add_u32 m0, s37, 20480
    s_add_u32 s33, s38, 409600
    buffer_load_dwordx4 v23, s[8:11], s33 offen lds
    s_add_u32 m0, s37, 21504
    s_add_u32 s33, s38, 430080
    buffer_load_dwordx4 v23, s[8:11], s33 offen lds
    s_add_u32 m0, s37, 22528
    s_add_u32 s33, s38, 450560
    buffer_load_dwordx4 v23, s[8:11], s33 offen lds
    s_add_u32 m0, s37, 23552
    s_add_u32 s33, s38, 471040
    buffer_load_dwordx4 v23, s[8:11], s33 offen lds
    s_add_u32 m0, s37, 24576
    s_add_u32 s33, s38, 491520
    buffer_load_dwordx4 v23, s[8:11], s33 offen lds
    s_add_u32 m0, s37, 25600
    s_add_u32 s33, s38, 512000
    buffer_load_dwordx4 v23, s[8:11], s33 offen lds
    s_add_u32 m0, s37, 26624
    s_add_u32 s33, s38, 532480
    buffer_load_dwordx4 v23, s[8:11], s33 offen lds
    s_add_u32 m0, s37, 27648
    s_add_u32 s33, s38, 552960
    buffer_load_dwordx4 v23, s[8:11], s33 offen lds
    s_add_u32 m0, s37, 28672
    s_add_u32 s33, s38, 573440
    buffer_load_dwordx4 v23, s[8:11], s33 offen lds
    s_add_u32 m0, s37, 29696
    s_add_u32 s33, s38, 593920
    buffer_load_dwordx4 v23, s[8:11], s33 offen lds
    s_add_u32 m0, s37, 30720
    s_add_u32 s33, s38, 614400
    buffer_load_dwordx4 v23, s[8:11], s33 offen lds
    s_add_u32 m0, s37, 31744
    s_add_u32 s33, s38, 634880
    buffer_load_dwordx4 v23, s[8:11], s33 offen lds
    s_add_u32 m0, s37, 32768
    s_add_u32 s33, s38, 655360
    buffer_load_dwordx4 v23, s[8:11], s33 offen lds
    s_add_u32 m0, s37, 33792
    s_add_u32 s33, s38, 675840
    buffer_load_dwordx4 v23, s[8:11], s33 offen lds
    s_add_u32 m0, s37, 34816
    s_add_u32 s33, s38, 696320
    buffer_load_dwordx4 v23, s[8:11], s33 offen lds
    s_add_u32 m0, s37, 35840
    s_add_u32 s33, s38, 716800
    buffer_load_dwordx4 v23, s[8:11], s33 offen lds
    s_add_u32 m0, s37, 36864
    s_add_u32 s33, s38, 737280
    buffer_load_dwordx4 v23, s[8:11], s33 offen lds
    s_add_u32 m0, s37, 37888
    s_add_u32 s33, s38, 757760
    buffer_load_dwordx4 v23, s[8:11], s33 offen lds
    s_add_u32 m0, s37, 38912
    s_add_u32 s33, s38, 778240
    buffer_load_dwordx4 v23, s[8:11], s33 offen lds
    s_add_u32 m0, s37, 39936
    s_add_u32 s33, s38, 798720
    buffer_load_dwordx4 v23, s[8:11], s33 offen lds
    s_waitcnt vmcnt(36)
    ds_read_b64_tr_b16 a[0:1], v24 offset:0
    ds_read_b64_tr_b16 a[2:3], v24 offset:128
    ds_read_b64_tr_b16 a[4:5], v24 offset:512
    ds_read_b64_tr_b16 a[6:7], v24 offset:640
    ds_read_b64_tr_b16 a[8:9], v24 offset:32
    ds_read_b64_tr_b16 a[10:11], v24 offset:160
    ds_read_b64_tr_b16 a[12:13], v24 offset:544
    ds_read_b64_tr_b16 a[14:15], v24 offset:672
    s_waitcnt lgkmcnt(0)
    s_add_u32 m0, s37, 0
    s_add_u32 s33, s38, 819200
    buffer_load_dwordx4 v23, s[8:11], s33 offen lds
    s_add_u32 m0, s37, 1024
    s_add_u32 s33, s38, 839680
    buffer_load_dwordx4 v23, s[8:11], s33 offen lds
    s_add_u32 m0, s37, 2048
    s_add_u32 s33, s38, 860160
    buffer_load_dwordx4 v23, s[8:11], s33 offen lds
    s_add_u32 m0, s37, 3072
    s_add_u32 s33, s38, 880640
    buffer_load_dwordx4 v23, s[8:11], s33 offen lds
    s_waitcnt vmcnt(36)
    ds_read_b64_tr_b16 a[16:17], v24 offset:4096
    ds_read_b64_tr_b16 a[18:19], v24 offset:4224
    ds_read_b64_tr_b16 a[20:21], v24 offset:4608
    ds_read_b64_tr_b16 a[22:23], v24 offset:4736
    ds_read_b64_tr_b16 a[24:25], v24 offset:4128
    ds_read_b64_tr_b16 a[26:27], v24 offset:4256
    ds_read_b64_tr_b16 a[28:29], v24 offset:4640
    ds_read_b64_tr_b16 a[30:31], v24 offset:4768
    s_waitcnt lgkmcnt(0)
    s_add_u32 m0, s37, 4096
    s_add_u32 s33, s38, 901120
    buffer_load_dwordx4 v23, s[8:11], s33 offen lds
    s_add_u32 m0, s37, 5120
    s_add_u32 s33, s38, 921600
    buffer_load_dwordx4 v23, s[8:11], s33 offen lds
    s_add_u32 m0, s37, 6144
    s_add_u32 s33, s38, 942080
    buffer_load_dwordx4 v23, s[8:11], s33 offen lds
    s_add_u32 m0, s37, 7168
    s_add_u32 s33, s38, 962560
    buffer_load_dwordx4 v23, s[8:11], s33 offen lds
    s_waitcnt vmcnt(36)
    ds_read_b64_tr_b16 a[32:33], v24 offset:8192
    ds_read_b64_tr_b16 a[34:35], v24 offset:8320
    ds_read_b64_tr_b16 a[36:37], v24 offset:8704
    ds_read_b64_tr_b16 a[38:39], v24 offset:8832
    ds_read_b64_tr_b16 a[40:41], v24 offset:8224
    ds_read_b64_tr_b16 a[42:43], v24 offset:8352
    ds_read_b64_tr_b16 a[44:45], v24 offset:8736
    ds_read_b64_tr_b16 a[46:47], v24 offset:8864
    s_waitcnt lgkmcnt(0)
    s_add_u32 m0, s37, 8192
    s_add_u32 s33, s38, 983040
    buffer_load_dwordx4 v23, s[8:11], s33 offen lds
    s_add_u32 m0, s37, 9216
    s_add_u32 s33, s38, 1003520
    buffer_load_dwordx4 v23, s[8:11], s33 offen lds
    s_add_u32 m0, s37, 10240
    s_add_u32 s33, s38, 1024000
    buffer_load_dwordx4 v23, s[8:11], s33 offen lds
    s_add_u32 m0, s37, 11264
    s_add_u32 s33, s38, 1044480
    buffer_load_dwordx4 v23, s[8:11], s33 offen lds
    s_waitcnt vmcnt(36)
    ds_read_b64_tr_b16 a[48:49], v24 offset:12288
    ds_read_b64_tr_b16 a[50:51], v24 offset:12416
    ds_read_b64_tr_b16 a[52:53], v24 offset:12800
    ds_read_b64_tr_b16 a[54:55], v24 offset:12928
    ds_read_b64_tr_b16 a[56:57], v24 offset:12320
    ds_read_b64_tr_b16 a[58:59], v24 offset:12448
    ds_read_b64_tr_b16 a[60:61], v24 offset:12832
    ds_read_b64_tr_b16 a[62:63], v24 offset:12960
    s_waitcnt lgkmcnt(0)
    s_add_u32 m0, s37, 12288
    s_add_u32 s33, s38, 1064960
    buffer_load_dwordx4 v23, s[8:11], s33 offen lds
    s_add_u32 m0, s37, 13312
    s_add_u32 s33, s38, 1085440
    buffer_load_dwordx4 v23, s[8:11], s33 offen lds
    s_add_u32 m0, s37, 14336
    s_add_u32 s33, s38, 1105920
    buffer_load_dwordx4 v23, s[8:11], s33 offen lds
    s_add_u32 m0, s37, 15360
    s_add_u32 s33, s38, 1126400
    buffer_load_dwordx4 v23, s[8:11], s33 offen lds
    s_waitcnt vmcnt(36)
    ds_read_b64_tr_b16 a[64:65], v24 offset:16384
    ds_read_b64_tr_b16 a[66:67], v24 offset:16512
    ds_read_b64_tr_b16 a[68:69], v24 offset:16896
    ds_read_b64_tr_b16 a[70:71], v24 offset:17024
    ds_read_b64_tr_b16 a[72:73], v24 offset:16416
    ds_read_b64_tr_b16 a[74:75], v24 offset:16544
    ds_read_b64_tr_b16 a[76:77], v24 offset:16928
    ds_read_b64_tr_b16 a[78:79], v24 offset:17056
    s_waitcnt lgkmcnt(0)
    s_add_u32 m0, s37, 16384
    s_add_u32 s33, s38, 1146880
    buffer_load_dwordx4 v23, s[8:11], s33 offen lds
    s_add_u32 m0, s37, 17408
    s_add_u32 s33, s38, 1167360
    buffer_load_dwordx4 v23, s[8:11], s33 offen lds
    s_add_u32 m0, s37, 18432
    s_add_u32 s33, s38, 1187840
    buffer_load_dwordx4 v23, s[8:11], s33 offen lds
    s_add_u32 m0, s37, 19456
    s_add_u32 s33, s38, 1208320
    buffer_load_dwordx4 v23, s[8:11], s33 offen lds
    s_waitcnt vmcnt(36)
    ds_read_b64_tr_b16 a[80:81], v24 offset:20480
    ds_read_b64_tr_b16 a[82:83], v24 offset:20608
    ds_read_b64_tr_b16 a[84:85], v24 offset:20992
    ds_read_b64_tr_b16 a[86:87], v24 offset:21120
    ds_read_b64_tr_b16 a[88:89], v24 offset:20512
    ds_read_b64_tr_b16 a[90:91], v24 offset:20640
    ds_read_b64_tr_b16 a[92:93], v24 offset:21024
    ds_read_b64_tr_b16 a[94:95], v24 offset:21152
    s_waitcnt lgkmcnt(0)
    s_add_u32 m0, s37, 20480
    s_add_u32 s33, s38, 1228800
    buffer_load_dwordx4 v23, s[8:11], s33 offen lds
    s_add_u32 m0, s37, 21504
    s_add_u32 s33, s38, 1249280
    buffer_load_dwordx4 v23, s[8:11], s33 offen lds
    s_add_u32 m0, s37, 22528
    s_add_u32 s33, s38, 1269760
    buffer_load_dwordx4 v23, s[8:11], s33 offen lds
    s_add_u32 m0, s37, 23552
    s_add_u32 s33, s38, 1290240
    buffer_load_dwordx4 v23, s[8:11], s33 offen lds
    s_waitcnt vmcnt(36)
    ds_read_b64_tr_b16 a[96:97], v24 offset:24576
    ds_read_b64_tr_b16 a[98:99], v24 offset:24704
    ds_read_b64_tr_b16 a[100:101], v24 offset:25088
    ds_read_b64_tr_b16 a[102:103], v24 offset:25216
    ds_read_b64_tr_b16 a[104:105], v24 offset:24608
    ds_read_b64_tr_b16 a[106:107], v24 offset:24736
    ds_read_b64_tr_b16 a[108:109], v24 offset:25120
    ds_read_b64_tr_b16 a[110:111], v24 offset:25248
    s_waitcnt lgkmcnt(0)
    s_waitcnt vmcnt(32)
    ds_read_b64_tr_b16 a[112:113], v24 offset:28672
    ds_read_b64_tr_b16 a[114:115], v24 offset:28800
    ds_read_b64_tr_b16 a[116:117], v24 offset:29184
    ds_read_b64_tr_b16 a[118:119], v24 offset:29312
    ds_read_b64_tr_b16 a[120:121], v24 offset:28704
    ds_read_b64_tr_b16 a[122:123], v24 offset:28832
    ds_read_b64_tr_b16 a[124:125], v24 offset:29216
    ds_read_b64_tr_b16 a[126:127], v24 offset:29344
    s_waitcnt lgkmcnt(0)
    s_waitcnt vmcnt(28)
    ds_read_b64_tr_b16 a[128:129], v24 offset:32768
    ds_read_b64_tr_b16 a[130:131], v24 offset:32896
    ds_read_b64_tr_b16 a[132:133], v24 offset:33280
    ds_read_b64_tr_b16 a[134:135], v24 offset:33408
    ds_read_b64_tr_b16 a[136:137], v24 offset:32800
    ds_read_b64_tr_b16 a[138:139], v24 offset:32928
    ds_read_b64_tr_b16 a[140:141], v24 offset:33312
    ds_read_b64_tr_b16 a[142:143], v24 offset:33440
    s_waitcnt lgkmcnt(0)
    s_waitcnt vmcnt(24)
    ds_read_b64_tr_b16 a[144:145], v24 offset:36864
    ds_read_b64_tr_b16 a[146:147], v24 offset:36992
    ds_read_b64_tr_b16 a[148:149], v24 offset:37376
    ds_read_b64_tr_b16 a[150:151], v24 offset:37504
    ds_read_b64_tr_b16 a[152:153], v24 offset:36896
    ds_read_b64_tr_b16 a[154:155], v24 offset:37024
    ds_read_b64_tr_b16 a[156:157], v24 offset:37408
    ds_read_b64_tr_b16 a[158:159], v24 offset:37536
    s_waitcnt lgkmcnt(0)
    s_waitcnt vmcnt(20)
    ds_read_b64_tr_b16 a[160:161], v24 offset:0
    ds_read_b64_tr_b16 a[162:163], v24 offset:128
    ds_read_b64_tr_b16 a[164:165], v24 offset:512
    ds_read_b64_tr_b16 a[166:167], v24 offset:640
    ds_read_b64_tr_b16 a[168:169], v24 offset:32
    ds_read_b64_tr_b16 a[170:171], v24 offset:160
    ds_read_b64_tr_b16 a[172:173], v24 offset:544
    ds_read_b64_tr_b16 a[174:175], v24 offset:672
    s_waitcnt lgkmcnt(0)
    s_waitcnt vmcnt(16)
    ds_read_b64_tr_b16 a[176:177], v24 offset:4096
    ds_read_b64_tr_b16 a[178:179], v24 offset:4224
    ds_read_b64_tr_b16 a[180:181], v24 offset:4608
    ds_read_b64_tr_b16 a[182:183], v24 offset:4736
    ds_read_b64_tr_b16 a[184:185], v24 offset:4128
    ds_read_b64_tr_b16 a[186:187], v24 offset:4256
    ds_read_b64_tr_b16 a[188:189], v24 offset:4640
    ds_read_b64_tr_b16 a[190:191], v24 offset:4768
    s_waitcnt lgkmcnt(0)
    s_waitcnt vmcnt(12)
    ds_read_b64_tr_b16 a[192:193], v24 offset:8192
    ds_read_b64_tr_b16 a[194:195], v24 offset:8320
    ds_read_b64_tr_b16 a[196:197], v24 offset:8704
    ds_read_b64_tr_b16 a[198:199], v24 offset:8832
    ds_read_b64_tr_b16 a[200:201], v24 offset:8224
    ds_read_b64_tr_b16 a[202:203], v24 offset:8352
    ds_read_b64_tr_b16 a[204:205], v24 offset:8736
    ds_read_b64_tr_b16 a[206:207], v24 offset:8864
    s_waitcnt lgkmcnt(0)
    s_waitcnt vmcnt(8)
    ds_read_b64_tr_b16 a[208:209], v24 offset:12288
    ds_read_b64_tr_b16 a[210:211], v24 offset:12416
    ds_read_b64_tr_b16 a[212:213], v24 offset:12800
    ds_read_b64_tr_b16 a[214:215], v24 offset:12928
    ds_read_b64_tr_b16 a[216:217], v24 offset:12320
    ds_read_b64_tr_b16 a[218:219], v24 offset:12448
    ds_read_b64_tr_b16 a[220:221], v24 offset:12832
    ds_read_b64_tr_b16 a[222:223], v24 offset:12960
    s_waitcnt lgkmcnt(0)
    s_waitcnt vmcnt(4)
    ds_read_b64_tr_b16 a[224:225], v24 offset:16384
    ds_read_b64_tr_b16 a[226:227], v24 offset:16512
    ds_read_b64_tr_b16 a[228:229], v24 offset:16896
    ds_read_b64_tr_b16 a[230:231], v24 offset:17024
    ds_read_b64_tr_b16 a[232:233], v24 offset:16416
    ds_read_b64_tr_b16 a[234:235], v24 offset:16544
    ds_read_b64_tr_b16 a[236:237], v24 offset:16928
    ds_read_b64_tr_b16 a[238:239], v24 offset:17056
    s_waitcnt lgkmcnt(0)
    s_waitcnt vmcnt(0)
    ds_read_b64_tr_b16 a[240:241], v24 offset:20480
    ds_read_b64_tr_b16 a[242:243], v24 offset:20608
    ds_read_b64_tr_b16 a[244:245], v24 offset:20992
    ds_read_b64_tr_b16 a[246:247], v24 offset:21120
    ds_read_b64_tr_b16 a[248:249], v24 offset:20512
    ds_read_b64_tr_b16 a[250:251], v24 offset:20640
    ds_read_b64_tr_b16 a[252:253], v24 offset:21024
    ds_read_b64_tr_b16 a[254:255], v24 offset:21152
    s_waitcnt lgkmcnt(0)
    v_lshlrev_b32 v0, 4, v20
    s_lshl_b32 s33, s3, 11
    v_add_u32 v1, s33, v0
    v_lshrrev_b32 v6, 3, v22
    v_mul_u32_u24 v6, 0xaaaa, v6
    v_add_u32 v4, 0x4444, v6
    v_lshrrev_b32 v6, 5, v20
    s_lshl_b32 s33, s3, 1
    v_add_u32 v6, s33, v6
    v_and_b32 v7, 1, v21
    v_lshlrev_b32 v7, 10, v7
    v_lshl_add_u32 v7, v22, 4, v7
    v_lshrrev_b32 v8, 2, v6
    v_lshl_add_u32 v7, v8, 8, v7
    v_and_b32 v8, 3, v6
    v_lshl_add_u32 v2, v8, 2, v7
    v_mul_u32_u24 v6, 2560, v6
    v_and_b32 v7, 31, v20
    v_lshl_add_u32 v3, v7, 1, v6
    v_and_b32 v5, 7, v22
    v_lshlrev_b32 v5, 7, v5
    s_mul_i32 s42, s39, 20480
    s_lshl_b32 s33, s40, 6
    s_add_u32 s42, s42, s33
    s_lshl_b32 s41, s39, 16
    s_lshl_b32 s33, s3, 14
    s_add_u32 s41, s41, s33
    s_add_u32 s41, s41, 81788928
    s_lshl_b32 s43, s3, 10
    s_add_u32 s43, s43, 69232640
    s_mov_b32 s44, 0
    s_mov_b32 s45, 0
    s_barrier
    s_add_u32 s41, s41, 14942208
    s_add_u32 s42, s42, 4669440
    s_lshr_b32 s45, s39, 2
    s_add_u32 s45, s45, 57
L_o2_loop:
    s_mov_b32 s50, s43
    s_mov_b32 s51, s45
    s_cmp_eq_u32 s45, 63
    s_cselect_b32 s51, 0, s51
    s_cselect_b32 s33, 4, 0
    s_add_u32 s50, s50, s33
L_o2_z:
    v_mov_b64 v[160:161], 0
    v_mov_b64 v[162:163], 0
    v_mov_b64 v[164:165], 0
    v_mov_b64 v[166:167], 0
    s_mov_b32 s32, 262144
    s_mov_b32 s33, s41
    s_branch L_o2_p
L_o2_w:
    s_sleep 8
L_o2_p:
    buffer_load_dword v6, v5, s[4:7], s50 offen sc1
    s_sub_u32 s32, s32, 1
    s_cbranch_scc1 L_abort
    s_waitcnt vmcnt(0)
    v_cmp_gt_u32 vcc, s51, v6
    s_cbranch_vccnz L_o2_w
    v_cmp_ge_u32 vcc, s45, v6
    s_cbranch_vccnz L_o2_p
    buffer_load_dwordx4 v[32:35], v0, s[4:7], s33 offen offset:0 sc1
    buffer_load_dwordx4 v[36:39], v0, s[4:7], s33 offen offset:1024 sc1
    buffer_load_dwordx4 v[40:43], v0, s[4:7], s33 offen offset:2048 sc1
    buffer_load_dwordx4 v[44:47], v0, s[4:7], s33 offen offset:3072 sc1
    s_add_u32 s33, s33, 4096
    buffer_load_dwordx4 v[48:51], v0, s[4:7], s33 offen offset:0 sc1
    buffer_load_dwordx4 v[52:55], v0, s[4:7], s33 offen offset:1024 sc1
    buffer_load_dwordx4 v[56:59], v0, s[4:7], s33 offen offset:2048 sc1
    buffer_load_dwordx4 v[60:63], v0, s[4:7], s33 offen offset:3072 sc1
    s_add_u32 s33, s33, 4096
    buffer_load_dwordx4 v[64:67], v0, s[4:7], s33 offen offset:0 sc1
    buffer_load_dwordx4 v[68:71], v0, s[4:7], s33 offen offset:1024 sc1
    buffer_load_dwordx4 v[72:75], v0, s[4:7], s33 offen offset:2048 sc1
    buffer_load_dwordx4 v[76:79], v0, s[4:7], s33 offen offset:3072 sc1
    s_add_u32 s33, s33, 4096
    buffer_load_dwordx4 v[80:83], v0, s[4:7], s33 offen offset:0 sc1
    buffer_load_dwordx4 v[84:87], v0, s[4:7], s33 offen offset:1024 sc1
    buffer_load_dwordx4 v[88:91], v0, s[4:7], s33 offen offset:2048 sc1
    buffer_load_dwordx4 v[92:95], v0, s[4:7], s33 offen offset:3072 sc1
    s_waitcnt vmcnt(15)
    v_smfmac_f32_16x16x64_bf16 v[160:163], v[32:35], a[0:7], v4
    v_smfmac_f32_16x16x64_bf16 v[164:167], v[32:35], a[8:15], v4
    s_waitcnt vmcnt(14)
    v_smfmac_f32_16x16x64_bf16 v[160:163], v[36:39], a[16:23], v4
    v_smfmac_f32_16x16x64_bf16 v[164:167], v[36:39], a[24:31], v4
    s_waitcnt vmcnt(13)
    v_smfmac_f32_16x16x64_bf16 v[160:163], v[40:43], a[32:39], v4
    v_smfmac_f32_16x16x64_bf16 v[164:167], v[40:43], a[40:47], v4
    s_waitcnt vmcnt(12)
    v_smfmac_f32_16x16x64_bf16 v[160:163], v[44:47], a[48:55], v4
    v_smfmac_f32_16x16x64_bf16 v[164:167], v[44:47], a[56:63], v4
    s_waitcnt vmcnt(11)
    v_smfmac_f32_16x16x64_bf16 v[160:163], v[48:51], a[64:71], v4
    v_smfmac_f32_16x16x64_bf16 v[164:167], v[48:51], a[72:79], v4
    s_waitcnt vmcnt(10)
    v_smfmac_f32_16x16x64_bf16 v[160:163], v[52:55], a[80:87], v4
    v_smfmac_f32_16x16x64_bf16 v[164:167], v[52:55], a[88:95], v4
    s_waitcnt vmcnt(9)
    v_smfmac_f32_16x16x64_bf16 v[160:163], v[56:59], a[96:103], v4
    v_smfmac_f32_16x16x64_bf16 v[164:167], v[56:59], a[104:111], v4
    s_waitcnt vmcnt(8)
    v_smfmac_f32_16x16x64_bf16 v[160:163], v[60:63], a[112:119], v4
    v_smfmac_f32_16x16x64_bf16 v[164:167], v[60:63], a[120:127], v4
    s_waitcnt vmcnt(7)
    v_smfmac_f32_16x16x64_bf16 v[160:163], v[64:67], a[128:135], v4
    v_smfmac_f32_16x16x64_bf16 v[164:167], v[64:67], a[136:143], v4
    s_waitcnt vmcnt(6)
    v_smfmac_f32_16x16x64_bf16 v[160:163], v[68:71], a[144:151], v4
    v_smfmac_f32_16x16x64_bf16 v[164:167], v[68:71], a[152:159], v4
    s_waitcnt vmcnt(5)
    v_smfmac_f32_16x16x64_bf16 v[160:163], v[72:75], a[160:167], v4
    v_smfmac_f32_16x16x64_bf16 v[164:167], v[72:75], a[168:175], v4
    s_waitcnt vmcnt(4)
    v_smfmac_f32_16x16x64_bf16 v[160:163], v[76:79], a[176:183], v4
    v_smfmac_f32_16x16x64_bf16 v[164:167], v[76:79], a[184:191], v4
    s_waitcnt vmcnt(3)
    v_smfmac_f32_16x16x64_bf16 v[160:163], v[80:83], a[192:199], v4
    v_smfmac_f32_16x16x64_bf16 v[164:167], v[80:83], a[200:207], v4
    s_waitcnt vmcnt(2)
    v_smfmac_f32_16x16x64_bf16 v[160:163], v[84:87], a[208:215], v4
    v_smfmac_f32_16x16x64_bf16 v[164:167], v[84:87], a[216:223], v4
    s_waitcnt vmcnt(1)
    v_smfmac_f32_16x16x64_bf16 v[160:163], v[88:91], a[224:231], v4
    v_smfmac_f32_16x16x64_bf16 v[164:167], v[88:91], a[232:239], v4
    s_waitcnt vmcnt(0)
    v_smfmac_f32_16x16x64_bf16 v[160:163], v[92:95], a[240:247], v4
    v_smfmac_f32_16x16x64_bf16 v[164:167], v[92:95], a[248:255], v4
    s_cmp_lg_u32 s50, s43
    s_cselect_b64 s[52:53], -1, 0
    s_mov_b32 s50, s43
    s_nop 0
    v_cmp_u_f32 vcc, v160, v161
    v_cmp_u_f32 s[48:49], v162, v163
    s_nop 0
    s_or_b64 vcc, vcc, s[48:49]
    s_and_b64 vcc, vcc, s[52:53]
    s_cbranch_scc1 L_o2_z
L_o2_r:
    ds_write_b128 v1, v[160:163] offset:0
    ds_write_b128 v1, v[164:167] offset:1024
    s_waitcnt lgkmcnt(0)
    s_barrier
    ds_read2st64_b32 v[176:177], v2 offset0:0 offset1:2
    ds_read2st64_b32 v[178:179], v2 offset0:8 offset1:10
    ds_read2st64_b32 v[180:181], v2 offset0:16 offset1:18
    ds_read2st64_b32 v[182:183], v2 offset0:24 offset1:26
    s_waitcnt lgkmcnt(2)
    v_pk_add_f32 v[176:177], v[176:177], v[178:179]
    s_waitcnt lgkmcnt(0)
    v_pk_add_f32 v[180:181], v[180:181], v[182:183]
    v_pk_add_f32 v[176:177], v[176:177], v[180:181]
    v_add_f32 v176, v176, v177
    v_cvt_pk_bf16_f32 v7, v176, v176
    buffer_store_short v7, v3, s[24:27], s42 offen
    v_xor_b32 v1, 16384, v1
    v_xor_b32 v2, 16384, v2
    s_add_u32 s41, s41, 524288
    s_add_u32 s42, s42, 163840
    s_add_u32 s45, s45, 2
    s_cmp_lt_u32 s45, 64
    s_cbranch_scc1 L_o2_loop
    s_endpgm
L_role_t:
    s_load_dwordx2 s[8:9], s[0:1], 24
    s_mov_b32 s10, 5242880
    s_mov_b32 s11, 0x20000
    s_load_dwordx2 s[12:13], s[0:1], 32
    s_mov_b32 s14, 5242880
    s_mov_b32 s15, 0x20000
    v_mbcnt_lo_u32_b32 v20, -1, 0
    v_mbcnt_hi_u32_b32 v20, -1, v20
    v_lshrrev_b32 v21, 4, v20
    v_and_b32 v22, 15, v20
    v_lshrrev_b32 v7, 2, v20
    v_and_b32 v8, 3, v20
    v_lshlrev_b32 v8, 4, v8
    v_lshl_add_u32 v23, v7, 13, v8
    s_mul_i32 s37, s3, 40960
    s_lshl_b32 s38, s21, 8
    s_lshl_b32 s33, s3, 6
    s_add_u32 s38, s38, s33
    v_and_b32 v9, 3, v22
    v_lshlrev_b32 v9, 3, v9
    v_add_u32 v9, s37, v9
    v_lshrrev_b32 v7, 1, v21
    v_lshlrev_b32 v7, 4, v7
    v_and_b32 v8, 1, v21
    v_lshl_add_u32 v7, v8, 2, v7
    v_lshrrev_b32 v8, 3, v22
    v_lshl_add_u32 v7, v8, 3, v7
    v_bfe_u32 v8, v22, 2, 1
    v_add_u32 v7, v7, v8
    v_lshl_add_u32 v24, v7, 6, v9
    s_waitcnt lgkmcnt(0)
    s_barrier
    s_add_u32 m0, s37, 0
    s_add_u32 s33, s38, 0
    buffer_load_dwordx4 v23, s[8:11], s33 offen lds
    s_add_u32 m0, s37, 1024
    s_add_u32 s33, s38, 131072
    buffer_load_dwordx4 v23, s[8:11], s33 offen lds
    s_add_u32 m0, s37, 2048
    s_add_u32 s33, s38, 262144
    buffer_load_dwordx4 v23, s[8:11], s33 offen lds
    s_add_u32 m0, s37, 3072
    s_add_u32 s33, s38, 393216
    buffer_load_dwordx4 v23, s[8:11], s33 offen lds
    s_add_u32 m0, s37, 4096
    s_add_u32 s33, s38, 0
    buffer_load_dwordx4 v23, s[12:15], s33 offen lds
    s_add_u32 m0, s37, 5120
    s_add_u32 s33, s38, 131072
    buffer_load_dwordx4 v23, s[12:15], s33 offen lds
    s_add_u32 m0, s37, 6144
    s_add_u32 s33, s38, 262144
    buffer_load_dwordx4 v23, s[12:15], s33 offen lds
    s_add_u32 m0, s37, 7168
    s_add_u32 s33, s38, 393216
    buffer_load_dwordx4 v23, s[12:15], s33 offen lds
    s_add_u32 m0, s37, 8192
    s_add_u32 s33, s38, 524288
    buffer_load_dwordx4 v23, s[8:11], s33 offen lds
    s_add_u32 m0, s37, 9216
    s_add_u32 s33, s38, 655360
    buffer_load_dwordx4 v23, s[8:11], s33 offen lds
    s_add_u32 m0, s37, 10240
    s_add_u32 s33, s38, 786432
    buffer_load_dwordx4 v23, s[8:11], s33 offen lds
    s_add_u32 m0, s37, 11264
    s_add_u32 s33, s38, 917504
    buffer_load_dwordx4 v23, s[8:11], s33 offen lds
    s_add_u32 m0, s37, 12288
    s_add_u32 s33, s38, 524288
    buffer_load_dwordx4 v23, s[12:15], s33 offen lds
    s_add_u32 m0, s37, 13312
    s_add_u32 s33, s38, 655360
    buffer_load_dwordx4 v23, s[12:15], s33 offen lds
    s_add_u32 m0, s37, 14336
    s_add_u32 s33, s38, 786432
    buffer_load_dwordx4 v23, s[12:15], s33 offen lds
    s_add_u32 m0, s37, 15360
    s_add_u32 s33, s38, 917504
    buffer_load_dwordx4 v23, s[12:15], s33 offen lds
    s_add_u32 m0, s37, 16384
    s_add_u32 s33, s38, 1048576
    buffer_load_dwordx4 v23, s[8:11], s33 offen lds
    s_add_u32 m0, s37, 17408
    s_add_u32 s33, s38, 1179648
    buffer_load_dwordx4 v23, s[8:11], s33 offen lds
    s_add_u32 m0, s37, 18432
    s_add_u32 s33, s38, 1310720
    buffer_load_dwordx4 v23, s[8:11], s33 offen lds
    s_add_u32 m0, s37, 19456
    s_add_u32 s33, s38, 1441792
    buffer_load_dwordx4 v23, s[8:11], s33 offen lds
    s_add_u32 m0, s37, 20480
    s_add_u32 s33, s38, 1048576
    buffer_load_dwordx4 v23, s[12:15], s33 offen lds
    s_add_u32 m0, s37, 21504
    s_add_u32 s33, s38, 1179648
    buffer_load_dwordx4 v23, s[12:15], s33 offen lds
    s_add_u32 m0, s37, 22528
    s_add_u32 s33, s38, 1310720
    buffer_load_dwordx4 v23, s[12:15], s33 offen lds
    s_add_u32 m0, s37, 23552
    s_add_u32 s33, s38, 1441792
    buffer_load_dwordx4 v23, s[12:15], s33 offen lds
    s_add_u32 m0, s37, 24576
    s_add_u32 s33, s38, 1572864
    buffer_load_dwordx4 v23, s[8:11], s33 offen lds
    s_add_u32 m0, s37, 25600
    s_add_u32 s33, s38, 1703936
    buffer_load_dwordx4 v23, s[8:11], s33 offen lds
    s_add_u32 m0, s37, 26624
    s_add_u32 s33, s38, 1835008
    buffer_load_dwordx4 v23, s[8:11], s33 offen lds
    s_add_u32 m0, s37, 27648
    s_add_u32 s33, s38, 1966080
    buffer_load_dwordx4 v23, s[8:11], s33 offen lds
    s_add_u32 m0, s37, 28672
    s_add_u32 s33, s38, 1572864
    buffer_load_dwordx4 v23, s[12:15], s33 offen lds
    s_add_u32 m0, s37, 29696
    s_add_u32 s33, s38, 1703936
    buffer_load_dwordx4 v23, s[12:15], s33 offen lds
    s_add_u32 m0, s37, 30720
    s_add_u32 s33, s38, 1835008
    buffer_load_dwordx4 v23, s[12:15], s33 offen lds
    s_add_u32 m0, s37, 31744
    s_add_u32 s33, s38, 1966080
    buffer_load_dwordx4 v23, s[12:15], s33 offen lds
    s_add_u32 m0, s37, 32768
    s_add_u32 s33, s38, 2097152
    buffer_load_dwordx4 v23, s[8:11], s33 offen lds
    s_add_u32 m0, s37, 33792
    s_add_u32 s33, s38, 2228224
    buffer_load_dwordx4 v23, s[8:11], s33 offen lds
    s_add_u32 m0, s37, 34816
    s_add_u32 s33, s38, 2359296
    buffer_load_dwordx4 v23, s[8:11], s33 offen lds
    s_add_u32 m0, s37, 35840
    s_add_u32 s33, s38, 2490368
    buffer_load_dwordx4 v23, s[8:11], s33 offen lds
    s_add_u32 m0, s37, 36864
    s_add_u32 s33, s38, 2097152
    buffer_load_dwordx4 v23, s[12:15], s33 offen lds
    s_add_u32 m0, s37, 37888
    s_add_u32 s33, s38, 2228224
    buffer_load_dwordx4 v23, s[12:15], s33 offen lds
    s_add_u32 m0, s37, 38912
    s_add_u32 s33, s38, 2359296
    buffer_load_dwordx4 v23, s[12:15], s33 offen lds
    s_add_u32 m0, s37, 39936
    s_add_u32 s33, s38, 2490368
    buffer_load_dwordx4 v23, s[12:15], s33 offen lds
    s_waitcnt vmcnt(36)
    ds_read_b64_tr_b16 v[192:193], v24 offset:0
    ds_read_b64_tr_b16 v[194:195], v24 offset:128
    ds_read_b64_tr_b16 v[196:197], v24 offset:2048
    ds_read_b64_tr_b16 v[198:199], v24 offset:2176
    ds_read_b64_tr_b16 v[200:201], v24 offset:32
    ds_read_b64_tr_b16 v[202:203], v24 offset:160
    ds_read_b64_tr_b16 v[204:205], v24 offset:2080
    ds_read_b64_tr_b16 v[206:207], v24 offset:2208
    s_waitcnt lgkmcnt(0)
    s_add_u32 m0, s37, 0
    s_add_u32 s33, s38, 2621440
    buffer_load_dwordx4 v23, s[8:11], s33 offen lds
    s_add_u32 m0, s37, 1024
    s_add_u32 s33, s38, 2752512
    buffer_load_dwordx4 v23, s[8:11], s33 offen lds
    s_add_u32 m0, s37, 2048
    s_add_u32 s33, s38, 2883584
    buffer_load_dwordx4 v23, s[8:11], s33 offen lds
    s_add_u32 m0, s37, 3072
    s_add_u32 s33, s38, 3014656
    buffer_load_dwordx4 v23, s[8:11], s33 offen lds
    s_waitcnt vmcnt(36)
    ds_read_b64_tr_b16 v[208:209], v24 offset:4096
    ds_read_b64_tr_b16 v[210:211], v24 offset:4224
    ds_read_b64_tr_b16 v[212:213], v24 offset:6144
    ds_read_b64_tr_b16 v[214:215], v24 offset:6272
    ds_read_b64_tr_b16 v[216:217], v24 offset:4128
    ds_read_b64_tr_b16 v[218:219], v24 offset:4256
    ds_read_b64_tr_b16 v[220:221], v24 offset:6176
    ds_read_b64_tr_b16 v[222:223], v24 offset:6304
    s_waitcnt lgkmcnt(0)
    s_add_u32 m0, s37, 4096
    s_add_u32 s33, s38, 2621440
    buffer_load_dwordx4 v23, s[12:15], s33 offen lds
    s_add_u32 m0, s37, 5120
    s_add_u32 s33, s38, 2752512
    buffer_load_dwordx4 v23, s[12:15], s33 offen lds
    s_add_u32 m0, s37, 6144
    s_add_u32 s33, s38, 2883584
    buffer_load_dwordx4 v23, s[12:15], s33 offen lds
    s_add_u32 m0, s37, 7168
    s_add_u32 s33, s38, 3014656
    buffer_load_dwordx4 v23, s[12:15], s33 offen lds
    s_waitcnt vmcnt(36)
    ds_read_b64_tr_b16 v[224:225], v24 offset:8192
    ds_read_b64_tr_b16 v[226:227], v24 offset:8320
    ds_read_b64_tr_b16 v[228:229], v24 offset:10240
    ds_read_b64_tr_b16 v[230:231], v24 offset:10368
    ds_read_b64_tr_b16 v[232:233], v24 offset:8224
    ds_read_b64_tr_b16 v[234:235], v24 offset:8352
    ds_read_b64_tr_b16 v[236:237], v24 offset:10272
    ds_read_b64_tr_b16 v[238:239], v24 offset:10400
    s_waitcnt lgkmcnt(0)
    s_add_u32 m0, s37, 8192
    s_add_u32 s33, s38, 3145728
    buffer_load_dwordx4 v23, s[8:11], s33 offen lds
    s_add_u32 m0, s37, 9216
    s_add_u32 s33, s38, 3276800
    buffer_load_dwordx4 v23, s[8:11], s33 offen lds
    s_add_u32 m0, s37, 10240
    s_add_u32 s33, s38, 3407872
    buffer_load_dwordx4 v23, s[8:11], s33 offen lds
    s_add_u32 m0, s37, 11264
    s_add_u32 s33, s38, 3538944
    buffer_load_dwordx4 v23, s[8:11], s33 offen lds
    s_waitcnt vmcnt(36)
    ds_read_b64_tr_b16 v[240:241], v24 offset:12288
    ds_read_b64_tr_b16 v[242:243], v24 offset:12416
    ds_read_b64_tr_b16 v[244:245], v24 offset:14336
    ds_read_b64_tr_b16 v[246:247], v24 offset:14464
    ds_read_b64_tr_b16 v[248:249], v24 offset:12320
    ds_read_b64_tr_b16 v[250:251], v24 offset:12448
    ds_read_b64_tr_b16 v[252:253], v24 offset:14368
    ds_read_b64_tr_b16 v[254:255], v24 offset:14496
    s_waitcnt lgkmcnt(0)
    s_add_u32 m0, s37, 12288
    s_add_u32 s33, s38, 3145728
    buffer_load_dwordx4 v23, s[12:15], s33 offen lds
    s_add_u32 m0, s37, 13312
    s_add_u32 s33, s38, 3276800
    buffer_load_dwordx4 v23, s[12:15], s33 offen lds
    s_add_u32 m0, s37, 14336
    s_add_u32 s33, s38, 3407872
    buffer_load_dwordx4 v23, s[12:15], s33 offen lds
    s_add_u32 m0, s37, 15360
    s_add_u32 s33, s38, 3538944
    buffer_load_dwordx4 v23, s[12:15], s33 offen lds
    s_waitcnt vmcnt(36)
    ds_read_b64_tr_b16 a[0:1], v24 offset:16384
    ds_read_b64_tr_b16 a[2:3], v24 offset:16512
    ds_read_b64_tr_b16 a[4:5], v24 offset:18432
    ds_read_b64_tr_b16 a[6:7], v24 offset:18560
    ds_read_b64_tr_b16 a[8:9], v24 offset:16416
    ds_read_b64_tr_b16 a[10:11], v24 offset:16544
    ds_read_b64_tr_b16 a[12:13], v24 offset:18464
    ds_read_b64_tr_b16 a[14:15], v24 offset:18592
    s_waitcnt lgkmcnt(0)
    s_add_u32 m0, s37, 16384
    s_add_u32 s33, s38, 3670016
    buffer_load_dwordx4 v23, s[8:11], s33 offen lds
    s_add_u32 m0, s37, 17408
    s_add_u32 s33, s38, 3801088
    buffer_load_dwordx4 v23, s[8:11], s33 offen lds
    s_add_u32 m0, s37, 18432
    s_add_u32 s33, s38, 3932160
    buffer_load_dwordx4 v23, s[8:11], s33 offen lds
    s_add_u32 m0, s37, 19456
    s_add_u32 s33, s38, 4063232
    buffer_load_dwordx4 v23, s[8:11], s33 offen lds
    s_waitcnt vmcnt(36)
    ds_read_b64_tr_b16 a[16:17], v24 offset:20480
    ds_read_b64_tr_b16 a[18:19], v24 offset:20608
    ds_read_b64_tr_b16 a[20:21], v24 offset:22528
    ds_read_b64_tr_b16 a[22:23], v24 offset:22656
    ds_read_b64_tr_b16 a[24:25], v24 offset:20512
    ds_read_b64_tr_b16 a[26:27], v24 offset:20640
    ds_read_b64_tr_b16 a[28:29], v24 offset:22560
    ds_read_b64_tr_b16 a[30:31], v24 offset:22688
    s_waitcnt lgkmcnt(0)
    s_add_u32 m0, s37, 20480
    s_add_u32 s33, s38, 3670016
    buffer_load_dwordx4 v23, s[12:15], s33 offen lds
    s_add_u32 m0, s37, 21504
    s_add_u32 s33, s38, 3801088
    buffer_load_dwordx4 v23, s[12:15], s33 offen lds
    s_add_u32 m0, s37, 22528
    s_add_u32 s33, s38, 3932160
    buffer_load_dwordx4 v23, s[12:15], s33 offen lds
    s_add_u32 m0, s37, 23552
    s_add_u32 s33, s38, 4063232
    buffer_load_dwordx4 v23, s[12:15], s33 offen lds
    s_waitcnt vmcnt(36)
    ds_read_b64_tr_b16 a[32:33], v24 offset:24576
    ds_read_b64_tr_b16 a[34:35], v24 offset:24704
    ds_read_b64_tr_b16 a[36:37], v24 offset:26624
    ds_read_b64_tr_b16 a[38:39], v24 offset:26752
    ds_read_b64_tr_b16 a[40:41], v24 offset:24608
    ds_read_b64_tr_b16 a[42:43], v24 offset:24736
    ds_read_b64_tr_b16 a[44:45], v24 offset:26656
    ds_read_b64_tr_b16 a[46:47], v24 offset:26784
    s_waitcnt lgkmcnt(0)
    s_add_u32 m0, s37, 24576
    s_add_u32 s33, s38, 4194304
    buffer_load_dwordx4 v23, s[8:11], s33 offen lds
    s_add_u32 m0, s37, 25600
    s_add_u32 s33, s38, 4325376
    buffer_load_dwordx4 v23, s[8:11], s33 offen lds
    s_add_u32 m0, s37, 26624
    s_add_u32 s33, s38, 4456448
    buffer_load_dwordx4 v23, s[8:11], s33 offen lds
    s_add_u32 m0, s37, 27648
    s_add_u32 s33, s38, 4587520
    buffer_load_dwordx4 v23, s[8:11], s33 offen lds
    s_waitcnt vmcnt(36)
    ds_read_b64_tr_b16 a[48:49], v24 offset:28672
    ds_read_b64_tr_b16 a[50:51], v24 offset:28800
    ds_read_b64_tr_b16 a[52:53], v24 offset:30720
    ds_read_b64_tr_b16 a[54:55], v24 offset:30848
    ds_read_b64_tr_b16 a[56:57], v24 offset:28704
    ds_read_b64_tr_b16 a[58:59], v24 offset:28832
    ds_read_b64_tr_b16 a[60:61], v24 offset:30752
    ds_read_b64_tr_b16 a[62:63], v24 offset:30880
    s_waitcnt lgkmcnt(0)
    s_add_u32 m0, s37, 28672
    s_add_u32 s33, s38, 4194304
    buffer_load_dwordx4 v23, s[12:15], s33 offen lds
    s_add_u32 m0, s37, 29696
    s_add_u32 s33, s38, 4325376
    buffer_load_dwordx4 v23, s[12:15], s33 offen lds
    s_add_u32 m0, s37, 30720
    s_add_u32 s33, s38, 4456448
    buffer_load_dwordx4 v23, s[12:15], s33 offen lds
    s_add_u32 m0, s37, 31744
    s_add_u32 s33, s38, 4587520
    buffer_load_dwordx4 v23, s[12:15], s33 offen lds
    s_waitcnt vmcnt(36)
    ds_read_b64_tr_b16 a[64:65], v24 offset:32768
    ds_read_b64_tr_b16 a[66:67], v24 offset:32896
    ds_read_b64_tr_b16 a[68:69], v24 offset:34816
    ds_read_b64_tr_b16 a[70:71], v24 offset:34944
    ds_read_b64_tr_b16 a[72:73], v24 offset:32800
    ds_read_b64_tr_b16 a[74:75], v24 offset:32928
    ds_read_b64_tr_b16 a[76:77], v24 offset:34848
    ds_read_b64_tr_b16 a[78:79], v24 offset:34976
    s_waitcnt lgkmcnt(0)
    s_add_u32 m0, s37, 32768
    s_add_u32 s33, s38, 4718592
    buffer_load_dwordx4 v23, s[8:11], s33 offen lds
    s_add_u32 m0, s37, 33792
    s_add_u32 s33, s38, 4849664
    buffer_load_dwordx4 v23, s[8:11], s33 offen lds
    s_add_u32 m0, s37, 34816
    s_add_u32 s33, s38, 4980736
    buffer_load_dwordx4 v23, s[8:11], s33 offen lds
    s_add_u32 m0, s37, 35840
    s_add_u32 s33, s38, 5111808
    buffer_load_dwordx4 v23, s[8:11], s33 offen lds
    s_waitcnt vmcnt(36)
    ds_read_b64_tr_b16 a[80:81], v24 offset:36864
    ds_read_b64_tr_b16 a[82:83], v24 offset:36992
    ds_read_b64_tr_b16 a[84:85], v24 offset:38912
    ds_read_b64_tr_b16 a[86:87], v24 offset:39040
    ds_read_b64_tr_b16 a[88:89], v24 offset:36896
    ds_read_b64_tr_b16 a[90:91], v24 offset:37024
    ds_read_b64_tr_b16 a[92:93], v24 offset:38944
    ds_read_b64_tr_b16 a[94:95], v24 offset:39072
    s_waitcnt lgkmcnt(0)
    s_add_u32 m0, s37, 36864
    s_add_u32 s33, s38, 4718592
    buffer_load_dwordx4 v23, s[12:15], s33 offen lds
    s_add_u32 m0, s37, 37888
    s_add_u32 s33, s38, 4849664
    buffer_load_dwordx4 v23, s[12:15], s33 offen lds
    s_add_u32 m0, s37, 38912
    s_add_u32 s33, s38, 4980736
    buffer_load_dwordx4 v23, s[12:15], s33 offen lds
    s_add_u32 m0, s37, 39936
    s_add_u32 s33, s38, 5111808
    buffer_load_dwordx4 v23, s[12:15], s33 offen lds
    s_waitcnt vmcnt(36)
    ds_read_b64_tr_b16 a[96:97], v24 offset:0
    ds_read_b64_tr_b16 a[98:99], v24 offset:128
    ds_read_b64_tr_b16 a[100:101], v24 offset:2048
    ds_read_b64_tr_b16 a[102:103], v24 offset:2176
    ds_read_b64_tr_b16 a[104:105], v24 offset:32
    ds_read_b64_tr_b16 a[106:107], v24 offset:160
    ds_read_b64_tr_b16 a[108:109], v24 offset:2080
    ds_read_b64_tr_b16 a[110:111], v24 offset:2208
    s_waitcnt lgkmcnt(0)
    s_waitcnt vmcnt(32)
    ds_read_b64_tr_b16 a[112:113], v24 offset:4096
    ds_read_b64_tr_b16 a[114:115], v24 offset:4224
    ds_read_b64_tr_b16 a[116:117], v24 offset:6144
    ds_read_b64_tr_b16 a[118:119], v24 offset:6272
    ds_read_b64_tr_b16 a[120:121], v24 offset:4128
    ds_read_b64_tr_b16 a[122:123], v24 offset:4256
    ds_read_b64_tr_b16 a[124:125], v24 offset:6176
    ds_read_b64_tr_b16 a[126:127], v24 offset:6304
    s_waitcnt lgkmcnt(0)
    s_waitcnt vmcnt(28)
    ds_read_b64_tr_b16 a[128:129], v24 offset:8192
    ds_read_b64_tr_b16 a[130:131], v24 offset:8320
    ds_read_b64_tr_b16 a[132:133], v24 offset:10240
    ds_read_b64_tr_b16 a[134:135], v24 offset:10368
    ds_read_b64_tr_b16 a[136:137], v24 offset:8224
    ds_read_b64_tr_b16 a[138:139], v24 offset:8352
    ds_read_b64_tr_b16 a[140:141], v24 offset:10272
    ds_read_b64_tr_b16 a[142:143], v24 offset:10400
    s_waitcnt lgkmcnt(0)
    s_waitcnt vmcnt(24)
    ds_read_b64_tr_b16 a[144:145], v24 offset:12288
    ds_read_b64_tr_b16 a[146:147], v24 offset:12416
    ds_read_b64_tr_b16 a[148:149], v24 offset:14336
    ds_read_b64_tr_b16 a[150:151], v24 offset:14464
    ds_read_b64_tr_b16 a[152:153], v24 offset:12320
    ds_read_b64_tr_b16 a[154:155], v24 offset:12448
    ds_read_b64_tr_b16 a[156:157], v24 offset:14368
    ds_read_b64_tr_b16 a[158:159], v24 offset:14496
    s_waitcnt lgkmcnt(0)
    s_waitcnt vmcnt(20)
    ds_read_b64_tr_b16 a[160:161], v24 offset:16384
    ds_read_b64_tr_b16 a[162:163], v24 offset:16512
    ds_read_b64_tr_b16 a[164:165], v24 offset:18432
    ds_read_b64_tr_b16 a[166:167], v24 offset:18560
    ds_read_b64_tr_b16 a[168:169], v24 offset:16416
    ds_read_b64_tr_b16 a[170:171], v24 offset:16544
    ds_read_b64_tr_b16 a[172:173], v24 offset:18464
    ds_read_b64_tr_b16 a[174:175], v24 offset:18592
    s_waitcnt lgkmcnt(0)
    s_waitcnt vmcnt(16)
    ds_read_b64_tr_b16 a[176:177], v24 offset:20480
    ds_read_b64_tr_b16 a[178:179], v24 offset:20608
    ds_read_b64_tr_b16 a[180:181], v24 offset:22528
    ds_read_b64_tr_b16 a[182:183], v24 offset:22656
    ds_read_b64_tr_b16 a[184:185], v24 offset:20512
    ds_read_b64_tr_b16 a[186:187], v24 offset:20640
    ds_read_b64_tr_b16 a[188:189], v24 offset:22560
    ds_read_b64_tr_b16 a[190:191], v24 offset:22688
    s_waitcnt lgkmcnt(0)
    s_waitcnt vmcnt(12)
    ds_read_b64_tr_b16 a[192:193], v24 offset:24576
    ds_read_b64_tr_b16 a[194:195], v24 offset:24704
    ds_read_b64_tr_b16 a[196:197], v24 offset:26624
    ds_read_b64_tr_b16 a[198:199], v24 offset:26752
    ds_read_b64_tr_b16 a[200:201], v24 offset:24608
    ds_read_b64_tr_b16 a[202:203], v24 offset:24736
    ds_read_b64_tr_b16 a[204:205], v24 offset:26656
    ds_read_b64_tr_b16 a[206:207], v24 offset:26784
    s_waitcnt lgkmcnt(0)
    s_waitcnt vmcnt(8)
    ds_read_b64_tr_b16 a[208:209], v24 offset:28672
    ds_read_b64_tr_b16 a[210:211], v24 offset:28800
    ds_read_b64_tr_b16 a[212:213], v24 offset:30720
    ds_read_b64_tr_b16 a[214:215], v24 offset:30848
    ds_read_b64_tr_b16 a[216:217], v24 offset:28704
    ds_read_b64_tr_b16 a[218:219], v24 offset:28832
    ds_read_b64_tr_b16 a[220:221], v24 offset:30752
    ds_read_b64_tr_b16 a[222:223], v24 offset:30880
    s_waitcnt lgkmcnt(0)
    s_waitcnt vmcnt(4)
    ds_read_b64_tr_b16 a[224:225], v24 offset:32768
    ds_read_b64_tr_b16 a[226:227], v24 offset:32896
    ds_read_b64_tr_b16 a[228:229], v24 offset:34816
    ds_read_b64_tr_b16 a[230:231], v24 offset:34944
    ds_read_b64_tr_b16 a[232:233], v24 offset:32800
    ds_read_b64_tr_b16 a[234:235], v24 offset:32928
    ds_read_b64_tr_b16 a[236:237], v24 offset:34848
    ds_read_b64_tr_b16 a[238:239], v24 offset:34976
    s_waitcnt lgkmcnt(0)
    s_waitcnt vmcnt(0)
    ds_read_b64_tr_b16 a[240:241], v24 offset:36864
    ds_read_b64_tr_b16 a[242:243], v24 offset:36992
    ds_read_b64_tr_b16 a[244:245], v24 offset:38912
    ds_read_b64_tr_b16 a[246:247], v24 offset:39040
    ds_read_b64_tr_b16 a[248:249], v24 offset:36896
    ds_read_b64_tr_b16 a[250:251], v24 offset:37024
    ds_read_b64_tr_b16 a[252:253], v24 offset:38944
    ds_read_b64_tr_b16 a[254:255], v24 offset:39072
    s_waitcnt lgkmcnt(0)
    s_mov_b32 s34, 0
    s_cmp_lg_u32 s22, 0
    s_cbranch_scc1 L_cd_17
    s_mov_b32 s32, 262144
    v_mbcnt_lo_u32_b32 v15, -1, 0
    v_mbcnt_hi_u32_b32 v15, -1, v15
    v_lshlrev_b32 v15, 2, v15
L_c_18:
    s_sleep 4
    buffer_load_dword v14, v15, s[16:19], 0 offen sc1
    s_sub_u32 s32, s32, 1
    s_cbranch_scc1 L_abort
    s_waitcnt vmcnt(0)
L_c_18_l:
    v_cmp_lt_u32 vcc, 32, v14
    v_readlane_b32 s36, v14, 48
    v_readlane_b32 s34, v14, 50
    s_and_b32 s33, vcc_lo, 0x10001
    s_and_b32 s35, vcc_hi, 0x3f
    s_or_b32 s33, s33, s35
    s_cbranch_scc1 L_recheck
    v_cmp_ne_u32 vcc, 32, v14
    s_nop 0
    s_and_b32 s33, vcc_lo, 0x10001
    s_and_b32 s35, vcc_hi, 0x3f
    s_or_b32 s33, s33, s35
    s_cbranch_scc1 L_c_18
    s_cmp_lt_u32 s36, 192
    s_cbranch_scc1 L_c_18
    s_cmp_lt_u32 s34, 48
    s_cbranch_scc1 L_c_18
L_cd_17:
    s_and_b32 s43, s34, 3
    s_lshl_b32 s43, s43, 13
    s_and_b32 s44, s34, 12
    s_lshl_b32 s44, s44, 11
    s_add_u32 s44, s44, 75497472
    s_add_u32 s43, s43, 71303168
    v_mbcnt_lo_u32_b32 v20, -1, 0
    v_mbcnt_hi_u32_b32 v20, -1, v20
    v_lshrrev_b32 v21, 4, v20
    v_and_b32 v22, 15, v20
    v_lshlrev_b32 v0, 4, v20
    s_lshl_b32 s33, s3, 10
    v_add_u32 v1, s33, v0
    v_lshrrev_b32 v2, 2, v1
    v_add_u32 v2, 4096, v2
    v_bfe_u32 v8, v22, 1, 1
    v_mul_u32_u24 v8, 0xaaaa, v8
    v_add_u32 v4, 0x4444, v8
    s_and_b32 s50, s3, 1
    s_lshr_b32 s35, s3, 1
    s_lshl_b32 s33, s35, 11
    v_add_u32 v6, s33, v0
    v_lshrrev_b32 v7, 3, v22
    v_lshlrev_b32 v7, 16, v7
    v_lshl_add_u32 v7, v21, 8, v7
    v_and_b32 v8, 7, v22
    v_lshl_add_u32 v5, v8, 4, v7
    s_lshl_b32 s42, s50, 17
    s_lshl_b32 s33, s21, 11
    s_add_u32 s42, s42, s33
    s_lshl_b32 s33, s35, 10
    s_add_u32 s42, s42, s33
    s_add_u32 s42, s42, 81788928
    s_mul_i32 s39, s21, 24576
    s_lshl_b32 s33, s3, 11
    s_add_u32 s39, s39, s33
    s_add_u32 s39, s39, 16777216
    s_mov_b32 s40, s33
    v_add_u32 v45, 8192, v0
    s_lshl_b32 s33, s50, 10
    s_add_u32 s33, s33, 0
    v_add_u32 v44, s33, v0
    s_lshl_b32 s33, s35, 12
    s_add_u32 s33, s33, 16384
    v_add_u32 v46, s33, v0
    s_lshl_b32 s45, s21, 7
    s_add_u32 s45, s45, 69206016
    s_lshl_b32 s46, s21, 7
    s_add_u32 s46, s46, 69232640
    s_cmp_eq_u32 s3, 0
    s_cselect_b32 s46, s46, 268435456
    s_mov_b32 s47, 0
    s_mov_b32 s48, 0
    s_mov_b32 s49, 0x3e0293ee
    s_lshl_b32 s33, s50, 4
    v_add_u32 v7, s33, v22
    v_lshlrev_b32 v8, 2, v21
    v_sub_u32 v7, v7, v8
    v_cmp_le_i32 s[52:53], 0, v7
    v_cmp_le_i32 s[54:55], 1, v7
    v_cmp_le_i32 s[56:57], 2, v7
    v_cmp_le_i32 s[58:59], 3, v7
    v_cmp_le_i32 s[60:61], 16, v7
    v_cmp_le_i32 s[62:63], 17, v7
    v_cmp_le_i32 s[64:65], 18, v7
    v_cmp_le_i32 s[66:67], 19, v7
    v_lshrrev_b32 v7, 2, v22
    v_cmp_eq_u32 vcc, v7, v21
    v_and_b32 v8, 1, v22
    v_lshlrev_b32 v8, 4, v8
    v_mov_b32 v9, 0x3f80
    v_lshlrev_b32 v9, v8, v9
    v_cndmask_b32 v166, 0, v9, vcc
    v_cndmask_b32 v167, 0, v9, vcc
    v_mov_b64 v[164:165], 0
    v_mov_b64 v[168:169], 0
    v_mov_b64 v[176:177], 0
    v_mov_b64 v[180:181], 0
    v_mov_b32 v170, 0x3f003f00
    v_mov_b32 v171, 0x3f003f00
    v_mov_b32 v172, 0x3f803f80
    v_mov_b32 v173, 0x3f803f80
    v_mov_b32 v174, 0x3f803f80
    v_mov_b32 v175, 0x3f803f80
    v_mov_b32 v11, 0xf149f2ca
    s_barrier
    s_mov_b32 s68, 1
    s_add_u32 s70, s43, 7168
    s_add_u32 s36, s48, 1
    s_min_u32 s35, s36, 63
    s_cmp_lt_u32 s35, s47
    s_cbranch_scc1 L_t_ok0
    s_mov_b32 s32, 262144
    v_min_u32 v7, 32, v0
    v_mul_u32_u24 v7, 264, v7
L_t_p0:
    buffer_load_dword v8, v7, s[4:7], s45 offen sc1
    s_sub_u32 s32, s32, 1
    s_cbranch_scc1 L_abort
    s_waitcnt vmcnt(0)
    v_readlane_b32 s33, v8, 0
    v_readlane_b32 s34, v8, 1
    v_readlane_b32 s47, v8, 2
    s_nop 1
    s_min_u32 s33, s33, s34
    s_min_u32 s47, s47, s33
    s_cmp_lt_u32 s35, s47
    s_cbranch_scc0 L_t_p0
L_t_ok0:
    s_cmp_lt_u32 s36, 64
    s_cselect_b32 s41, s39, 268435456
    s_mov_b32 s41, s39
    s_add_u32 m0, s40, 32768
    s_add_u32 s33, s41, 0
    buffer_load_dwordx4 v0, s[4:7], s33 offen offset:0 sc1 lds
    buffer_load_dwordx4 v0, s[4:7], s33 offen offset:1024 sc1 lds
    s_add_u32 m0, s40, 40960
    s_add_u32 s33, s41, 8192
    buffer_load_dwordx4 v0, s[4:7], s33 offen offset:0 sc1 lds
    buffer_load_dwordx4 v0, s[4:7], s33 offen offset:1024 sc1 lds
    s_add_u32 m0, s40, 49152
    s_add_u32 s33, s41, 16384
    buffer_load_dwordx4 v0, s[4:7], s33 offen offset:0 sc1 lds
    buffer_load_dwordx4 v0, s[4:7], s33 offen offset:1024 sc1 lds
    s_add_u32 s39, s39, 786432
    s_add_u32 s40, s40, 0x8000
    s_and_b32 s40, s40, 0xffff
    s_mov_b32 s41, s39
    s_add_u32 m0, s40, 32768
    s_add_u32 s33, s41, 0
    buffer_load_dwordx4 v0, s[4:7], s33 offen offset:0 sc1 lds
    buffer_load_dwordx4 v0, s[4:7], s33 offen offset:1024 sc1 lds
    s_add_u32 m0, s40, 40960
    s_add_u32 s33, s41, 8192
    buffer_load_dwordx4 v0, s[4:7], s33 offen offset:0 sc1 lds
    buffer_load_dwordx4 v0, s[4:7], s33 offen offset:1024 sc1 lds
    s_add_u32 m0, s40, 49152
    s_add_u32 s33, s41, 16384
    buffer_load_dwordx4 v0, s[4:7], s33 offen offset:0 sc1 lds
    buffer_load_dwordx4 v0, s[4:7], s33 offen offset:1024 sc1 lds
    s_add_u32 s39, s39, 786432
    s_add_u32 s40, s40, 0x8000
    s_and_b32 s40, s40, 0xffff
    s_waitcnt vmcnt(0)
    s_barrier
L_t_loop:
    buffer_load_dword v47, off, s[4:7], s70 sc1
    s_cmp_lt_u32 s48, s68
    s_cselect_b32 s69, 1, 0
    s_cbranch_scc0 L_t_n1
    buffer_load_dwordx4 v[124:127], v1, s[4:7], s43 offen sc1
    buffer_load_dword v132, v2, s[4:7], s43 offen sc1
    buffer_load_dwordx4 v[128:131], v1, s[4:7], s44 offen sc1
    buffer_load_dword v133, v2, s[4:7], s44 offen sc1
L_t_n1:
    ds_read_b128 v[12:15], v44 offset:32768
    ds_read_b128 v[76:79], v45 offset:32768
    ds_read_b128 v[80:83], v45 offset:33792
    ds_read_b128 v[16:19], v44 offset:34816
    ds_read_b128 v[84:87], v45 offset:34816
    ds_read_b128 v[88:91], v45 offset:35840
    ds_read_b128 v[20:23], v44 offset:36864
    ds_read_b128 v[92:95], v45 offset:36864
    ds_read_b128 v[96:99], v45 offset:37888
    ds_read_b128 v[24:27], v44 offset:38912
    ds_read_b128 v[100:103], v45 offset:38912
    ds_read_b128 v[104:107], v45 offset:39936
    v_mov_b64 v[108:109], 0
    v_mov_b64 v[110:111], 0
    v_mov_b64 v[112:113], 0
    v_mov_b64 v[114:115], 0
    v_mov_b64 v[116:117], 0
    v_mov_b64 v[118:119], 0
    v_mov_b64 v[120:121], 0
    v_mov_b64 v[122:123], 0
    s_waitcnt lgkmcnt(10)
    v_mfma_f32_16x16x32_bf16 v[144:147], v[76:79], v[12:15], 0
    s_waitcnt lgkmcnt(9)
    v_mfma_f32_16x16x32_bf16 v[148:151], v[80:83], v[12:15], 0
    ds_read_b128 v[28:31], v46 offset:32768
    s_waitcnt lgkmcnt(8)
    v_mfma_f32_16x16x32_bf16 v[144:147], v[84:87], v[16:19], v[144:147]
    s_waitcnt lgkmcnt(7)
    v_mfma_f32_16x16x32_bf16 v[148:151], v[88:91], v[16:19], v[148:151]
    ds_read_b128 v[32:35], v46 offset:33792
    s_waitcnt lgkmcnt(6)
    v_mfma_f32_16x16x32_bf16 v[144:147], v[92:95], v[20:23], v[144:147]
    s_waitcnt lgkmcnt(5)
    v_mfma_f32_16x16x32_bf16 v[148:151], v[96:99], v[20:23], v[148:151]
    ds_read_b128 v[36:39], v46 offset:34816
    s_waitcnt lgkmcnt(4)
    v_mfma_f32_16x16x32_bf16 v[144:147], v[100:103], v[24:27], v[144:147]
    s_waitcnt lgkmcnt(3)
    v_mfma_f32_16x16x32_bf16 v[148:151], v[104:107], v[24:27], v[148:151]
    ds_read_b128 v[40:43], v46 offset:35840
    v_add_u32 v44, 0x8000, v44
    v_and_b32 v44, 0xffff, v44
    v_add_u32 v45, 0x8000, v45
    v_and_b32 v45, 0xffff, v45
    v_add_u32 v46, 0x8000, v46
    v_and_b32 v46, 0xffff, v46
    v_cndmask_b32 v144, v11, v144, s[52:53]
    v_cndmask_b32 v145, v11, v145, s[54:55]
    v_cndmask_b32 v146, v11, v146, s[56:57]
    v_cndmask_b32 v147, v11, v147, s[58:59]
    v_cndmask_b32 v148, v11, v148, s[60:61]
    v_cndmask_b32 v149, v11, v149, s[62:63]
    v_cndmask_b32 v150, v11, v150, s[64:65]
    v_cndmask_b32 v151, v11, v151, s[66:67]
    v_max3_f32 v48, v144, v145, v146
    v_max3_f32 v48, v48, v147, v148
    v_max3_f32 v48, v48, v149, v150
    v_max_f32 v48, v48, v151
    v_mov_b32 v9, s48
    s_waitcnt vmcnt(0) lgkmcnt(0)
    v_max3_u32 v7, v124, v125, v126
    v_max3_u32 v7, v7, v127, v128
    v_max3_u32 v7, v7, v129, v130
    v_max3_u32 v7, v7, v131, v132
    v_max_u32 v7, v7, v133
    v_cmp_eq_u32 vcc, -1, v7
    v_readfirstlane_b32 s68, v47
    s_cmp_ge_u32 s48, 64
    s_cselect_b32 s68, 64, s68
    s_cmp_eq_u64 vcc, 0
    s_cselect_b32 s33, 2, 0
    s_mul_i32 s69, s69, s33
    s_cmp_lg_u32 s69, 0
    s_cbranch_scc1 L_t_n2
    s_cmp_lt_u32 s48, s68
    s_cbranch_scc0 L_t_n2
    buffer_load_dwordx4 v[124:127], v1, s[4:7], s43 offen sc1
    buffer_load_dword v132, v2, s[4:7], s43 offen sc1
    buffer_load_dwordx4 v[128:131], v1, s[4:7], s44 offen sc1
    buffer_load_dword v133, v2, s[4:7], s44 offen sc1
    s_mov_b32 s69, 1
L_t_n2:
    s_barrier
    buffer_store_dword v9, off, s[4:7], s46 sc1
    s_add_u32 s36, s48, 2
    s_min_u32 s35, s36, 63
    s_cmp_lt_u32 s35, s47
    s_cbranch_scc1 L_t_ok1
    s_mov_b32 s32, 262144
    v_min_u32 v7, 32, v0
    v_mul_u32_u24 v7, 264, v7
L_t_p1:
    buffer_load_dword v8, v7, s[4:7], s45 offen sc1
    s_sub_u32 s32, s32, 1
    s_cbranch_scc1 L_abort
    s_waitcnt vmcnt(0)
    v_readlane_b32 s33, v8, 0
    v_readlane_b32 s34, v8, 1
    v_readlane_b32 s47, v8, 2
    s_nop 1
    s_min_u32 s33, s33, s34
    s_min_u32 s47, s47, s33
    s_cmp_lt_u32 s35, s47
    s_cbranch_scc0 L_t_p1
L_t_ok1:
    s_cmp_lt_u32 s36, 64
    s_cselect_b32 s41, s39, 268435456
    s_mov_b32 s32, 262144
    s_cmp_eq_u32 s69, 2
    s_cbranch_scc1 L_t_w
    s_cmp_eq_u32 s69, 0
    s_cbranch_scc1 L_t_h0
    s_waitcnt vmcnt(1)
    v_max3_u32 v7, v124, v125, v126
    v_max3_u32 v7, v7, v127, v128
    v_max3_u32 v7, v7, v129, v130
    v_max3_u32 v7, v7, v131, v132
    v_max_u32 v7, v7, v133
    v_cmp_eq_u32 vcc, -1, v7
    s_cbranch_vccz L_t_w
    s_branch L_t_g0
L_t_h0:
L_t_h:
    buffer_load_dword v8, off, s[4:7], s70 sc1
    s_sub_u32 s32, s32, 1
    s_cbranch_scc1 L_abort
    s_waitcnt vmcnt(0)
    v_cmp_ge_u32 vcc, s48, v8
    s_cbranch_vccnz L_t_h
L_t_g0:
    buffer_load_dwordx4 v[124:127], v1, s[4:7], s43 offen sc1
    buffer_load_dword v132, v2, s[4:7], s43 offen sc1
    buffer_load_dwordx4 v[128:131], v1, s[4:7], s44 offen sc1
    buffer_load_dword v133, v2, s[4:7], s44 offen sc1
L_t_g:
    buffer_load_dwordx4 v[124:127], v1, s[4:7], s43 offen sc1
    buffer_load_dword v132, v2, s[4:7], s43 offen sc1
    buffer_load_dwordx4 v[128:131], v1, s[4:7], s44 offen sc1
    buffer_load_dword v133, v2, s[4:7], s44 offen sc1
    s_sub_u32 s32, s32, 1
    s_cbranch_scc1 L_abort
    s_waitcnt vmcnt(4)
    v_max3_u32 v7, v124, v125, v126
    v_max3_u32 v7, v7, v127, v128
    v_max3_u32 v7, v7, v129, v130
    v_max3_u32 v7, v7, v131, v132
    v_max_u32 v7, v7, v133
    v_cmp_eq_u32 vcc, -1, v7
    s_cbranch_vccnz L_t_g
L_t_w:
    ds_write_b32 v2, v132 offset:0
    ds_write_b128 v1, v[124:127] offset:0
    ds_write_b32 v2, v133 offset:5120
    ds_write_b128 v1, v[128:131] offset:5120
    s_waitcnt lgkmcnt(0)
    s_barrier
    ds_read_b128 v[76:79], v0 offset:0
    ds_read_b128 v[80:83], v0 offset:1024
    ds_read_b128 v[84:87], v0 offset:2048
    ds_read_b128 v[88:91], v0 offset:3072
    s_waitcnt lgkmcnt(3)
    v_smfmac_f32_16x16x64_bf16 v[108:111], v[76:79], v[192:199], v4
    ds_read_b128 v[92:95], v0 offset:4096
    v_smfmac_f32_16x16x64_bf16 v[112:115], v[76:79], v[200:207], v4
    s_waitcnt lgkmcnt(3)
    v_smfmac_f32_16x16x64_bf16 v[108:111], v[80:83], v[224:231], v4
    ds_read_b128 v[96:99], v0 offset:5120
    v_smfmac_f32_16x16x64_bf16 v[112:115], v[80:83], v[232:239], v4
    s_waitcnt lgkmcnt(3)
    v_smfmac_f32_16x16x64_bf16 v[108:111], v[84:87], a[0:7], v4
    ds_read_b128 v[100:103], v0 offset:6144
    v_smfmac_f32_16x16x64_bf16 v[112:115], v[84:87], a[8:15], v4
    s_waitcnt lgkmcnt(3)
    v_smfmac_f32_16x16x64_bf16 v[108:111], v[88:91], a[32:39], v4
    ds_read_b128 v[104:107], v0 offset:7168
    v_smfmac_f32_16x16x64_bf16 v[112:115], v[88:91], a[40:47], v4
    s_add_u32 m0, s40, 32768
    s_add_u32 s33, s41, 0
    buffer_load_dwordx4 v0, s[4:7], s33 offen offset:0 sc1 lds
    s_waitcnt lgkmcnt(3)
    v_smfmac_f32_16x16x64_bf16 v[108:111], v[92:95], a[64:71], v4
    ds_read_b128 v[52:55], v0 offset:8192
    v_smfmac_f32_16x16x64_bf16 v[112:115], v[92:95], a[72:79], v4
    buffer_load_dwordx4 v0, s[4:7], s33 offen offset:1024 sc1 lds
    s_waitcnt lgkmcnt(3)
    v_smfmac_f32_16x16x64_bf16 v[108:111], v[96:99], a[96:103], v4
    ds_read_b128 v[56:59], v0 offset:9216
    v_smfmac_f32_16x16x64_bf16 v[112:115], v[96:99], a[104:111], v4
    s_add_u32 m0, s40, 40960
    s_add_u32 s33, s41, 8192
    buffer_load_dwordx4 v0, s[4:7], s33 offen offset:0 sc1 lds
    s_waitcnt lgkmcnt(3)
    v_smfmac_f32_16x16x64_bf16 v[108:111], v[100:103], a[128:135], v4
    v_smfmac_f32_16x16x64_bf16 v[112:115], v[100:103], a[136:143], v4
    buffer_load_dwordx4 v0, s[4:7], s33 offen offset:1024 sc1 lds
    s_waitcnt lgkmcnt(2)
    v_smfmac_f32_16x16x64_bf16 v[108:111], v[104:107], a[160:167], v4
    v_smfmac_f32_16x16x64_bf16 v[112:115], v[104:107], a[168:175], v4
    s_add_u32 m0, s40, 49152
    s_add_u32 s33, s41, 16384
    buffer_load_dwordx4 v0, s[4:7], s33 offen offset:0 sc1 lds
    s_waitcnt lgkmcnt(1)
    v_smfmac_f32_16x16x64_bf16 v[108:111], v[52:55], a[192:199], v4
    v_smfmac_f32_16x16x64_bf16 v[112:115], v[52:55], a[200:207], v4
    buffer_load_dwordx4 v0, s[4:7], s33 offen offset:1024 sc1 lds
    s_waitcnt lgkmcnt(0)
    v_smfmac_f32_16x16x64_bf16 v[108:111], v[56:59], a[224:231], v4
    v_smfmac_f32_16x16x64_bf16 v[112:115], v[56:59], a[232:239], v4
    s_add_u32 s39, s39, 786432
    s_add_u32 s40, s40, 0x8000
    s_and_b32 s40, s40, 0xffff
    v_smfmac_f32_16x16x64_bf16 v[116:119], v[76:79], v[208:215], v4
    v_cvt_pk_bf16_f32 v108, v108, v109
    v_cvt_pk_bf16_f32 v109, v110, v111
    v_cvt_pk_bf16_f32 v110, v112, v113
    v_cvt_pk_bf16_f32 v111, v114, v115
    v_smfmac_f32_16x16x64_bf16 v[120:123], v[76:79], v[216:223], v4
    s_waitcnt vmcnt(6)
    v_mfma_f32_16x16x32_bf16 v[124:127], v[108:111], v[166:169], 0
    v_mfma_f32_16x16x32_bf16 v[128:131], v[108:111], v[164:167], 0
    v_smfmac_f32_16x16x64_bf16 v[116:119], v[80:83], v[240:247], v4
    v_cvt_pk_bf16_f32 v124, v124, v125
    v_cvt_pk_bf16_f32 v125, v126, v127
    v_cvt_pk_bf16_f32 v126, v128, v129
    v_cvt_pk_bf16_f32 v127, v130, v131
    v_smfmac_f32_16x16x64_bf16 v[120:123], v[80:83], v[248:255], v4
    ds_write_b128 v1, v[124:127] offset:10240
    v_smfmac_f32_16x16x64_bf16 v[116:119], v[84:87], a[16:23], v4
    v_smfmac_f32_16x16x64_bf16 v[120:123], v[84:87], a[24:31], v4
    v_smfmac_f32_16x16x64_bf16 v[116:119], v[88:91], a[48:55], v4
    v_smfmac_f32_16x16x64_bf16 v[120:123], v[88:91], a[56:63], v4
    v_smfmac_f32_16x16x64_bf16 v[116:119], v[92:95], a[80:87], v4
    s_waitcnt lgkmcnt(0)
    s_barrier
    ds_read_b128 v[124:127], v0 offset:10240
    v_smfmac_f32_16x16x64_bf16 v[120:123], v[92:95], a[88:95], v4
    ds_read_b128 v[128:131], v0 offset:11264
    v_smfmac_f32_16x16x64_bf16 v[116:119], v[96:99], a[112:119], v4
    ds_read_b128 v[132:135], v0 offset:12288
    v_smfmac_f32_16x16x64_bf16 v[120:123], v[96:99], a[120:127], v4
    ds_read_b128 v[136:139], v0 offset:13312
    v_smfmac_f32_16x16x64_bf16 v[116:119], v[100:103], a[144:151], v4
    v_smfmac_f32_16x16x64_bf16 v[120:123], v[100:103], a[152:159], v4
    v_smfmac_f32_16x16x64_bf16 v[116:119], v[104:107], a[176:183], v4
    v_smfmac_f32_16x16x64_bf16 v[120:123], v[104:107], a[184:191], v4
    s_waitcnt lgkmcnt(3)
    v_mfma_f32_16x16x32_bf16 v[152:155], v[124:127], v[12:15], 0
    s_waitcnt lgkmcnt(2)
    v_mfma_f32_16x16x32_bf16 v[152:155], v[128:131], v[16:19], v[152:155]
    s_waitcnt lgkmcnt(1)
    v_mfma_f32_16x16x32_bf16 v[152:155], v[132:135], v[20:23], v[152:155]
    s_waitcnt lgkmcnt(0)
    v_mfma_f32_16x16x32_bf16 v[152:155], v[136:139], v[24:27], v[152:155]
    v_smfmac_f32_16x16x64_bf16 v[116:119], v[52:55], a[208:215], v4
    v_smfmac_f32_16x16x64_bf16 v[120:123], v[52:55], a[216:223], v4
    v_mul_f32 v152, s49, v152
    v_mul_f32 v153, s49, v153
    v_max3_f32 v7, v48, v152, v153
    v_max3_f32 v9, v48, v152, v153
    v_smfmac_f32_16x16x64_bf16 v[116:119], v[56:59], a[240:247], v4
    s_nop 0
    v_permlane16_swap_b32 v7, v9
    v_max_f32 v8, v7, v9
    v_max_f32 v7, v7, v9
    v_smfmac_f32_16x16x64_bf16 v[120:123], v[56:59], a[248:255], v4
    s_nop 0
    v_permlane32_swap_b32 v7, v8
    v_max_f32 v7, v7, v8
    v_cvt_pk_bf16_f32 v116, v116, v117
    v_cvt_pk_bf16_f32 v117, v118, v119
    s_nop 0
    v_cvt_pk_bf16_f32 v118, v120, v121
    v_cvt_pk_bf16_f32 v119, v122, v123
    ds_write_b128 v1, v[116:119] offset:14336
    s_cmp_eq_u32 s48, 63
    s_cselect_b32 s33, s46, 268435456
    buffer_store_dword v4, off, s[4:7], s33 offset:4 sc1
    v_sub_f32 v144, v144, v7
    v_sub_f32 v145, v145, v7
    v_sub_f32 v146, v146, v7
    v_sub_f32 v147, v147, v7
    v_sub_f32 v148, v148, v7
    v_sub_f32 v149, v149, v7
    v_sub_f32 v150, v150, v7
    v_sub_f32 v151, v151, v7
    v_sub_f32 v152, v152, v7
    v_sub_f32 v153, v153, v7
    v_exp_f32 v144, v144
    v_exp_f32 v145, v145
    v_exp_f32 v146, v146
    v_exp_f32 v147, v147
    s_waitcnt lgkmcnt(0)
    s_barrier
    ds_read_b128 v[156:159], v6 offset:14336
    v_exp_f32 v148, v148
    ds_read_b128 v[160:163], v6 offset:15360
    v_exp_f32 v149, v149
    v_exp_f32 v150, v150
    v_exp_f32 v151, v151
    v_exp_f32 v152, v152
    v_exp_f32 v153, v153
    v_cvt_pk_bf16_f32 v182, v144, v145
    v_cvt_pk_bf16_f32 v183, v146, v147
    v_cvt_pk_bf16_f32 v184, v148, v149
    v_cvt_pk_bf16_f32 v185, v150, v151
    v_cvt_pk_bf16_f32 v178, v152, v153
    v_cvt_pk_bf16_f32 v179, v152, v153
    v_mfma_f32_16x16x32_bf16 v[186:189], v[172:175], v[182:185], 0
    s_nop 0
    v_mfma_f32_16x16x32_bf16 v[186:189], v[170:173], v[178:181], v[186:189]
    v_mfma_f32_16x16x32_bf16 v[108:111], v[28:31], v[182:185], 0
    s_waitcnt lgkmcnt(1)
    v_mfma_f32_16x16x32_bf16 v[108:111], v[156:159], v[178:181], v[108:111]
    v_rcp_f32 v186, v186
    v_mfma_f32_16x16x32_bf16 v[112:115], v[32:35], v[182:185], 0
    v_mfma_f32_16x16x32_bf16 v[112:115], v[156:159], v[176:179], v[112:115]
    v_mfma_f32_16x16x32_bf16 v[116:119], v[36:39], v[182:185], 0
    v_mul_f32 v108, v108, v186
    v_mul_f32 v109, v109, v186
    v_mul_f32 v110, v110, v186
    s_waitcnt lgkmcnt(0)
    v_mfma_f32_16x16x32_bf16 v[116:119], v[160:163], v[178:181], v[116:119]
    v_mul_f32 v111, v111, v186
    v_cvt_pk_bf16_f32 v124, v108, v109
    v_cvt_pk_bf16_f32 v125, v110, v111
    v_mfma_f32_16x16x32_bf16 v[120:123], v[40:43], v[182:185], 0
    v_mul_f32 v112, v112, v186
    v_mul_f32 v113, v113, v186
    v_mul_f32 v114, v114, v186
    v_mfma_f32_16x16x32_bf16 v[120:123], v[160:163], v[176:179], v[120:123]
    v_mul_f32 v115, v115, v186
    v_cvt_pk_bf16_f32 v126, v112, v113
    v_cvt_pk_bf16_f32 v127, v114, v115
    v_mul_f32 v116, v116, v186
    v_mul_f32 v117, v117, v186
    v_mul_f32 v118, v118, v186
    v_mul_f32 v119, v119, v186
    v_cvt_pk_bf16_f32 v128, v116, v117
    v_cvt_pk_bf16_f32 v129, v118, v119
    v_mul_f32 v120, v120, v186
    v_mul_f32 v121, v121, v186
    v_mul_f32 v122, v122, v186
    v_mul_f32 v123, v123, v186
    v_cvt_pk_bf16_f32 v130, v120, v121
    v_cvt_pk_bf16_f32 v131, v122, v123
    buffer_store_dwordx4 v[124:127], v5, s[4:7], s42 offen offset:0 sc1
    buffer_store_dwordx4 v[128:131], v5, s[4:7], s42 offen offset:128 sc1
    s_add_u32 s48, s48, 1
    v_mov_b32 v7, s48
    s_add_u32 s43, s43, 32768
    s_add_u32 s44, s44, 32768
    s_add_u32 s42, s42, 262144
    s_cmp_lt_u32 s48, 64
    s_cbranch_scc1 L_t_loop
    s_waitcnt vmcnt(0)
    s_barrier
    buffer_store_dword v7, off, s[4:7], s46 sc1
    s_endpgm
L_recheck:
    s_waitcnt vmcnt(0) lgkmcnt(0)
    s_barrier
    s_lshr_b32 s20, s2, 5
    s_and_b32 s21, s2, 31
    s_mov_b32 s22, 1572864
    s_cmp_lt_u32 s20, 2
    s_cbranch_scc0 L_bulk
L_fb2:
    s_waitcnt vmcnt(0)
    s_barrier
    v_mbcnt_lo_u32_b32 v14, -1, 0
    v_mbcnt_hi_u32_b32 v14, -1, v14
    v_or_b32 v14, s3, v14
    v_cmp_eq_u32 vcc, 0, v14
    v_mov_b32 v14, 0x1000
    v_mov_b32 v15, 196
    v_cndmask_b32 v14, v14, v15, vcc
    v_mov_b32 v15, 1
    buffer_atomic_add v15, v14, s[16:19], 0 offen
    s_mov_b32 s32, 262144
L_aw_19:
    buffer_load_dword v14, off, s[16:19], 0 offset:196 sc1
    s_sub_u32 s32, s32, 1
    s_cbranch_scc1 L_abort
    s_waitcnt vmcnt(0)
    v_readfirstlane_b32 s33, v14
    s_sleep 4
    s_cmp_lt_u32 s33, 256
    s_cbranch_scc1 L_aw_19
    s_cmp_lt_u32 s20, 2
    s_cbranch_scc0 L_dispatch
    v_mbcnt_lo_u32_b32 v0, -1, 0
    v_mbcnt_hi_u32_b32 v0, -1, v0
    s_load_dwordx2 s[8:9], s[0:1], 16
    s_load_dwordx2 s[12:13], s[0:1], 24
    s_load_dwordx2 s[24:25], s[0:1], 32
    s_load_dwordx2 s[28:29], s[0:1], 40
    s_mov_b32 s10, 5242880
    s_mov_b32 s11, 0x20000
    s_mov_b32 s14, 5242880
    s_mov_b32 s15, 0x20000
    s_mov_b32 s26, 5242880
    s_mov_b32 s27, 0x20000
    s_mov_b32 s30, 5242880
    s_mov_b32 s31, 0x20000
    v_mov_b32 v95, v0
    v_lshrrev_b32 v94, 4, v95
    v_and_b32 v93, 15, v95
    v_and_b32 v86, 1, v94
    v_lshlrev_b32 v86, 1, v86
    v_xor_b32 v86, v86, v93
    v_lshlrev_b32 v86, 4, v86
    v_lshl_add_u32 v80, v94, 13, v86
    v_xor_b32 v81, 64, v80
    v_xor_b32 v82, 128, v80
    v_xor_b32 v83, 192, v80
    s_mul_i32 s36, s3, 36864
    s_add_u32 s36, s36, 16384
    s_lshl_b32 s68, s21, 8
    s_lshl_b32 s33, s3, 17
    s_add_u32 s68, s68, s33
    s_mul_i32 s33, s20, 2621440
    s_add_u32 s69, s68, s33
    s_sub_u32 s70, 2621440, s33
    s_add_u32 s70, s70, s68
    s_waitcnt lgkmcnt(0)
    s_add_u32 m0, s36, 0
    s_add_u32 s33, s69, 0
    buffer_load_dwordx4 v80, s[8:11], s33 offen lds
    s_add_u32 m0, s36, 1024
    s_add_u32 s33, s69, 32768
    buffer_load_dwordx4 v81, s[8:11], s33 offen lds
    s_add_u32 m0, s36, 2048
    s_add_u32 s33, s69, 65536
    buffer_load_dwordx4 v82, s[8:11], s33 offen lds
    s_add_u32 m0, s36, 3072
    s_add_u32 s33, s69, 98304
    buffer_load_dwordx4 v83, s[8:11], s33 offen lds
    s_add_u32 m0, s36, 4096
    s_add_u32 s33, s69, 524288
    buffer_load_dwordx4 v80, s[8:11], s33 offen lds
    s_add_u32 m0, s36, 5120
    s_add_u32 s33, s69, 557056
    buffer_load_dwordx4 v81, s[8:11], s33 offen lds
    s_add_u32 m0, s36, 6144
    s_add_u32 s33, s69, 589824
    buffer_load_dwordx4 v82, s[8:11], s33 offen lds
    s_add_u32 m0, s36, 7168
    s_add_u32 s33, s69, 622592
    buffer_load_dwordx4 v83, s[8:11], s33 offen lds
    s_add_u32 m0, s36, 8192
    s_add_u32 s33, s69, 1048576
    buffer_load_dwordx4 v80, s[8:11], s33 offen lds
    s_add_u32 m0, s36, 9216
    s_add_u32 s33, s69, 1081344
    buffer_load_dwordx4 v81, s[8:11], s33 offen lds
    s_add_u32 m0, s36, 10240
    s_add_u32 s33, s69, 1114112
    buffer_load_dwordx4 v82, s[8:11], s33 offen lds
    s_add_u32 m0, s36, 11264
    s_add_u32 s33, s69, 1146880
    buffer_load_dwordx4 v83, s[8:11], s33 offen lds
    s_mul_i32 s71, s21, 163840
    s_mul_i32 s33, s20, 640
    s_add_u32 s71, s71, s33
    s_mul_i32 s33, s3, 40960
    s_add_u32 s71, s71, s33
    v_add_u32 v86, 0, v95
    v_mul_u32_u24 v85, 1639, v86
    v_lshrrev_b32 v85, 16, v85
    v_mul_u32_u24 v85, 640, v85
    v_lshl_add_u32 v70, v86, 4, v85
    v_add_u32 v86, 64, v95
    v_mul_u32_u24 v85, 1639, v86
    v_lshrrev_b32 v85, 16, v85
    v_mul_u32_u24 v85, 640, v85
    v_lshl_add_u32 v71, v86, 4, v85
    v_add_u32 v86, 128, v95
    v_mul_u32_u24 v85, 1639, v86
    v_lshrrev_b32 v85, 16, v85
    v_mul_u32_u24 v85, 640, v85
    v_lshl_add_u32 v72, v86, 4, v85
    v_add_u32 v86, 192, v95
    v_mul_u32_u24 v85, 1639, v86
    v_lshrrev_b32 v85, 16, v85
    v_mul_u32_u24 v85, 640, v85
    v_lshl_add_u32 v73, v86, 4, v85
    v_add_u32 v86, 256, v95
    v_mul_u32_u24 v85, 1639, v86
    v_lshrrev_b32 v85, 16, v85
    v_mul_u32_u24 v85, 640, v85
    v_lshl_add_u32 v74, v86, 4, v85
    s_xor_b32 s33, s3, 0
    s_lshl_b32 s64, s33, 12
    s_mul_i32 s33, s33, 36864
    s_mul_i32 s34, s3, 160
    s_add_u32 s33, s33, s34
    s_add_u32 s72, s33, 32768
    s_xor_b32 s33, s3, 1
    s_lshl_b32 s65, s33, 12
    s_mul_i32 s33, s33, 36864
    s_mul_i32 s34, s3, 160
    s_add_u32 s33, s33, s34
    s_add_u32 s73, s33, 32768
    s_xor_b32 s33, s3, 2
    s_lshl_b32 s66, s33, 12
    s_mul_i32 s33, s33, 36864
    s_mul_i32 s34, s3, 160
    s_add_u32 s33, s33, s34
    s_add_u32 s74, s33, 32768
    s_xor_b32 s33, s3, 3
    s_lshl_b32 s67, s33, 12
    s_mul_i32 s33, s33, 36864
    s_mul_i32 s34, s3, 160
    s_add_u32 s33, s33, s34
    s_add_u32 s75, s33, 32768
    v_lshrrev_b32 v86, 3, v95
    v_and_b32 v85, 7, v95
    v_lshlrev_b32 v85, 4, v85
    v_mul_u32_u24 v4, 4224, v86
    v_add_u32 v4, v4, v85
    v_lshlrev_b32 v0, 4, v95
    v_add_u32 v1, s36, v0
    s_lshl_b32 s33, s3, 10
    v_add_u32 v2, s33, v0
    v_xor_b32 v9, 1024, v2
    v_xor_b32 v10, 2048, v2
    v_xor_b32 v11, 3072, v2
    v_lshrrev_b32 v7, 2, v2
    v_add_u32 v7, 4096, v7
    v_lshrrev_b32 v86, 1, v94
    v_bfe_u32 v85, v93, 2, 1
    v_lshl_add_u32 v86, v86, 1, v85
    v_and_b32 v85, 1, v94
    v_lshl_add_u32 v86, v86, 1, v85
    v_and_b32 v85, 3, v93
    v_lshl_add_u32 v86, v86, 2, v85
    v_lshlrev_b32 v5, 2, v86
    v_lshrrev_b32 v86, 3, v93
    v_bfe_u32 v85, v93, 1, 1
    v_lshl_add_u32 v86, v85, 16, v86
    s_mov_b32 s33, 0xaaaa
    v_mul_lo_u32 v86, v86, s33
    v_add_u32 v6, 0x44444444, v86
    v_and_b32 v86, 1, v94
    v_lshrrev_b32 v85, 3, v93
    v_lshl_add_u32 v86, v85, 1, v86
    v_bfe_u32 v85, v93, 2, 1
    v_lshl_add_u32 v84, v86, 1, v85
    v_lshl_add_u32 v86, v86, 2, v85
    v_lshlrev_b32 v86, 8, v86
    v_lshrrev_b32 v85, 1, v94
    v_mul_u32_u24 v85, 36864, v85
    v_add_u32 v86, v86, v85
    s_lshl_b32 s33, s3, 1
    v_xor_b32 v84, s33, v84
    v_lshl_add_u32 v86, v84, 5, v86
    v_and_b32 v84, 3, v93
    v_lshlrev_b32 v84, 3, v84
    v_add_u32 v86, v86, v84
    v_add_u32 v76, 16384, v86
    v_xor_b32 v77, 32, v76
    v_add_u32 v78, 73728, v76
    v_add_u32 v79, 73728, v77
    v_and_b32 v86, 1, v94
    v_lshrrev_b32 v85, 1, v94
    v_lshl_add_u32 v86, v86, 2, v85
    v_mul_u32_u24 v86, 2560, v86
    v_lshl_add_u32 v88, v93, 2, v86
    v_lshrrev_b32 v86, 2, v95
    v_mul_u32_u24 v86, 640, v86
    v_and_b32 v85, 3, v95
    v_lshl_add_u32 v87, v85, 3, v86
    v_and_b32 v86, 1, v94
    v_lshlrev_b32 v86, 2, v86
    v_sub_u32 v86, v93, v86
    v_and_b32 v85, 2, v94
    v_sub_u32 v86, v86, v85
    v_lshlrev_b32 v85, 1, v94
    v_sub_u32 v85, v93, v85
    v_mov_b32 v20, 0x3f80
    v_mov_b32 v21, 0x3f800000
    v_cmp_eq_u32 vcc, 0, v85
    s_nop 1
    v_cndmask_b32 v16, 0, v20, vcc
    v_cmp_eq_u32 vcc, 1, v85
    s_nop 1
    v_cndmask_b32 v16, v16, v21, vcc
    v_cmp_eq_u32 vcc, 0, v85
    s_nop 1
    v_cndmask_b32 v17, 0, v20, vcc
    v_cmp_eq_u32 vcc, 1, v85
    s_nop 1
    v_cndmask_b32 v17, v17, v21, vcc
    v_cmp_eq_u32 vcc, 8, v86
    s_nop 1
    v_cndmask_b32 v18, 0, v20, vcc
    v_cmp_eq_u32 vcc, 9, v86
    s_nop 1
    v_cndmask_b32 v18, v18, v21, vcc
    v_cmp_eq_u32 vcc, 8, v86
    s_nop 1
    v_cndmask_b32 v19, 0, v20, vcc
    v_cmp_eq_u32 vcc, 9, v86
    s_nop 1
    v_cndmask_b32 v19, v19, v21, vcc
    ds_write_b128 v0, v[16:19] offset:13312
    v_and_b32 v86, 7, v93
    v_cmp_eq_u32 vcc, 0, v86
    s_nop 1
    v_cndmask_b32 v24, 0, v20, vcc
    v_cmp_eq_u32 vcc, 4, v86
    s_nop 1
    v_cndmask_b32 v24, v24, v21, vcc
    v_cmp_eq_u32 vcc, 1, v86
    s_nop 1
    v_cndmask_b32 v25, 0, v20, vcc
    v_cmp_eq_u32 vcc, 5, v86
    s_nop 1
    v_cndmask_b32 v25, v25, v21, vcc
    v_mov_b32 v26, v24
    v_mov_b32 v27, v25
    ds_write_b128 v0, v[24:27] offset:14336
    s_lshl_b32 s33, s3, 5
    s_add_u32 s33, s33, s21
    s_cmp_lt_u32 s33, 40
    s_cselect_b32 s61, 1, 0
    s_cselect_b32 s35, 0, 0x10000000
    s_mul_i32 s49, s33, 4224
    s_mul_i32 s76, s33, 26
    s_lshr_b32 s76, s76, 8
    s_mul_i32 s76, s76, 10
    s_sub_u32 s77, s33, s76
    s_and_b32 s78, s77, 1
    s_lshl_b32 s78, s78, 1
    s_bfe_u32 s79, s77, 0x10001
    s_or_b32 s78, s78, s79
    s_and_b32 s79, s77, 4
    s_or_b32 s78, s78, s79
    s_cmp_lt_u32 s77, 8
    s_cselect_b32 s77, s78, s77
    s_add_u32 s33, s76, s77
    s_lshl_b32 s33, s33, 7
    s_add_u32 s33, s33, s35
    s_lshl_b32 s37, s20, 15
    s_add_u32 s37, s37, s22
    s_add_u32 s37, s37, 2228224
    s_add_u32 s39, s37, s33
    s_mul_i32 s44, s20, 4194304
    s_add_u32 s44, s44, s33
    s_xor_b32 s42, s20, 1
    s_mul_i32 s42, s42, 4194304
    s_add_u32 s42, s42, 71303168
    s_add_u32 s44, s44, 71303168
    s_mul_i32 s34, s20, 506880
    s_add_u32 s34, s34, s22
    s_add_u32 s34, s34, 2293760
    s_add_u32 s49, s49, s34
    s_mov_b32 s40, s49
    s_mul_i32 s47, s3, 42240
    s_add_u32 s47, s47, s34
    s_lshl_b32 s34, s21, 7
    s_add_u32 s47, s47, s34
    s_mul_i32 s33, s21, 24576
    s_lshl_b32 s34, s3, 11
    s_add_u32 s33, s33, s34
    s_add_u32 s55, s33, 16785408
    s_add_u32 s56, s33, 16793600
    s_lshl_b32 s33, s21, 7
    s_add_u32 s59, s33, 69210240
    s_mov_b32 s62, 0x3e0293ee
    s_mov_b32 s23, 0
    s_mov_b32 s60, 0
    s_mov_b32 s38, s47
    s_mov_b32 s50, 168960
    s_mov_b32 s46, 0x41800000
    s_mov_b32 s63, s62
    s_mov_b32 s78, 0x05040100
    s_mov_b32 s79, 0x07060302
    s_lshl_b32 s33, s3, 11
    v_lshl_add_u32 v90, v0, 3, s33
    v_lshlrev_b32 v91, 2, v95
    s_mov_b32 s57, s55
    s_waitcnt lgkmcnt(0)
    s_waitcnt vmcnt(8)
    s_add_u32 m0, s36, 12288
    s_add_u32 s33, s69, 1572864
    buffer_load_dwordx4 v80, s[8:11], s33 offen lds
    s_add_u32 m0, s36, 13312
    s_add_u32 s33, s69, 1605632
    buffer_load_dwordx4 v81, s[8:11], s33 offen lds
    s_add_u32 m0, s36, 14336
    s_add_u32 s33, s69, 1638400
    buffer_load_dwordx4 v82, s[8:11], s33 offen lds
    s_add_u32 m0, s36, 15360
    s_add_u32 s33, s69, 1671168
    buffer_load_dwordx4 v83, s[8:11], s33 offen lds
    s_waitcnt vmcnt(8)
    s_add_u32 m0, s36, 32768
    s_add_u32 s33, s69, 2097152
    buffer_load_dwordx4 v80, s[8:11], s33 offen lds
    s_add_u32 m0, s36, 33792
    s_add_u32 s33, s69, 2129920
    buffer_load_dwordx4 v81, s[8:11], s33 offen lds
    s_add_u32 m0, s36, 34816
    s_add_u32 s33, s69, 2162688
    buffer_load_dwordx4 v82, s[8:11], s33 offen lds
    s_add_u32 m0, s36, 35840
    s_add_u32 s33, s69, 2195456
    buffer_load_dwordx4 v83, s[8:11], s33 offen lds
    s_waitcnt vmcnt(8)
    s_add_u32 m0, s36, 16384
    s_add_u32 s33, s69, 0
    buffer_load_dwordx4 v80, s[12:15], s33 offen lds
    s_add_u32 m0, s36, 17408
    s_add_u32 s33, s69, 32768
    buffer_load_dwordx4 v81, s[12:15], s33 offen lds
    s_add_u32 m0, s36, 18432
    s_add_u32 s33, s69, 65536
    buffer_load_dwordx4 v82, s[12:15], s33 offen lds
    s_add_u32 m0, s36, 19456
    s_add_u32 s33, s69, 98304
    buffer_load_dwordx4 v83, s[12:15], s33 offen lds
    s_waitcnt vmcnt(8)
    s_add_u32 m0, s36, 20480
    s_add_u32 s33, s69, 524288
    buffer_load_dwordx4 v80, s[12:15], s33 offen lds
    s_add_u32 m0, s36, 21504
    s_add_u32 s33, s69, 557056
    buffer_load_dwordx4 v81, s[12:15], s33 offen lds
    s_add_u32 m0, s36, 22528
    s_add_u32 s33, s69, 589824
    buffer_load_dwordx4 v82, s[12:15], s33 offen lds
    s_add_u32 m0, s36, 23552
    s_add_u32 s33, s69, 622592
    buffer_load_dwordx4 v83, s[12:15], s33 offen lds
    s_barrier
    v_add_u32 v86, s64, v76
    v_add_u32 v85, s64, v77
    v_add_u32 v84, s64, v78
    v_add_u32 v93, s64, v79
    ds_read_b64_tr_b16 v[176:177], v86 offset:0
    ds_read_b64_tr_b16 v[178:179], v86 offset:512
    ds_read_b64_tr_b16 v[180:181], v84 offset:0
    ds_read_b64_tr_b16 v[182:183], v84 offset:512
    ds_read_b64_tr_b16 v[184:185], v85 offset:0
    ds_read_b64_tr_b16 v[186:187], v85 offset:512
    ds_read_b64_tr_b16 v[188:189], v93 offset:0
    ds_read_b64_tr_b16 v[190:191], v93 offset:512
    v_add_u32 v86, s65, v76
    v_add_u32 v85, s65, v77
    v_add_u32 v84, s65, v78
    v_add_u32 v93, s65, v79
    ds_read_b64_tr_b16 v[208:209], v86 offset:0
    ds_read_b64_tr_b16 v[210:211], v86 offset:512
    ds_read_b64_tr_b16 v[212:213], v84 offset:0
    ds_read_b64_tr_b16 v[214:215], v84 offset:512
    ds_read_b64_tr_b16 v[216:217], v85 offset:0
    ds_read_b64_tr_b16 v[218:219], v85 offset:512
    ds_read_b64_tr_b16 v[220:221], v93 offset:0
    ds_read_b64_tr_b16 v[222:223], v93 offset:512
    v_add_u32 v86, s66, v76
    v_add_u32 v85, s66, v77
    v_add_u32 v84, s66, v78
    v_add_u32 v93, s66, v79
    ds_read_b64_tr_b16 v[240:241], v86 offset:0
    ds_read_b64_tr_b16 v[242:243], v86 offset:512
    ds_read_b64_tr_b16 v[244:245], v84 offset:0
    ds_read_b64_tr_b16 v[246:247], v84 offset:512
    ds_read_b64_tr_b16 v[248:249], v85 offset:0
    ds_read_b64_tr_b16 v[250:251], v85 offset:512
    ds_read_b64_tr_b16 v[252:253], v93 offset:0
    ds_read_b64_tr_b16 v[254:255], v93 offset:512
    v_add_u32 v86, s67, v76
    v_add_u32 v85, s67, v77
    v_add_u32 v84, s67, v78
    v_add_u32 v93, s67, v79
    ds_read_b64_tr_b16 a[16:17], v86 offset:0
    ds_read_b64_tr_b16 a[18:19], v86 offset:512
    ds_read_b64_tr_b16 a[20:21], v84 offset:0
    ds_read_b64_tr_b16 a[22:23], v84 offset:512
    ds_read_b64_tr_b16 a[24:25], v85 offset:0
    ds_read_b64_tr_b16 a[26:27], v85 offset:512
    ds_read_b64_tr_b16 a[28:29], v93 offset:0
    ds_read_b64_tr_b16 a[30:31], v93 offset:512
    s_waitcnt lgkmcnt(0)
    s_barrier
    s_waitcnt vmcnt(8)
    s_add_u32 m0, s36, 24576
    s_add_u32 s33, s69, 1048576
    buffer_load_dwordx4 v80, s[12:15], s33 offen lds
    s_add_u32 m0, s36, 25600
    s_add_u32 s33, s69, 1081344
    buffer_load_dwordx4 v81, s[12:15], s33 offen lds
    s_add_u32 m0, s36, 26624
    s_add_u32 s33, s69, 1114112
    buffer_load_dwordx4 v82, s[12:15], s33 offen lds
    s_add_u32 m0, s36, 27648
    s_add_u32 s33, s69, 1146880
    buffer_load_dwordx4 v83, s[12:15], s33 offen lds
    s_barrier
    ds_read_b64_tr_b16 a[48:49], v76 offset:32768
    ds_read_b64_tr_b16 a[50:51], v76 offset:33280
    ds_read_b64_tr_b16 a[52:53], v78 offset:32768
    ds_read_b64_tr_b16 a[54:55], v78 offset:33280
    ds_read_b64_tr_b16 a[56:57], v77 offset:32768
    ds_read_b64_tr_b16 a[58:59], v77 offset:33280
    ds_read_b64_tr_b16 a[60:61], v79 offset:32768
    ds_read_b64_tr_b16 a[62:63], v79 offset:33280
    s_waitcnt lgkmcnt(0)
    s_barrier
    s_waitcnt vmcnt(8)
    s_add_u32 m0, s36, 28672
    s_add_u32 s33, s69, 1572864
    buffer_load_dwordx4 v80, s[12:15], s33 offen lds
    s_add_u32 m0, s36, 29696
    s_add_u32 s33, s69, 1605632
    buffer_load_dwordx4 v81, s[12:15], s33 offen lds
    s_add_u32 m0, s36, 30720
    s_add_u32 s33, s69, 1638400
    buffer_load_dwordx4 v82, s[12:15], s33 offen lds
    s_add_u32 m0, s36, 31744
    s_add_u32 s33, s69, 1671168
    buffer_load_dwordx4 v83, s[12:15], s33 offen lds
    s_waitcnt vmcnt(8)
    s_add_u32 m0, s36, 0
    s_add_u32 s33, s70, 0
    buffer_load_dwordx4 v80, s[8:11], s33 offen lds
    s_add_u32 m0, s36, 1024
    s_add_u32 s33, s70, 32768
    buffer_load_dwordx4 v81, s[8:11], s33 offen lds
    s_add_u32 m0, s36, 2048
    s_add_u32 s33, s70, 65536
    buffer_load_dwordx4 v82, s[8:11], s33 offen lds
    s_add_u32 m0, s36, 3072
    s_add_u32 s33, s70, 98304
    buffer_load_dwordx4 v83, s[8:11], s33 offen lds
    s_waitcnt vmcnt(8)
    s_add_u32 m0, s36, 4096
    s_add_u32 s33, s70, 524288
    buffer_load_dwordx4 v80, s[8:11], s33 offen lds
    s_add_u32 m0, s36, 5120
    s_add_u32 s33, s70, 557056
    buffer_load_dwordx4 v81, s[8:11], s33 offen lds
    s_add_u32 m0, s36, 6144
    s_add_u32 s33, s70, 589824
    buffer_load_dwordx4 v82, s[8:11], s33 offen lds
    s_add_u32 m0, s36, 7168
    s_add_u32 s33, s70, 622592
    buffer_load_dwordx4 v83, s[8:11], s33 offen lds
    s_waitcnt vmcnt(8)
    s_add_u32 m0, s36, 8192
    s_add_u32 s33, s70, 1048576
    buffer_load_dwordx4 v80, s[8:11], s33 offen lds
    s_add_u32 m0, s36, 9216
    s_add_u32 s33, s70, 1081344
    buffer_load_dwordx4 v81, s[8:11], s33 offen lds
    s_add_u32 m0, s36, 10240
    s_add_u32 s33, s70, 1114112
    buffer_load_dwordx4 v82, s[8:11], s33 offen lds
    s_add_u32 m0, s36, 11264
    s_add_u32 s33, s70, 1146880
    buffer_load_dwordx4 v83, s[8:11], s33 offen lds
    s_barrier
    v_add_u32 v86, s64, v76
    v_add_u32 v85, s64, v77
    v_add_u32 v84, s64, v78
    v_add_u32 v93, s64, v79
    ds_read_b64_tr_b16 v[192:193], v86 offset:16384
    ds_read_b64_tr_b16 v[194:195], v86 offset:16896
    ds_read_b64_tr_b16 v[196:197], v84 offset:16384
    ds_read_b64_tr_b16 v[198:199], v84 offset:16896
    ds_read_b64_tr_b16 v[200:201], v85 offset:16384
    ds_read_b64_tr_b16 v[202:203], v85 offset:16896
    ds_read_b64_tr_b16 v[204:205], v93 offset:16384
    ds_read_b64_tr_b16 v[206:207], v93 offset:16896
    v_add_u32 v86, s65, v76
    v_add_u32 v85, s65, v77
    v_add_u32 v84, s65, v78
    v_add_u32 v93, s65, v79
    ds_read_b64_tr_b16 v[224:225], v86 offset:16384
    ds_read_b64_tr_b16 v[226:227], v86 offset:16896
    ds_read_b64_tr_b16 v[228:229], v84 offset:16384
    ds_read_b64_tr_b16 v[230:231], v84 offset:16896
    ds_read_b64_tr_b16 v[232:233], v85 offset:16384
    ds_read_b64_tr_b16 v[234:235], v85 offset:16896
    ds_read_b64_tr_b16 v[236:237], v93 offset:16384
    ds_read_b64_tr_b16 v[238:239], v93 offset:16896
    v_add_u32 v86, s66, v76
    v_add_u32 v85, s66, v77
    v_add_u32 v84, s66, v78
    v_add_u32 v93, s66, v79
    ds_read_b64_tr_b16 a[0:1], v86 offset:16384
    ds_read_b64_tr_b16 a[2:3], v86 offset:16896
    ds_read_b64_tr_b16 a[4:5], v84 offset:16384
    ds_read_b64_tr_b16 a[6:7], v84 offset:16896
    ds_read_b64_tr_b16 a[8:9], v85 offset:16384
    ds_read_b64_tr_b16 a[10:11], v85 offset:16896
    ds_read_b64_tr_b16 a[12:13], v93 offset:16384
    ds_read_b64_tr_b16 a[14:15], v93 offset:16896
    v_add_u32 v86, s67, v76
    v_add_u32 v85, s67, v77
    v_add_u32 v84, s67, v78
    v_add_u32 v93, s67, v79
    ds_read_b64_tr_b16 a[32:33], v86 offset:16384
    ds_read_b64_tr_b16 a[34:35], v86 offset:16896
    ds_read_b64_tr_b16 a[36:37], v84 offset:16384
    ds_read_b64_tr_b16 a[38:39], v84 offset:16896
    ds_read_b64_tr_b16 a[40:41], v85 offset:16384
    ds_read_b64_tr_b16 a[42:43], v85 offset:16896
    ds_read_b64_tr_b16 a[44:45], v93 offset:16384
    ds_read_b64_tr_b16 a[46:47], v93 offset:16896
    s_waitcnt lgkmcnt(0)
    s_barrier
    s_waitcnt vmcnt(8)
    s_add_u32 m0, s36, 12288
    s_add_u32 s33, s70, 1572864
    buffer_load_dwordx4 v80, s[8:11], s33 offen lds
    s_add_u32 m0, s36, 13312
    s_add_u32 s33, s70, 1605632
    buffer_load_dwordx4 v81, s[8:11], s33 offen lds
    s_add_u32 m0, s36, 14336
    s_add_u32 s33, s70, 1638400
    buffer_load_dwordx4 v82, s[8:11], s33 offen lds
    s_add_u32 m0, s36, 15360
    s_add_u32 s33, s70, 1671168
    buffer_load_dwordx4 v83, s[8:11], s33 offen lds
    s_waitcnt vmcnt(8)
    s_add_u32 m0, s36, 32768
    s_add_u32 s33, s69, 2097152
    buffer_load_dwordx4 v80, s[12:15], s33 offen lds
    s_add_u32 m0, s36, 33792
    s_add_u32 s33, s69, 2129920
    buffer_load_dwordx4 v81, s[12:15], s33 offen lds
    s_add_u32 m0, s36, 34816
    s_add_u32 s33, s69, 2162688
    buffer_load_dwordx4 v82, s[12:15], s33 offen lds
    s_add_u32 m0, s36, 35840
    s_add_u32 s33, s69, 2195456
    buffer_load_dwordx4 v83, s[12:15], s33 offen lds
    s_waitcnt vmcnt(8)
    s_add_u32 m0, s36, 16384
    s_add_u32 s33, s71, 0
    buffer_load_dwordx4 v70, s[28:31], s33 offen lds
    s_add_u32 m0, s36, 17408
    s_add_u32 s33, s71, 0
    buffer_load_dwordx4 v71, s[28:31], s33 offen lds
    s_add_u32 m0, s36, 18432
    s_add_u32 s33, s71, 0
    buffer_load_dwordx4 v72, s[28:31], s33 offen lds
    s_add_u32 m0, s36, 19456
    s_add_u32 s33, s71, 0
    buffer_load_dwordx4 v73, s[28:31], s33 offen lds
    s_add_u32 m0, s36, 20480
    s_add_u32 s33, s71, 0
    buffer_load_dwordx4 v74, s[28:31], s33 offen lds
    s_add_u32 m0, s36, 21504
    s_add_u32 s33, s71, 10240
    buffer_load_dwordx4 v70, s[28:31], s33 offen lds
    s_add_u32 m0, s36, 22528
    s_add_u32 s33, s71, 10240
    buffer_load_dwordx4 v71, s[28:31], s33 offen lds
    s_add_u32 m0, s36, 23552
    s_add_u32 s33, s71, 10240
    buffer_load_dwordx4 v72, s[28:31], s33 offen lds
    s_add_u32 m0, s36, 24576
    s_add_u32 s33, s71, 10240
    buffer_load_dwordx4 v73, s[28:31], s33 offen lds
    s_add_u32 m0, s36, 25600
    s_add_u32 s33, s71, 10240
    buffer_load_dwordx4 v74, s[28:31], s33 offen lds
    s_add_u32 m0, s36, 26624
    s_add_u32 s33, s71, 20480
    buffer_load_dwordx4 v70, s[28:31], s33 offen lds
    s_add_u32 m0, s36, 27648
    s_add_u32 s33, s71, 20480
    buffer_load_dwordx4 v71, s[28:31], s33 offen lds
    s_add_u32 m0, s36, 28672
    s_add_u32 s33, s71, 20480
    buffer_load_dwordx4 v72, s[28:31], s33 offen lds
    s_add_u32 m0, s36, 29696
    s_add_u32 s33, s71, 20480
    buffer_load_dwordx4 v73, s[28:31], s33 offen lds
    s_add_u32 m0, s36, 30720
    s_add_u32 s33, s71, 20480
    buffer_load_dwordx4 v74, s[28:31], s33 offen lds
    s_add_u32 m0, s36, 31744
    s_add_u32 s33, s71, 30720
    buffer_load_dwordx4 v70, s[28:31], s33 offen lds
    s_waitcnt vmcnt(20)
    s_barrier
    v_add_u32 v86, s64, v76
    v_add_u32 v85, s64, v77
    v_add_u32 v84, s64, v78
    v_add_u32 v93, s64, v79
    ds_read_b64_tr_b16 a[80:81], v86 offset:0
    ds_read_b64_tr_b16 a[82:83], v86 offset:512
    ds_read_b64_tr_b16 a[84:85], v84 offset:0
    ds_read_b64_tr_b16 a[86:87], v84 offset:512
    ds_read_b64_tr_b16 a[88:89], v85 offset:0
    ds_read_b64_tr_b16 a[90:91], v85 offset:512
    ds_read_b64_tr_b16 a[92:93], v93 offset:0
    ds_read_b64_tr_b16 a[94:95], v93 offset:512
    v_add_u32 v86, s65, v76
    v_add_u32 v85, s65, v77
    v_add_u32 v84, s65, v78
    v_add_u32 v93, s65, v79
    ds_read_b64_tr_b16 a[112:113], v86 offset:0
    ds_read_b64_tr_b16 a[114:115], v86 offset:512
    ds_read_b64_tr_b16 a[116:117], v84 offset:0
    ds_read_b64_tr_b16 a[118:119], v84 offset:512
    ds_read_b64_tr_b16 a[120:121], v85 offset:0
    ds_read_b64_tr_b16 a[122:123], v85 offset:512
    ds_read_b64_tr_b16 a[124:125], v93 offset:0
    ds_read_b64_tr_b16 a[126:127], v93 offset:512
    v_add_u32 v86, s66, v76
    v_add_u32 v85, s66, v77
    v_add_u32 v84, s66, v78
    v_add_u32 v93, s66, v79
    ds_read_b64_tr_b16 a[144:145], v86 offset:0
    ds_read_b64_tr_b16 a[146:147], v86 offset:512
    ds_read_b64_tr_b16 a[148:149], v84 offset:0
    ds_read_b64_tr_b16 a[150:151], v84 offset:512
    ds_read_b64_tr_b16 a[152:153], v85 offset:0
    ds_read_b64_tr_b16 a[154:155], v85 offset:512
    ds_read_b64_tr_b16 a[156:157], v93 offset:0
    ds_read_b64_tr_b16 a[158:159], v93 offset:512
    v_add_u32 v86, s67, v76
    v_add_u32 v85, s67, v77
    v_add_u32 v84, s67, v78
    v_add_u32 v93, s67, v79
    ds_read_b64_tr_b16 a[192:193], v86 offset:0
    ds_read_b64_tr_b16 a[194:195], v86 offset:512
    ds_read_b64_tr_b16 a[196:197], v84 offset:0
    ds_read_b64_tr_b16 a[198:199], v84 offset:512
    ds_read_b64_tr_b16 a[200:201], v85 offset:0
    ds_read_b64_tr_b16 a[202:203], v85 offset:512
    ds_read_b64_tr_b16 a[204:205], v93 offset:0
    ds_read_b64_tr_b16 a[206:207], v93 offset:512
    s_waitcnt lgkmcnt(0)
    s_barrier
    s_waitcnt vmcnt(16)
    s_barrier
    ds_read_b64_tr_b16 a[64:65], v76 offset:32768
    ds_read_b64_tr_b16 a[66:67], v76 offset:33280
    ds_read_b64_tr_b16 a[68:69], v78 offset:32768
    ds_read_b64_tr_b16 a[70:71], v78 offset:33280
    ds_read_b64_tr_b16 a[72:73], v77 offset:32768
    ds_read_b64_tr_b16 a[74:75], v77 offset:33280
    ds_read_b64_tr_b16 a[76:77], v79 offset:32768
    ds_read_b64_tr_b16 a[78:79], v79 offset:33280
    s_waitcnt lgkmcnt(0)
    s_barrier
    s_add_u32 m0, s36, 32768
    s_add_u32 s33, s71, 30720
    buffer_load_dwordx4 v71, s[28:31], s33 offen lds
    s_add_u32 m0, s36, 33792
    s_add_u32 s33, s71, 30720
    buffer_load_dwordx4 v72, s[28:31], s33 offen lds
    s_add_u32 m0, s36, 34816
    s_add_u32 s33, s71, 30720
    buffer_load_dwordx4 v73, s[28:31], s33 offen lds
    s_add_u32 m0, s36, 35840
    s_add_u32 s33, s71, 30720
    buffer_load_dwordx4 v74, s[28:31], s33 offen lds
    s_add_u32 m0, s36, 12288
    s_add_u32 s33, s70, 2097152
    buffer_load_dwordx4 v80, s[8:11], s33 offen lds
    s_add_u32 m0, s36, 13312
    s_add_u32 s33, s70, 2129920
    buffer_load_dwordx4 v81, s[8:11], s33 offen lds
    s_add_u32 m0, s36, 14336
    s_add_u32 s33, s70, 2162688
    buffer_load_dwordx4 v82, s[8:11], s33 offen lds
    s_add_u32 m0, s36, 15360
    s_add_u32 s33, s70, 2195456
    buffer_load_dwordx4 v83, s[8:11], s33 offen lds
    s_waitcnt vmcnt(20)
    s_add_u32 m0, s36, 8192
    s_add_u32 s33, s70, 2097152
    buffer_load_dwordx4 v80, s[12:15], s33 offen lds
    s_add_u32 m0, s36, 9216
    s_add_u32 s33, s70, 2129920
    buffer_load_dwordx4 v81, s[12:15], s33 offen lds
    s_add_u32 m0, s36, 10240
    s_add_u32 s33, s70, 2162688
    buffer_load_dwordx4 v82, s[12:15], s33 offen lds
    s_add_u32 m0, s36, 11264
    s_add_u32 s33, s70, 2195456
    buffer_load_dwordx4 v83, s[12:15], s33 offen lds
    s_waitcnt vmcnt(20)
    s_add_u32 m0, s36, 0
    s_add_u32 s33, s70, 0
    buffer_load_dwordx4 v80, s[12:15], s33 offen lds
    s_add_u32 m0, s36, 1024
    s_add_u32 s33, s70, 32768
    buffer_load_dwordx4 v81, s[12:15], s33 offen lds
    s_add_u32 m0, s36, 2048
    s_add_u32 s33, s70, 65536
    buffer_load_dwordx4 v82, s[12:15], s33 offen lds
    s_add_u32 m0, s36, 3072
    s_add_u32 s33, s70, 98304
    buffer_load_dwordx4 v83, s[12:15], s33 offen lds
    s_waitcnt vmcnt(20)
    s_add_u32 m0, s36, 4096
    s_add_u32 s33, s70, 524288
    buffer_load_dwordx4 v80, s[12:15], s33 offen lds
    s_add_u32 m0, s36, 5120
    s_add_u32 s33, s70, 557056
    buffer_load_dwordx4 v81, s[12:15], s33 offen lds
    s_add_u32 m0, s36, 6144
    s_add_u32 s33, s70, 589824
    buffer_load_dwordx4 v82, s[12:15], s33 offen lds
    s_add_u32 m0, s36, 7168
    s_add_u32 s33, s70, 622592
    buffer_load_dwordx4 v83, s[12:15], s33 offen lds
    s_waitcnt vmcnt(20)
    s_waitcnt vmcnt(16)
    s_barrier
    v_add_u32 v86, s72, v88
    v_add_u32 v85, s72, v87
    ds_read_b64_tr_b16 v[160:161], v85 offset:128
    ds_read_b64_tr_b16 v[162:163], v85 offset:10368
    ds_read_b32 v12, v86 offset:0
    ds_read_b32 v13, v86 offset:640
    ds_read_b32 v14, v86 offset:64
    ds_read_b32 v15, v86 offset:704
    ds_read_b32 v16, v86 offset:1280
    ds_read_b32 v17, v86 offset:1920
    ds_read_b32 v18, v86 offset:1344
    ds_read_b32 v19, v86 offset:1984
    ds_read_b32 v20, v86 offset:5120
    ds_read_b32 v21, v86 offset:5760
    ds_read_b32 v22, v86 offset:5184
    ds_read_b32 v23, v86 offset:5824
    ds_read_b32 v24, v86 offset:6400
    ds_read_b32 v25, v86 offset:7040
    ds_read_b32 v26, v86 offset:6464
    ds_read_b32 v27, v86 offset:7104
    s_waitcnt lgkmcnt(14)
    v_perm_b32 v96, v13, v12, s78
    v_perm_b32 v104, v13, v12, s79
    s_waitcnt lgkmcnt(12)
    v_perm_b32 v97, v15, v14, s78
    v_perm_b32 v105, v15, v14, s79
    s_waitcnt lgkmcnt(10)
    v_perm_b32 v98, v17, v16, s78
    v_perm_b32 v106, v17, v16, s79
    s_waitcnt lgkmcnt(8)
    v_perm_b32 v99, v19, v18, s78
    v_perm_b32 v107, v19, v18, s79
    s_waitcnt lgkmcnt(6)
    v_perm_b32 v100, v21, v20, s78
    v_perm_b32 v108, v21, v20, s79
    s_waitcnt lgkmcnt(4)
    v_perm_b32 v101, v23, v22, s78
    v_perm_b32 v109, v23, v22, s79
    s_waitcnt lgkmcnt(2)
    v_perm_b32 v102, v25, v24, s78
    v_perm_b32 v110, v25, v24, s79
    s_waitcnt lgkmcnt(0)
    v_perm_b32 v103, v27, v26, s78
    v_perm_b32 v111, v27, v26, s79
    v_add_u32 v86, s73, v88
    v_add_u32 v85, s73, v87
    ds_read_b64_tr_b16 v[164:165], v85 offset:128
    ds_read_b64_tr_b16 v[166:167], v85 offset:10368
    ds_read_b32 v28, v86 offset:0
    ds_read_b32 v29, v86 offset:640
    ds_read_b32 v30, v86 offset:64
    ds_read_b32 v31, v86 offset:704
    ds_read_b32 v32, v86 offset:1280
    ds_read_b32 v33, v86 offset:1920
    ds_read_b32 v34, v86 offset:1344
    ds_read_b32 v35, v86 offset:1984
    ds_read_b32 v36, v86 offset:5120
    ds_read_b32 v37, v86 offset:5760
    ds_read_b32 v38, v86 offset:5184
    ds_read_b32 v39, v86 offset:5824
    ds_read_b32 v40, v86 offset:6400
    ds_read_b32 v41, v86 offset:7040
    ds_read_b32 v42, v86 offset:6464
    ds_read_b32 v43, v86 offset:7104
    s_waitcnt lgkmcnt(14)
    v_perm_b32 v112, v29, v28, s78
    v_perm_b32 v120, v29, v28, s79
    s_waitcnt lgkmcnt(12)
    v_perm_b32 v113, v31, v30, s78
    v_perm_b32 v121, v31, v30, s79
    s_waitcnt lgkmcnt(10)
    v_perm_b32 v114, v33, v32, s78
    v_perm_b32 v122, v33, v32, s79
    s_waitcnt lgkmcnt(8)
    v_perm_b32 v115, v35, v34, s78
    v_perm_b32 v123, v35, v34, s79
    s_waitcnt lgkmcnt(6)
    v_perm_b32 v116, v37, v36, s78
    v_perm_b32 v124, v37, v36, s79
    s_waitcnt lgkmcnt(4)
    v_perm_b32 v117, v39, v38, s78
    v_perm_b32 v125, v39, v38, s79
    s_waitcnt lgkmcnt(2)
    v_perm_b32 v118, v41, v40, s78
    v_perm_b32 v126, v41, v40, s79
    s_waitcnt lgkmcnt(0)
    v_perm_b32 v119, v43, v42, s78
    v_perm_b32 v127, v43, v42, s79
    v_add_u32 v86, s74, v88
    v_add_u32 v85, s74, v87
    ds_read_b64_tr_b16 v[168:169], v85 offset:128
    ds_read_b64_tr_b16 v[170:171], v85 offset:10368
    ds_read_b32 v12, v86 offset:0
    ds_read_b32 v13, v86 offset:640
    ds_read_b32 v14, v86 offset:64
    ds_read_b32 v15, v86 offset:704
    ds_read_b32 v16, v86 offset:1280
    ds_read_b32 v17, v86 offset:1920
    ds_read_b32 v18, v86 offset:1344
    ds_read_b32 v19, v86 offset:1984
    ds_read_b32 v20, v86 offset:5120
    ds_read_b32 v21, v86 offset:5760
    ds_read_b32 v22, v86 offset:5184
    ds_read_b32 v23, v86 offset:5824
    ds_read_b32 v24, v86 offset:6400
    ds_read_b32 v25, v86 offset:7040
    ds_read_b32 v26, v86 offset:6464
    ds_read_b32 v27, v86 offset:7104
    s_waitcnt lgkmcnt(14)
    v_perm_b32 v128, v13, v12, s78
    v_perm_b32 v136, v13, v12, s79
    s_waitcnt lgkmcnt(12)
    v_perm_b32 v129, v15, v14, s78
    v_perm_b32 v137, v15, v14, s79
    s_waitcnt lgkmcnt(10)
    v_perm_b32 v130, v17, v16, s78
    v_perm_b32 v138, v17, v16, s79
    s_waitcnt lgkmcnt(8)
    v_perm_b32 v131, v19, v18, s78
    v_perm_b32 v139, v19, v18, s79
    s_waitcnt lgkmcnt(6)
    v_perm_b32 v132, v21, v20, s78
    v_perm_b32 v140, v21, v20, s79
    s_waitcnt lgkmcnt(4)
    v_perm_b32 v133, v23, v22, s78
    v_perm_b32 v141, v23, v22, s79
    s_waitcnt lgkmcnt(2)
    v_perm_b32 v134, v25, v24, s78
    v_perm_b32 v142, v25, v24, s79
    s_waitcnt lgkmcnt(0)
    v_perm_b32 v135, v27, v26, s78
    v_perm_b32 v143, v27, v26, s79
    v_add_u32 v86, s75, v88
    v_add_u32 v85, s75, v87
    ds_read_b64_tr_b16 v[172:173], v85 offset:128
    ds_read_b64_tr_b16 v[174:175], v85 offset:10368
    ds_read_b32 v28, v86 offset:0
    ds_read_b32 v29, v86 offset:640
    ds_read_b32 v30, v86 offset:64
    ds_read_b32 v31, v86 offset:704
    ds_read_b32 v32, v86 offset:1280
    ds_read_b32 v33, v86 offset:1920
    ds_read_b32 v34, v86 offset:1344
    ds_read_b32 v35, v86 offset:1984
    ds_read_b32 v36, v86 offset:5120
    ds_read_b32 v37, v86 offset:5760
    ds_read_b32 v38, v86 offset:5184
    ds_read_b32 v39, v86 offset:5824
    ds_read_b32 v40, v86 offset:6400
    ds_read_b32 v41, v86 offset:7040
    ds_read_b32 v42, v86 offset:6464
    ds_read_b32 v43, v86 offset:7104
    s_waitcnt lgkmcnt(14)
    v_perm_b32 v144, v29, v28, s78
    v_perm_b32 v152, v29, v28, s79
    s_waitcnt lgkmcnt(12)
    v_perm_b32 v145, v31, v30, s78
    v_perm_b32 v153, v31, v30, s79
    s_waitcnt lgkmcnt(10)
    v_perm_b32 v146, v33, v32, s78
    v_perm_b32 v154, v33, v32, s79
    s_waitcnt lgkmcnt(8)
    v_perm_b32 v147, v35, v34, s78
    v_perm_b32 v155, v35, v34, s79
    s_waitcnt lgkmcnt(6)
    v_perm_b32 v148, v37, v36, s78
    v_perm_b32 v156, v37, v36, s79
    s_waitcnt lgkmcnt(4)
    v_perm_b32 v149, v39, v38, s78
    v_perm_b32 v157, v39, v38, s79
    s_waitcnt lgkmcnt(2)
    v_perm_b32 v150, v41, v40, s78
    v_perm_b32 v158, v41, v40, s79
    s_waitcnt lgkmcnt(0)
    v_perm_b32 v151, v43, v42, s78
    v_perm_b32 v159, v43, v42, s79
    s_waitcnt lgkmcnt(0)
    s_barrier
    s_waitcnt vmcnt(12)
    s_barrier
    ds_read_b64_tr_b16 a[224:225], v76 offset:12288
    ds_read_b64_tr_b16 a[226:227], v76 offset:12800
    ds_read_b64_tr_b16 a[228:229], v78 offset:12288
    ds_read_b64_tr_b16 a[230:231], v78 offset:12800
    ds_read_b64_tr_b16 a[232:233], v77 offset:12288
    ds_read_b64_tr_b16 a[234:235], v77 offset:12800
    ds_read_b64_tr_b16 a[236:237], v79 offset:12288
    ds_read_b64_tr_b16 a[238:239], v79 offset:12800
    s_waitcnt lgkmcnt(0)
    s_barrier
    s_waitcnt vmcnt(8)
    s_barrier
    ds_read_b64_tr_b16 a[240:241], v76 offset:8192
    ds_read_b64_tr_b16 a[242:243], v76 offset:8704
    ds_read_b64_tr_b16 a[244:245], v78 offset:8192
    ds_read_b64_tr_b16 a[246:247], v78 offset:8704
    ds_read_b64_tr_b16 a[248:249], v77 offset:8192
    ds_read_b64_tr_b16 a[250:251], v77 offset:8704
    ds_read_b64_tr_b16 a[252:253], v79 offset:8192
    ds_read_b64_tr_b16 a[254:255], v79 offset:8704
    s_waitcnt lgkmcnt(0)
    s_barrier
    s_add_u32 m0, s36, 8192
    s_add_u32 s33, s70, 1048576
    buffer_load_dwordx4 v80, s[12:15], s33 offen lds
    s_add_u32 m0, s36, 9216
    s_add_u32 s33, s70, 1081344
    buffer_load_dwordx4 v81, s[12:15], s33 offen lds
    s_add_u32 m0, s36, 10240
    s_add_u32 s33, s70, 1114112
    buffer_load_dwordx4 v82, s[12:15], s33 offen lds
    s_add_u32 m0, s36, 11264
    s_add_u32 s33, s70, 1146880
    buffer_load_dwordx4 v83, s[12:15], s33 offen lds
    s_add_u32 m0, s36, 12288
    s_add_u32 s33, s70, 1572864
    buffer_load_dwordx4 v80, s[12:15], s33 offen lds
    s_add_u32 m0, s36, 13312
    s_add_u32 s33, s70, 1605632
    buffer_load_dwordx4 v81, s[12:15], s33 offen lds
    s_add_u32 m0, s36, 14336
    s_add_u32 s33, s70, 1638400
    buffer_load_dwordx4 v82, s[12:15], s33 offen lds
    s_add_u32 m0, s36, 15360
    s_add_u32 s33, s70, 1671168
    buffer_load_dwordx4 v83, s[12:15], s33 offen lds
    s_add_u32 m0, s36, 16384
    s_add_u32 s33, s70, 0
    buffer_load_dwordx4 v80, s[24:27], s33 offen lds
    s_add_u32 m0, s36, 17408
    s_add_u32 s33, s70, 32768
    buffer_load_dwordx4 v81, s[24:27], s33 offen lds
    s_add_u32 m0, s36, 18432
    s_add_u32 s33, s70, 65536
    buffer_load_dwordx4 v82, s[24:27], s33 offen lds
    s_add_u32 m0, s36, 19456
    s_add_u32 s33, s70, 98304
    buffer_load_dwordx4 v83, s[24:27], s33 offen lds
    s_add_u32 m0, s36, 20480
    s_add_u32 s33, s70, 524288
    buffer_load_dwordx4 v80, s[24:27], s33 offen lds
    s_add_u32 m0, s36, 21504
    s_add_u32 s33, s70, 557056
    buffer_load_dwordx4 v81, s[24:27], s33 offen lds
    s_add_u32 m0, s36, 22528
    s_add_u32 s33, s70, 589824
    buffer_load_dwordx4 v82, s[24:27], s33 offen lds
    s_add_u32 m0, s36, 23552
    s_add_u32 s33, s70, 622592
    buffer_load_dwordx4 v83, s[24:27], s33 offen lds
    s_waitcnt vmcnt(20)
    s_add_u32 m0, s36, 24576
    s_add_u32 s33, s70, 1048576
    buffer_load_dwordx4 v80, s[24:27], s33 offen lds
    s_add_u32 m0, s36, 25600
    s_add_u32 s33, s70, 1081344
    buffer_load_dwordx4 v81, s[24:27], s33 offen lds
    s_add_u32 m0, s36, 26624
    s_add_u32 s33, s70, 1114112
    buffer_load_dwordx4 v82, s[24:27], s33 offen lds
    s_add_u32 m0, s36, 27648
    s_add_u32 s33, s70, 1146880
    buffer_load_dwordx4 v83, s[24:27], s33 offen lds
    s_waitcnt vmcnt(20)
    s_add_u32 m0, s36, 28672
    s_add_u32 s33, s70, 1572864
    buffer_load_dwordx4 v80, s[24:27], s33 offen lds
    s_add_u32 m0, s36, 29696
    s_add_u32 s33, s70, 1605632
    buffer_load_dwordx4 v81, s[24:27], s33 offen lds
    s_add_u32 m0, s36, 30720
    s_add_u32 s33, s70, 1638400
    buffer_load_dwordx4 v82, s[24:27], s33 offen lds
    s_add_u32 m0, s36, 31744
    s_add_u32 s33, s70, 1671168
    buffer_load_dwordx4 v83, s[24:27], s33 offen lds
    s_waitcnt vmcnt(20)
    s_add_u32 m0, s36, 32768
    s_add_u32 s33, s69, 2097152
    buffer_load_dwordx4 v80, s[24:27], s33 offen lds
    s_add_u32 m0, s36, 33792
    s_add_u32 s33, s69, 2129920
    buffer_load_dwordx4 v81, s[24:27], s33 offen lds
    s_add_u32 m0, s36, 34816
    s_add_u32 s33, s69, 2162688
    buffer_load_dwordx4 v82, s[24:27], s33 offen lds
    s_add_u32 m0, s36, 35840
    s_add_u32 s33, s69, 2195456
    buffer_load_dwordx4 v83, s[24:27], s33 offen lds
    s_waitcnt vmcnt(20)
    s_barrier
    v_add_u32 v86, s64, v76
    v_add_u32 v85, s64, v77
    v_add_u32 v84, s64, v78
    v_add_u32 v93, s64, v79
    ds_read_b64_tr_b16 a[96:97], v86 offset:0
    ds_read_b64_tr_b16 a[98:99], v86 offset:512
    ds_read_b64_tr_b16 a[100:101], v84 offset:0
    ds_read_b64_tr_b16 a[102:103], v84 offset:512
    ds_read_b64_tr_b16 a[104:105], v85 offset:0
    ds_read_b64_tr_b16 a[106:107], v85 offset:512
    ds_read_b64_tr_b16 a[108:109], v93 offset:0
    ds_read_b64_tr_b16 a[110:111], v93 offset:512
    v_add_u32 v86, s65, v76
    v_add_u32 v85, s65, v77
    v_add_u32 v84, s65, v78
    v_add_u32 v93, s65, v79
    ds_read_b64_tr_b16 v[12:13], v86 offset:0
    ds_read_b64_tr_b16 v[14:15], v86 offset:512
    ds_read_b64_tr_b16 v[16:17], v84 offset:0
    ds_read_b64_tr_b16 v[18:19], v84 offset:512
    ds_read_b64_tr_b16 v[20:21], v85 offset:0
    ds_read_b64_tr_b16 v[22:23], v85 offset:512
    ds_read_b64_tr_b16 v[24:25], v93 offset:0
    ds_read_b64_tr_b16 v[26:27], v93 offset:512
    v_add_u32 v86, s66, v76
    v_add_u32 v85, s66, v77
    v_add_u32 v84, s66, v78
    v_add_u32 v93, s66, v79
    ds_read_b64_tr_b16 a[160:161], v86 offset:0
    ds_read_b64_tr_b16 a[162:163], v86 offset:512
    ds_read_b64_tr_b16 a[164:165], v84 offset:0
    ds_read_b64_tr_b16 a[166:167], v84 offset:512
    ds_read_b64_tr_b16 a[168:169], v85 offset:0
    ds_read_b64_tr_b16 a[170:171], v85 offset:512
    ds_read_b64_tr_b16 a[172:173], v93 offset:0
    ds_read_b64_tr_b16 a[174:175], v93 offset:512
    v_add_u32 v86, s67, v76
    v_add_u32 v85, s67, v77
    v_add_u32 v84, s67, v78
    v_add_u32 v93, s67, v79
    ds_read_b64_tr_b16 v[28:29], v86 offset:0
    ds_read_b64_tr_b16 v[30:31], v86 offset:512
    ds_read_b64_tr_b16 v[32:33], v84 offset:0
    ds_read_b64_tr_b16 v[34:35], v84 offset:512
    ds_read_b64_tr_b16 v[36:37], v85 offset:0
    ds_read_b64_tr_b16 v[38:39], v85 offset:512
    ds_read_b64_tr_b16 v[40:41], v93 offset:0
    ds_read_b64_tr_b16 v[42:43], v93 offset:512
    s_waitcnt lgkmcnt(0)
    s_barrier
    s_add_u32 m0, s36, 0
    s_add_u32 s33, s69, 0
    buffer_load_dwordx4 v80, s[24:27], s33 offen lds
    s_add_u32 m0, s36, 1024
    s_add_u32 s33, s69, 32768
    buffer_load_dwordx4 v81, s[24:27], s33 offen lds
    s_add_u32 m0, s36, 2048
    s_add_u32 s33, s69, 65536
    buffer_load_dwordx4 v82, s[24:27], s33 offen lds
    s_add_u32 m0, s36, 3072
    s_add_u32 s33, s69, 98304
    buffer_load_dwordx4 v83, s[24:27], s33 offen lds
    s_waitcnt vmcnt(20)
    s_add_u32 m0, s36, 4096
    s_add_u32 s33, s69, 524288
    buffer_load_dwordx4 v80, s[24:27], s33 offen lds
    s_add_u32 m0, s36, 5120
    s_add_u32 s33, s69, 557056
    buffer_load_dwordx4 v81, s[24:27], s33 offen lds
    s_add_u32 m0, s36, 6144
    s_add_u32 s33, s69, 589824
    buffer_load_dwordx4 v82, s[24:27], s33 offen lds
    s_add_u32 m0, s36, 7168
    s_add_u32 s33, s69, 622592
    buffer_load_dwordx4 v83, s[24:27], s33 offen lds
    s_waitcnt vmcnt(20)
    s_add_u32 m0, s36, 8192
    s_add_u32 s33, s69, 1048576
    buffer_load_dwordx4 v80, s[24:27], s33 offen lds
    s_add_u32 m0, s36, 9216
    s_add_u32 s33, s69, 1081344
    buffer_load_dwordx4 v81, s[24:27], s33 offen lds
    s_add_u32 m0, s36, 10240
    s_add_u32 s33, s69, 1114112
    buffer_load_dwordx4 v82, s[24:27], s33 offen lds
    s_add_u32 m0, s36, 11264
    s_add_u32 s33, s69, 1146880
    buffer_load_dwordx4 v83, s[24:27], s33 offen lds
    s_waitcnt vmcnt(20)
    s_add_u32 m0, s36, 12288
    s_add_u32 s33, s69, 1572864
    buffer_load_dwordx4 v80, s[24:27], s33 offen lds
    s_add_u32 m0, s36, 13312
    s_add_u32 s33, s69, 1605632
    buffer_load_dwordx4 v81, s[24:27], s33 offen lds
    s_add_u32 m0, s36, 14336
    s_add_u32 s33, s69, 1638400
    buffer_load_dwordx4 v82, s[24:27], s33 offen lds
    s_add_u32 m0, s36, 15360
    s_add_u32 s33, s69, 1671168
    buffer_load_dwordx4 v83, s[24:27], s33 offen lds
    s_waitcnt vmcnt(20)
    s_barrier
    v_add_u32 v86, s64, v76
    v_add_u32 v85, s64, v77
    v_add_u32 v84, s64, v78
    v_add_u32 v93, s64, v79
    ds_read_b64_tr_b16 v[44:45], v86 offset:16384
    ds_read_b64_tr_b16 v[46:47], v86 offset:16896
    ds_read_b64_tr_b16 v[48:49], v84 offset:16384
    ds_read_b64_tr_b16 v[50:51], v84 offset:16896
    ds_read_b64_tr_b16 v[52:53], v85 offset:16384
    ds_read_b64_tr_b16 v[54:55], v85 offset:16896
    ds_read_b64_tr_b16 v[56:57], v93 offset:16384
    ds_read_b64_tr_b16 v[58:59], v93 offset:16896
    v_add_u32 v86, s65, v76
    v_add_u32 v85, s65, v77
    v_add_u32 v84, s65, v78
    v_add_u32 v93, s65, v79
    ds_read_b64_tr_b16 a[128:129], v86 offset:16384
    ds_read_b64_tr_b16 a[130:131], v86 offset:16896
    ds_read_b64_tr_b16 a[132:133], v84 offset:16384
    ds_read_b64_tr_b16 a[134:135], v84 offset:16896
    ds_read_b64_tr_b16 a[136:137], v85 offset:16384
    ds_read_b64_tr_b16 a[138:139], v85 offset:16896
    ds_read_b64_tr_b16 a[140:141], v93 offset:16384
    ds_read_b64_tr_b16 a[142:143], v93 offset:16896
    v_add_u32 v86, s66, v76
    v_add_u32 v85, s66, v77
    v_add_u32 v84, s66, v78
    v_add_u32 v93, s66, v79
    ds_read_b64_tr_b16 a[176:177], v86 offset:16384
    ds_read_b64_tr_b16 a[178:179], v86 offset:16896
    ds_read_b64_tr_b16 a[180:181], v84 offset:16384
    ds_read_b64_tr_b16 a[182:183], v84 offset:16896
    ds_read_b64_tr_b16 a[184:185], v85 offset:16384
    ds_read_b64_tr_b16 a[186:187], v85 offset:16896
    ds_read_b64_tr_b16 a[188:189], v93 offset:16384
    ds_read_b64_tr_b16 a[190:191], v93 offset:16896
    v_add_u32 v86, s67, v76
    v_add_u32 v85, s67, v77
    v_add_u32 v84, s67, v78
    v_add_u32 v93, s67, v79
    ds_read_b64_tr_b16 a[208:209], v86 offset:16384
    ds_read_b64_tr_b16 a[210:211], v86 offset:16896
    ds_read_b64_tr_b16 a[212:213], v84 offset:16384
    ds_read_b64_tr_b16 a[214:215], v84 offset:16896
    ds_read_b64_tr_b16 a[216:217], v85 offset:16384
    ds_read_b64_tr_b16 a[218:219], v85 offset:16896
    ds_read_b64_tr_b16 a[220:221], v93 offset:16384
    ds_read_b64_tr_b16 a[222:223], v93 offset:16896
    s_waitcnt lgkmcnt(0)
    s_barrier
    ds_write_b128 v1, v[12:15] offset:20480
    ds_write_b128 v1, v[16:19] offset:21504
    ds_write_b128 v1, v[20:23] offset:22528
    ds_write_b128 v1, v[24:27] offset:23552
    ds_write_b128 v1, v[28:31] offset:24576
    ds_write_b128 v1, v[32:35] offset:25600
    ds_write_b128 v1, v[36:39] offset:26624
    ds_write_b128 v1, v[40:43] offset:27648
    ds_write_b128 v1, v[44:47] offset:28672
    ds_write_b128 v1, v[48:51] offset:29696
    ds_write_b128 v1, v[52:55] offset:30720
    ds_write_b128 v1, v[56:59] offset:31744
    s_add_u32 m0, s36, 16384
    s_add_u32 s33, s70, 2097152
    buffer_load_dwordx4 v80, s[24:27], s33 offen lds
    s_add_u32 m0, s36, 17408
    s_add_u32 s33, s70, 2129920
    buffer_load_dwordx4 v81, s[24:27], s33 offen lds
    s_add_u32 m0, s36, 18432
    s_add_u32 s33, s70, 2162688
    buffer_load_dwordx4 v82, s[24:27], s33 offen lds
    s_add_u32 m0, s36, 19456
    s_add_u32 s33, s70, 2195456
    buffer_load_dwordx4 v83, s[24:27], s33 offen lds
    s_waitcnt vmcnt(20)
    s_barrier
    ds_read_b64_tr_b16 v[12:13], v76 offset:32768
    ds_read_b64_tr_b16 v[14:15], v76 offset:33280
    ds_read_b64_tr_b16 v[16:17], v78 offset:32768
    ds_read_b64_tr_b16 v[18:19], v78 offset:33280
    ds_read_b64_tr_b16 v[20:21], v77 offset:32768
    ds_read_b64_tr_b16 v[22:23], v77 offset:33280
    ds_read_b64_tr_b16 v[24:25], v79 offset:32768
    ds_read_b64_tr_b16 v[26:27], v79 offset:33280
    s_waitcnt lgkmcnt(0)
    s_barrier
    ds_write_b128 v1, v[12:15] offset:32768
    ds_write_b128 v1, v[16:19] offset:33792
    ds_write_b128 v1, v[20:23] offset:34816
    ds_write_b128 v1, v[24:27] offset:35840
    s_waitcnt vmcnt(16)
    s_waitcnt vmcnt(12)
    v_lshrrev_b32 v94, 5, v95
    v_mul_u32_u24 v94, 164864, v94
    v_lshl_add_u32 v94, v0, 3, v94
    s_add_u32 s33, s40, 168960
    s_cmp_lg_u32 s61, 0
    s_cselect_b32 s33, s33, 0x10000000
    buffer_load_dword v89, v94, s[4:7], s33 offen sc1
    s_waitcnt vmcnt(9)
    s_waitcnt vmcnt(5)
    s_barrier
    v_add_u32 v86, s64, v76
    v_add_u32 v85, s64, v77
    v_add_u32 v84, s64, v78
    v_add_u32 v93, s64, v79
    ds_read_b64_tr_b16 v[12:13], v86 offset:0
    ds_read_b64_tr_b16 v[14:15], v86 offset:512
    ds_read_b64_tr_b16 v[16:17], v84 offset:0
    ds_read_b64_tr_b16 v[18:19], v84 offset:512
    ds_read_b64_tr_b16 v[20:21], v85 offset:0
    ds_read_b64_tr_b16 v[22:23], v85 offset:512
    ds_read_b64_tr_b16 v[24:25], v93 offset:0
    ds_read_b64_tr_b16 v[26:27], v93 offset:512
    v_add_u32 v86, s65, v76
    v_add_u32 v85, s65, v77
    v_add_u32 v84, s65, v78
    v_add_u32 v93, s65, v79
    ds_read_b64_tr_b16 v[28:29], v86 offset:0
    ds_read_b64_tr_b16 v[30:31], v86 offset:512
    ds_read_b64_tr_b16 v[32:33], v84 offset:0
    ds_read_b64_tr_b16 v[34:35], v84 offset:512
    ds_read_b64_tr_b16 v[36:37], v85 offset:0
    ds_read_b64_tr_b16 v[38:39], v85 offset:512
    ds_read_b64_tr_b16 v[40:41], v93 offset:0
    ds_read_b64_tr_b16 v[42:43], v93 offset:512
    v_add_u32 v86, s66, v76
    v_add_u32 v85, s66, v77
    v_add_u32 v84, s66, v78
    v_add_u32 v93, s66, v79
    ds_read_b64_tr_b16 v[44:45], v86 offset:0
    ds_read_b64_tr_b16 v[46:47], v86 offset:512
    ds_read_b64_tr_b16 v[48:49], v84 offset:0
    ds_read_b64_tr_b16 v[50:51], v84 offset:512
    ds_read_b64_tr_b16 v[52:53], v85 offset:0
    ds_read_b64_tr_b16 v[54:55], v85 offset:512
    ds_read_b64_tr_b16 v[56:57], v93 offset:0
    ds_read_b64_tr_b16 v[58:59], v93 offset:512
    v_add_u32 v86, s67, v76
    v_add_u32 v85, s67, v77
    v_add_u32 v84, s67, v78
    v_add_u32 v93, s67, v79
    ds_read_b64_tr_b16 v[60:61], v86 offset:0
    ds_read_b64_tr_b16 v[62:63], v86 offset:512
    ds_read_b64_tr_b16 v[64:65], v84 offset:0
    ds_read_b64_tr_b16 v[66:67], v84 offset:512
    ds_read_b64_tr_b16 v[68:69], v85 offset:0
    ds_read_b64_tr_b16 v[70:71], v85 offset:512
    ds_read_b64_tr_b16 v[72:73], v93 offset:0
    ds_read_b64_tr_b16 v[74:75], v93 offset:512
    s_waitcnt lgkmcnt(0)
    s_barrier
    ds_write_b128 v1, v[12:15] offset:0
    ds_write_b128 v1, v[16:19] offset:1024
    ds_write_b128 v1, v[20:23] offset:2048
    ds_write_b128 v1, v[24:27] offset:3072
    ds_write_b128 v1, v[28:31] offset:4096
    ds_write_b128 v1, v[32:35] offset:5120
    ds_write_b128 v1, v[36:39] offset:6144
    ds_write_b128 v1, v[40:43] offset:7168
    ds_write_b128 v1, v[44:47] offset:8192
    ds_write_b128 v1, v[48:51] offset:9216
    ds_write_b128 v1, v[52:55] offset:10240
    ds_write_b128 v1, v[56:59] offset:11264
    ds_write_b128 v1, v[60:63] offset:12288
    ds_write_b128 v1, v[64:67] offset:13312
    ds_write_b128 v1, v[68:71] offset:14336
    ds_write_b128 v1, v[72:75] offset:15360
    s_waitcnt vmcnt(1)
    s_barrier
    ds_read_b64_tr_b16 v[12:13], v76 offset:16384
    ds_read_b64_tr_b16 v[14:15], v76 offset:16896
    ds_read_b64_tr_b16 v[16:17], v78 offset:16384
    ds_read_b64_tr_b16 v[18:19], v78 offset:16896
    ds_read_b64_tr_b16 v[20:21], v77 offset:16384
    ds_read_b64_tr_b16 v[22:23], v77 offset:16896
    ds_read_b64_tr_b16 v[24:25], v79 offset:16384
    ds_read_b64_tr_b16 v[26:27], v79 offset:16896
    s_waitcnt lgkmcnt(0)
    s_barrier
    ds_write_b128 v1, v[12:15] offset:16384
    ds_write_b128 v1, v[16:19] offset:17408
    ds_write_b128 v1, v[20:23] offset:18432
    ds_write_b128 v1, v[24:27] offset:19456
    s_waitcnt vmcnt(0) lgkmcnt(0)
    v_mov_b32 v14, v92
    v_mov_b32 v18, v90
    s_mov_b32 s34, 0
    s_cmp_lg_u32 s22, 0
    s_cbranch_scc1 L_cd_20
    s_mov_b32 s32, 262144
    v_mbcnt_lo_u32_b32 v15, -1, 0
    v_mbcnt_hi_u32_b32 v15, -1, v15
    v_lshlrev_b32 v15, 2, v15
L_c_21:
    s_sleep 4
    buffer_load_dword v14, v15, s[16:19], 0 offen sc1
    s_sub_u32 s32, s32, 1
    s_cbranch_scc1 L_abort
    s_waitcnt vmcnt(0)
L_c_21_l:
    v_cmp_lt_u32 vcc, 32, v14
    v_readlane_b32 s36, v14, 48
    v_readlane_b32 s34, v14, 50
    s_and_b32 s33, vcc_lo, 0x10001
    s_and_b32 s35, vcc_hi, 0x3f
    s_or_b32 s33, s33, s35
    s_cbranch_scc1 L_recheck
    v_cmp_ne_u32 vcc, 32, v14
    s_nop 0
    s_and_b32 s33, vcc_lo, 0x10001
    s_and_b32 s35, vcc_hi, 0x3f
    s_or_b32 s33, s33, s35
    s_cbranch_scc1 L_c_21
    s_cmp_lt_u32 s36, 192
    s_cbranch_scc1 L_c_21
    s_cmp_lt_u32 s34, 48
    s_cbranch_scc1 L_c_21
L_cd_20:
    s_lshl_b32 s33, s20, 1
    s_lshr_b32 s35, s34, s33
    s_and_b32 s35, s35, 3
    s_lshl_b32 s35, s35, 13
    s_add_u32 s44, s44, s35
    s_xor_b32 s33, s33, 2
    s_lshr_b32 s35, s34, s33
    s_and_b32 s35, s35, 3
    s_lshl_b32 s35, s35, 13
    s_add_u32 s42, s42, s35
    s_add_u32 s35, s23, 1
    s_min_u32 s35, s35, 63
    s_cmp_lt_u32 s35, s60
    s_cbranch_scc1 Rgi_kv_oki
    s_mov_b32 s32, 262144
    v_and_b32 v36, 16, v0
    v_mul_u32_u24 v36, 264, v36
Rgi_kv_pi:
    buffer_load_dword v37, v36, s[4:7], s59 offen sc1
    s_sub_u32 s32, s32, 1
    s_cbranch_scc1 L_abort
    s_waitcnt vmcnt(0)
    v_readlane_b32 s33, v37, 0
    v_readlane_b32 s34, v37, 1
    s_nop 1
    s_min_u32 s60, s33, s34
    s_cmp_lt_u32 s35, s60
    s_cbranch_scc0 Rgi_kv_pi
Rgi_kv_oki:
    s_mov_b32 exec_hi, 0
    buffer_load_dword v8, v18, s[4:7], s57 offen sc1
    s_mov_b32 exec_hi, -1
Rg_start:
    s_mov_b32 s8, 0x3f803f80
    s_mov_b32 s9, 0x3f803f80
    s_mov_b32 s10, 0x3f003f00
    s_mov_b32 s11, 0x3f003f00
    s_mov_b32 s12, 0xffffff7f
    s_lshl_b32 s13, s3, 10
    s_lshl_b32 s14, s3, 8
    s_add_u32 s14, s14, 4096
    s_movk_i32 s53, 4096
    s_lshl_b32 s15, s3, 11
    s_lshl_b32 s33, s20, 5
    s_add_u32 s33, s33, s21
    s_lshl_b32 s33, s33, 2
    s_add_u32 s33, s33, s3
    s_and_b32 s57, s44, 0x6000
    s_add_u32 s57, s57, 71310336
    s_cmp_eq_u32 s33, 64
    s_cselect_b32 s57, s57, 0x10000000
    s_cmp_eq_u32 s3, 3
    s_cselect_b32 s58, s59, 0x20000000
    s_sub_u32 s58, s58, 786432
    v_lshrrev_b32 v3, 8, v0
    v_lshrrev_b32 v12, 1, v0
    v_mad_u32_u24 v3, v3, s53, v12
    v_mov_b64 v[12:13], 0
    v_mov_b64 v[14:15], 0
    v_mov_b64 v[16:17], 0
    v_mov_b64 v[18:19], 0
    v_mov_b64 v[20:21], 0
    v_mov_b64 v[22:23], 0
    v_mov_b64 v[24:25], 0
    v_mov_b64 v[26:27], 0
    v_mov_b64 v[28:29], 0
    v_mov_b64 v[30:31], 0
    v_mov_b64 v[32:33], 0
    v_mov_b64 v[34:35], 0
    s_and_b32 s33, s23, 3
    s_lshl_b32 s33, s33, 13
    s_add_u32 s41, s37, s33
    s_add_u32 s43, s39, s33
    s_xor_b32 s34, s33, 16384
    s_add_u32 s45, s39, s34
    s_branch Rg_loop
.p2align 5
Rg_loop:
    s_barrier
Rg_loop2:
    s_mov_b32 s32, 262144
    s_add_u32 s52, s47, 33792
    s_add_u32 m0, s13, 5120
    v_mov_b64 v[12:13], 0
    v_mov_b64 v[14:15], 0
    v_mov_b64 v[16:17], 0
    v_mov_b64 v[18:19], 0
    v_mov_b64 v[20:21], 0
    v_mov_b64 v[22:23], 0
    v_mov_b64 v[28:29], 0
    v_mov_b64 v[30:31], 0
    v_mov_b64 v[32:33], 0
    v_mov_b64 v[34:35], 0
    v_mov_b64 v[24:25], 0
    v_mov_b64 v[26:27], 0
    ds_read_b128 v[64:67], v1 offset:0
    ds_read_b128 v[68:71], v1 offset:1024
    ds_read_b128 v[72:75], v1 offset:2048
    ds_read_b128 v[76:79], v1 offset:3072
    ds_read_b128 v[80:83], v1 offset:4096
    ds_read_b128 v[84:87], v1 offset:5120
    buffer_load_dwordx4 v[40:43], v2, s[4:7], s41 offen sc1
    buffer_load_dword v48, v7, s[4:7], s41 offen sc1
    v_mov_b64 v[56:57], -1
    v_mov_b64 v[58:59], -1
    s_add_u32 s48, s38, s50
    s_add_u32 s54, s48, 33792
    buffer_store_dwordx4 v[56:59], v4, s[4:7], s48 offen sc1
    s_mov_b64 exec, 0xffff
    buffer_store_dwordx4 v[56:59], v4, s[4:7], s54 offen sc1
    s_mov_b64 exec, -1
    buffer_store_dword v56, v5, s[4:7], s45 offen sc1
    s_waitcnt vmcnt(3)
Rg_op:
    ds_write_b32 v7, v48 offset:0
    ds_write_b128 v2, v[40:43] offset:0
    v_max3_u32 v49, v40, v41, v42
    v_max3_u32 v49, v49, v43, v48
    v_cmp_eq_u32 vcc, -1, v49
    v_smfmac_f32_16x16x64_bf16 v[12:15], v[40:43], v[176:183], v6 abid:1
    v_smfmac_f32_16x16x64_bf16 v[20:23], v[40:43], v[192:199], v6 abid:1
    s_cbranch_vccnz Rg_o2
Rg_og:
    s_waitcnt lgkmcnt(0)
    s_barrier
    ds_read_b128 v[56:59], v9 offset:0
    v_smfmac_f32_16x16x64_bf16 v[16:19], v[40:43], v[184:191], v6 abid:1
    buffer_load_dwordx4 v[44:47], v2, s[4:7], s42 offen sc1
    v_smfmac_f32_16x16x64_bf16 v[28:31], v[40:43], v[64:71], v6 abid:1
    ds_read_b128 v[64:67], v1 offset:6144
    v_smfmac_f32_16x16x64_bf16 v[24:27], v[40:43], v[200:207], v6 abid:1
    buffer_load_dword v48, v7, s[4:7], s42 offen sc1
    v_smfmac_f32_16x16x64_bf16 v[32:35], v[40:43], v[72:79], v6 abid:1
    ds_read_b128 v[68:71], v1 offset:7168
    s_waitcnt lgkmcnt(2)
    v_smfmac_f32_16x16x64_bf16 v[12:15], v[56:59], v[208:215], v6 abid:1
    ds_read_b128 v[60:63], v10 offset:0
    v_smfmac_f32_16x16x64_bf16 v[20:23], v[56:59], v[224:231], v6 abid:1
    ds_read_b128 v[72:75], v1 offset:8192
    v_smfmac_f32_16x16x64_bf16 v[28:31], v[56:59], v[80:87], v6 abid:1
    buffer_load_dwordx4 v2, s[4:7], s42 offen sc1 lds
    s_add_u32 m0, s14, 5120
    v_smfmac_f32_16x16x64_bf16 v[16:19], v[56:59], v[216:223], v6 abid:1
    ds_read_b128 v[76:79], v1 offset:9216
    v_lshl_add_u32 v8, v0, 3, s15
    v_smfmac_f32_16x16x64_bf16 v[24:27], v[56:59], v[232:239], v6 abid:1
    ds_read_b128 v[80:83], v1 offset:10240
    s_waitcnt lgkmcnt(4)
    v_smfmac_f32_16x16x64_bf16 v[32:35], v[56:59], v[64:71], v6 abid:1
    ds_read_b128 v[84:87], v1 offset:11264
    s_waitcnt lgkmcnt(4)
    v_smfmac_f32_16x16x64_bf16 v[12:15], v[60:63], v[240:247], v6 abid:1
    buffer_load_dword v7, s[4:7], s42 offen sc1 lds
    v_smfmac_f32_16x16x64_bf16 v[20:23], v[60:63], a[0:7], v6 abid:1
    ds_read_b128 v[36:39], v11 offset:0
    s_sub_u32 s35, s58, s55
    v_writelane_b32 v8, s35, 32
    s_waitcnt lgkmcnt(3)
    v_smfmac_f32_16x16x64_bf16 v[28:31], v[60:63], v[72:79], v6 abid:1
    ds_read_b128 v[64:67], v1 offset:12288
    v_smfmac_f32_16x16x64_bf16 v[16:19], v[60:63], v[248:255], v6 abid:1
    ds_read_b128 v[68:71], v1 offset:13312
    v_smfmac_f32_16x16x64_bf16 v[24:27], v[60:63], a[8:15], v6 abid:1
    buffer_load_dwordx4 v[88:91], v0, s[4:7], s56 offen sc1
    s_waitcnt lgkmcnt(3)
    v_smfmac_f32_16x16x64_bf16 v[32:35], v[60:63], v[80:87], v6 abid:1
    ds_read_b128 v[72:75], v1 offset:14336
    s_add_u32 s35, s35, 4224
    v_writelane_b32 v8, s35, 33
    s_waitcnt lgkmcnt(3)
    v_smfmac_f32_16x16x64_bf16 v[12:15], v[36:39], a[16:23], v6 abid:1
    ds_read_b128 v[76:79], v1 offset:15360
    v_smfmac_f32_16x16x64_bf16 v[20:23], v[36:39], a[32:39], v6 abid:1
    ds_read_b128 v[52:55], v0 offset:4096
    s_waitcnt lgkmcnt(3)
    v_smfmac_f32_16x16x64_bf16 v[28:31], v[36:39], v[64:71], v6 abid:1
    buffer_load_dwordx4 v[92:95], v0, s[4:7], s56 offen offset:1024 sc1
    v_smfmac_f32_16x16x64_bf16 v[16:19], v[36:39], a[24:31], v6 abid:1
    ds_read_b128 v[84:87], v1 offset:33792
    ds_read_b128 v[80:83], v1 offset:32768
    v_smfmac_f32_16x16x64_bf16 v[24:27], v[36:39], a[40:47], v6 abid:1
    ds_read_b128 v[64:67], v1 offset:34816
    s_waitcnt lgkmcnt(4)
    v_smfmac_f32_16x16x64_bf16 v[32:35], v[36:39], v[72:79], v6 abid:1
    ds_read_b128 v[68:71], v1 offset:35840
    s_waitcnt lgkmcnt(4)
    v_smfmac_f32_16x16x64_bf16 v[12:15], v[52:55], a[48:55], v6 abid:1
    buffer_load_dwordx4 v[56:59], v0, s[4:7], s55 offen sc1
    v_smfmac_f32_16x16x64_bf16 v[20:23], v[52:55], a[64:71], v6 abid:1
    ds_read_b128 v[72:75], v1 offset:20480
    s_waitcnt vmcnt(6)
    v_max3_u32 v49, v44, v45, v46
    s_waitcnt lgkmcnt(3)
    v_smfmac_f32_16x16x64_bf16 v[28:31], v[52:55], v[80:87], v6 abid:1
    ds_read_b128 v[76:79], v1 offset:21504
    s_waitcnt vmcnt(5)
    v_max3_u32 v49, v49, v47, v48
    v_smfmac_f32_16x16x64_bf16 v[16:19], v[52:55], a[56:63], v6 abid:1
    ds_read_b128 v[80:83], v1 offset:22528
    v_cmp_eq_u32 vcc, -1, v49
    v_smfmac_f32_16x16x64_bf16 v[24:27], v[52:55], a[72:79], v6 abid:1
    buffer_load_dwordx4 v[60:63], v0, s[4:7], s55 offen offset:1024 sc1
    s_waitcnt lgkmcnt(3)
    v_smfmac_f32_16x16x64_bf16 v[32:35], v[52:55], v[64:71], v6 abid:1
    s_cbranch_vccnz Rg_xr
Rg_xb:
    v_smfmac_f32_16x16x64_bf16 v[12:15], v[44:47], a[80:87], v6 abid:1
    s_waitcnt vmcnt(4)
    s_barrier
    ds_read_b128 v[40:43], v9 offset:5120
    s_add_u32 s55, s55, 786432
    s_add_u32 s56, s56, 786432
    v_smfmac_f32_16x16x64_bf16 v[20:23], v[44:47], a[96:103], v6 abid:1
    s_mov_b32 exec_hi, 3
    buffer_load_dword v8, v8, s[4:7], s55 offen sc1
    s_mov_b32 exec_hi, -1
    v_smfmac_f32_16x16x64_bf16 v[16:19], v[44:47], a[88:95], v6 abid:1
    ds_read_b128 v[84:87], v1 offset:23552
    v_smfmac_f32_16x16x64_bf16 v[24:27], v[44:47], a[104:111], v6 abid:1
    ds_read_b128 v[48:51], v10 offset:5120
    s_waitcnt lgkmcnt(2)
    v_smfmac_f32_16x16x64_bf16 v[12:15], v[40:43], a[112:119], v6 abid:1
    ds_read_b128 v[36:39], v11 offset:5120
    v_smfmac_f32_16x16x64_bf16 v[20:23], v[40:43], v[72:79], v6 abid:1
    ds_read_b128 v[64:67], v1 offset:24576
    v_smfmac_f32_16x16x64_bf16 v[16:19], v[40:43], a[120:127], v6 abid:1
    ds_read_b128 v[68:71], v1 offset:25600
    s_waitcnt lgkmcnt(4)
    v_smfmac_f32_16x16x64_bf16 v[24:27], v[40:43], v[80:87], v6 abid:1
    ds_read_b128 v[72:75], v1 offset:26624
    s_waitcnt lgkmcnt(4)
    v_smfmac_f32_16x16x64_bf16 v[12:15], v[48:51], a[144:151], v6 abid:1
    ds_read_b128 v[76:79], v1 offset:27648
    v_smfmac_f32_16x16x64_bf16 v[20:23], v[48:51], a[160:167], v6 abid:1
    ds_read_b128 v[52:55], v0 offset:9216
    v_smfmac_f32_16x16x64_bf16 v[16:19], v[48:51], a[152:159], v6 abid:1
    ds_read_b128 v[80:83], v1 offset:28672
    v_smfmac_f32_16x16x64_bf16 v[24:27], v[48:51], a[168:175], v6 abid:1
    ds_read_b128 v[84:87], v1 offset:29696
    s_waitcnt lgkmcnt(7)
    v_smfmac_f32_16x16x64_bf16 v[12:15], v[36:39], a[192:199], v6 abid:1
    s_waitcnt lgkmcnt(5)
    v_smfmac_f32_16x16x64_bf16 v[20:23], v[36:39], v[64:71], v6 abid:1
    ds_read_b128 v[64:67], v1 offset:30720
    v_smfmac_f32_16x16x64_bf16 v[16:19], v[36:39], a[200:207], v6 abid:1
    ds_read_b128 v[68:71], v1 offset:31744
    s_waitcnt lgkmcnt(5)
    v_smfmac_f32_16x16x64_bf16 v[24:27], v[36:39], v[72:79], v6 abid:1
    ds_read_b128 v[72:75], v0 offset:13312
    s_waitcnt lgkmcnt(5)
    v_smfmac_f32_16x16x64_bf16 v[12:15], v[52:55], a[224:231], v6 abid:1
    v_smfmac_f32_16x16x64_bf16 v[20:23], v[52:55], a[240:247], v6 abid:1
    v_smfmac_f32_16x16x64_bf16 v[16:19], v[52:55], a[232:239], v6 abid:1
    v_cvt_pk_bf16_f32 v12, v12, v13
    v_smfmac_f32_16x16x64_bf16 v[24:27], v[52:55], a[248:255], v6 abid:1
    s_waitcnt lgkmcnt(0)
    v_cvt_pk_bf16_f32 v13, v14, v15
    v_cvt_pk_bf16_f32 v14, v20, v21
    v_cvt_pk_bf16_f32 v15, v22, v23
    v_cvt_pk_bf16_f32 v16, v16, v17
    v_cvt_pk_bf16_f32 v17, v18, v19
    v_mfma_f32_16x16x32_bf16 v[20:23], v[12:15], v[72:75], 0
    v_cvt_pk_bf16_f32 v18, v24, v25
    v_cvt_pk_bf16_f32 v19, v26, v27
    s_waitcnt vmcnt(1)
    s_nop 0
    v_mfma_f32_16x16x32_bf16 v[24:27], v[16:19], v[72:75], 0
    ds_read_b128 v[72:75], v1 offset:16384
    s_nop 0
    v_cvt_pk_bf16_f32 v20, v20, v21
    v_cvt_pk_bf16_f32 v21, v22, v23
    v_smfmac_f32_16x16x64_bf16 v[28:31], v[44:47], v[80:87], v6 abid:1
    ds_read_b128 v[76:79], v1 offset:17408
    s_nop 1
    v_cvt_pk_bf16_f32 v22, v24, v25
    v_cvt_pk_bf16_f32 v23, v26, v27
    s_nop 1
    v_mfma_f32_16x16x32_bf16 v[24:27], v[20:23], v[20:23], 0
    ds_read_b128 v[80:83], v1 offset:18432
    v_mfma_f32_16x16x32_bf16 v[12:15], v[56:59], v[20:23], 0
    ds_read_b128 v[84:87], v1 offset:19456
    v_mfma_f32_16x16x32_bf16 v[16:19], v[60:63], v[20:23], 0
    v_permlane32_swap_b32 v24, v26
    v_permlane32_swap_b32 v25, v27
    v_xor_b32 v60, 256, v7
    v_xor_b32 v61, 512, v7
    v_mov_b32_dpp v26, v27 row_ror:8 row_mask:0xf bank_mask:0xc
    v_mov_b32_dpp v12, v16 row_ror:8 row_mask:0xf bank_mask:0xc
    ds_write_b32 v7, v26 offset:0
    v_mov_b32_dpp v13, v17 row_ror:8 row_mask:0xf bank_mask:0xc
    v_mov_b32_dpp v14, v18 row_ror:8 row_mask:0xf bank_mask:0xc
    v_mov_b32_dpp v15, v19 row_ror:8 row_mask:0xf bank_mask:0xc
    v_smfmac_f32_16x16x64_bf16 v[32:35], v[44:47], v[64:71], v6 abid:1
    ds_write_b128 v2, v[12:15] offset:0
    v_smfmac_f32_16x16x64_bf16 v[28:31], v[40:43], a[128:135], v6 abid:1
    v_xor_b32 v62, 768, v7
    v_smfmac_f32_16x16x64_bf16 v[32:35], v[40:43], a[136:143], v6 abid:1
    v_bfe_u32 v63, v0, 8, 1
    v_smfmac_f32_16x16x64_bf16 v[28:31], v[48:51], a[176:183], v6 abid:1
    v_lshlrev_b32 v63, 7, v63
    v_smfmac_f32_16x16x64_bf16 v[32:35], v[48:51], a[184:191], v6 abid:1
    s_waitcnt lgkmcnt(0)
    s_barrier
    ds_read_b128 v[16:19], v9 offset:0
    v_smfmac_f32_16x16x64_bf16 v[28:31], v[36:39], a[208:215], v6 abid:1
    ds_read_b32 v60, v60 offset:0
    ds_read_b128 v[20:23], v10 offset:0
    v_smfmac_f32_16x16x64_bf16 v[32:35], v[36:39], a[216:223], v6 abid:1
    ds_read_b32 v61, v61 offset:0
    ds_read_b128 v[56:59], v11 offset:0
    v_smfmac_f32_16x16x64_bf16 v[28:31], v[52:55], v[72:79], v6 abid:1
    ds_read_b32 v62, v62 offset:0
    v_xor_b32 v27, v63, v2
    v_smfmac_f32_16x16x64_bf16 v[32:35], v[52:55], v[80:87], v6 abid:1
    v_mov_b64 v[40:41], 0
    v_mov_b64 v[44:45], 0
    s_waitcnt lgkmcnt(4)
    v_add_f32 v26, v26, v60
    v_pk_add_f32 v[12:13], v[12:13], v[16:17]
    v_pk_add_f32 v[14:15], v[14:15], v[18:19]
    v_cvt_pk_bf16_f32 v84, v28, v29
    v_cvt_pk_bf16_f32 v85, v30, v31
    s_waitcnt lgkmcnt(0)
    v_pk_add_f32 v[20:21], v[20:21], v[56:57]
    v_pk_add_f32 v[22:23], v[22:23], v[58:59]
    v_add_f32 v61, v61, v62
    v_pk_add_f32 v[12:13], v[12:13], v[20:21]
    v_pk_add_f32 v[14:15], v[14:15], v[22:23]
    v_add_f32 v26, v26, v61
    v_mul_f32 v26, s62, v26
    v_exp_f32 v16, v12
    v_exp_f32 v17, v13
    v_exp_f32 v18, v14
    v_exp_f32 v19, v15
    v_cvt_pk_bf16_f32 v20, v16, v17
    v_cvt_pk_bf16_f32 v21, v18, v19
    v_exp_f32 v24, v26
    v_mov_b32_dpp v22, v20 row_ror:8 row_mask:0xf bank_mask:0xf
    v_mov_b32_dpp v23, v21 row_ror:8 row_mask:0xf bank_mask:0xf
    v_mov_b32_dpp v25, v24 row_ror:8 row_mask:0xf bank_mask:0xf
    v_cvt_pk_bf16_f32 v42, v24, v25
    v_mfma_f32_16x16x32_bf16 v[36:39], v[88:91], v[20:23], 0
    v_cvt_pk_bf16_f32 v43, v24, v25
    v_cvt_pk_bf16_f32 v86, v32, v33
    v_cvt_pk_bf16_f32 v87, v34, v35
    v_mfma_f32_16x16x32_bf16 v[48:51], v[92:95], v[20:23], 0
    v_max3_f32 v56, |v12|, |v13|, |v14|
    v_max3_f32 v56, v56, |v15|, |v26|
    v_mfma_f32_16x16x32_bf16 v[36:39], v[84:87], v[42:45], v[36:39]
    v_cmp_nge_f32 vcc, s46, v56
    v_mov_b64 v[66:67], s[8:9]
    v_mfma_f32_16x16x32_bf16 v[48:51], v[84:87], v[40:43], v[48:51]
    v_mov_b64 v[68:69], s[8:9]
    v_mov_b64 v[64:65], s[10:11]
    s_nop 0
    v_cvt_pk_bf16_f32 v72, v36, v37
    v_mfma_f32_16x16x32_bf16 v[52:55], v[20:23], v[66:69], 0
    v_cvt_pk_bf16_f32 v73, v38, v39
    s_cbranch_vccnz Rg_max
Rg_pvd:
    v_cvt_pk_bf16_f32 v74, v48, v49
    v_cvt_pk_bf16_f32 v75, v50, v51
    v_mfma_f32_16x16x32_bf16 v[52:55], v[42:45], v[64:67], v[52:55]
    ds_write_b128 v27, v[72:75] offset:5120
    v_mov_b32_dpp v72, v72 row_ror:8 row_mask:0xf bank_mask:0xc
    v_mov_b32_dpp v73, v73 row_ror:8 row_mask:0xf bank_mask:0xc
    v_mov_b32_dpp v74, v74 row_ror:8 row_mask:0xf bank_mask:0xc
    v_mov_b32_dpp v75, v75 row_ror:8 row_mask:0xf bank_mask:0xc
    v_and_or_b32 v60, v9, s12, v63
    v_and_or_b32 v61, v10, s12, v63
    v_and_or_b32 v62, v11, s12, v63
    v_mov_b64 v[12:13], 0
    v_mov_b64 v[14:15], 0
    v_mov_b64 v[16:17], 0
    v_mov_b64 v[18:19], 0
    v_smfmac_f32_16x16x64_bf16 v[12:15], v[72:75], v[96:103], v6
    s_waitcnt lgkmcnt(0)
    s_barrier
    ds_read_b128 v[76:79], v60 offset:5120
    v_smfmac_f32_16x16x64_bf16 v[16:19], v[72:75], v[104:111], v6
    ds_read_b128 v[80:83], v61 offset:5120
    ds_read_b128 v[84:87], v62 offset:5120
    v_mfma_f32_16x16x32_bf16 v[56:59], v[72:75], v[160:163], 0
    v_rcp_f32 v52, v52
    v_rcp_f32 v53, v53
    s_waitcnt lgkmcnt(2)
    v_mfma_f32_16x16x32_bf16 v[56:59], v[76:79], v[164:167], v[56:59]
    v_rcp_f32 v54, v54
    s_waitcnt lgkmcnt(1)
    v_mfma_f32_16x16x32_bf16 v[56:59], v[80:83], v[168:171], v[56:59]
    v_rcp_f32 v55, v55
    s_waitcnt lgkmcnt(0)
    v_mfma_f32_16x16x32_bf16 v[56:59], v[84:87], v[172:175], v[56:59]
    v_smfmac_f32_16x16x64_bf16 v[12:15], v[76:79], v[112:119], v6
    v_smfmac_f32_16x16x64_bf16 v[12:15], v[80:83], v[128:135], v6
    v_mul_f32 v56, v56, v52
    v_smfmac_f32_16x16x64_bf16 v[12:15], v[84:87], v[144:151], v6
    v_mul_f32 v57, v57, v53
    v_mul_f32 v58, v58, v54
    v_smfmac_f32_16x16x64_bf16 v[16:19], v[76:79], v[120:127], v6
    v_mul_f32 v59, v59, v55
    v_cvt_pk_bf16_f32 v56, v56, v57
    v_smfmac_f32_16x16x64_bf16 v[16:19], v[80:83], v[136:143], v6
    v_cvt_pk_bf16_f32 v57, v58, v59
    v_smfmac_f32_16x16x64_bf16 v[16:19], v[84:87], v[152:159], v6
    s_mov_b32 exec_hi, 0
    buffer_store_dwordx2 v[56:57], v3, s[4:7], s52 offen sc1
    s_mov_b32 exec_hi, -1
    v_pk_mul_f32 v[12:13], v[12:13], v[52:53]
    v_pk_mul_f32 v[14:15], v[14:15], v[54:55]
    v_cvt_pk_bf16_f32 v12, v12, v13
    v_cvt_pk_bf16_f32 v13, v14, v15
    s_nop 0
    v_pk_mul_f32 v[16:17], v[16:17], v[52:53]
    v_pk_mul_f32 v[18:19], v[18:19], v[54:55]
    v_cvt_pk_bf16_f32 v14, v16, v17
    v_cvt_pk_bf16_f32 v15, v18, v19
    buffer_store_dwordx4 v[12:15], v4, s[4:7], s47 offen sc1
    s_add_u32 s23, s23, 1
    ds_read_b128 v[88:91], v0 offset:14336
    v_mov_b64 v[92:93], 0
    s_add_u32 s42, s42, 32768
    s_add_u32 s44, s44, 32768
    s_and_b32 s33, s23, 3
    s_lshl_b32 s33, s33, 13
    s_add_u32 s41, s37, s33
    s_add_u32 s43, s39, s33
    s_xor_b32 s34, s33, 16384
    s_add_u32 s45, s39, s34
    s_mov_b32 s47, s48
    s_add_u32 s36, s40, s50
    s_add_u32 s50, s50, 168960
    s_cmp_eq_u32 s50, 506880
    s_cselect_b32 s50, 0, s50
    s_cmp_eq_u32 s61, 0
    s_cbranch_scc1 Rg_nored
    s_sleep 3
    buffer_load_dwordx4 v[36:39], v0, s[4:7], s49 offen offset:0 sc1
    buffer_load_dwordx4 v[40:43], v0, s[4:7], s49 offen offset:1024 sc1
    buffer_load_dwordx4 v[44:47], v0, s[4:7], s49 offen offset:2048 sc1
    buffer_load_dwordx4 v[48:51], v0, s[4:7], s49 offen offset:3072 sc1
    s_sleep 2
    buffer_load_dwordx4 v[36:39], v0, s[4:7], s49 offen offset:0 sc1
    buffer_load_dwordx4 v[40:43], v0, s[4:7], s49 offen offset:1024 sc1
    buffer_load_dwordx4 v[44:47], v0, s[4:7], s49 offen offset:2048 sc1
    buffer_load_dwordx4 v[48:51], v0, s[4:7], s49 offen offset:3072 sc1
    s_add_u32 s33, s23, 1
    v_mov_b32 v60, s33
    buffer_store_dword v60, off, s[4:7], s57 sc1
    s_mov_b32 s32, 64
    s_waitcnt lgkmcnt(0)
    s_waitcnt vmcnt(7)
    v_smfmac_f32_16x16x64_bf16 v[92:95], v[88:91], v[36:43], v6
    s_waitcnt vmcnt(5)
    v_smfmac_f32_16x16x64_bf16 v[92:95], v[88:91], v[44:51], v6
    s_nop 7
    v_cmp_u_f32 vcc, v92, v93
    v_add_f32_dpp v60, v92, v92 row_ror:8 row_mask:0xf bank_mask:0xf
    v_add_f32_dpp v61, v93, v93 row_ror:8 row_mask:0xf bank_mask:0xf
    v_cvt_pk_bf16_f32 v94, v60, v61
    s_cbranch_vccnz Rg_ragain
Rg_rg:
    buffer_store_dword v94, v5, s[4:7], s43 offen sc1
    buffer_store_dword v94, v5, s[4:7], s44 offen sc1
    s_mov_b32 s49, s36
Rg_join:
    s_cmp_lt_u32 s23, 63
    s_cbranch_scc1 Rg_loop
    s_endpgm
Rg_ragain:
    buffer_load_dwordx4 v[36:39], v0, s[4:7], s49 offen offset:0 sc1
    buffer_load_dwordx4 v[40:43], v0, s[4:7], s49 offen offset:1024 sc1
    buffer_load_dwordx4 v[44:47], v0, s[4:7], s49 offen offset:2048 sc1
    buffer_load_dwordx4 v[48:51], v0, s[4:7], s49 offen offset:3072 sc1
    v_mov_b64 v[92:93], 0
    s_sub_u32 s32, s32, 1
    s_cbranch_scc1 Rg_rslow
    s_waitcnt vmcnt(7)
    v_smfmac_f32_16x16x64_bf16 v[92:95], v[88:91], v[36:43], v6
    s_waitcnt vmcnt(5)
    v_smfmac_f32_16x16x64_bf16 v[92:95], v[88:91], v[44:51], v6
    s_nop 7
    v_cmp_u_f32 vcc, v92, v93
    v_add_f32_dpp v60, v92, v92 row_ror:8 row_mask:0xf bank_mask:0xf
    v_add_f32_dpp v61, v93, v93 row_ror:8 row_mask:0xf bank_mask:0xf
    v_cvt_pk_bf16_f32 v94, v60, v61
    s_cbranch_vccz Rg_rg
Rg_ragain2:
    buffer_load_dwordx4 v[36:39], v0, s[4:7], s49 offen offset:0 sc1
    buffer_load_dwordx4 v[40:43], v0, s[4:7], s49 offen offset:1024 sc1
    buffer_load_dwordx4 v[44:47], v0, s[4:7], s49 offen offset:2048 sc1
    buffer_load_dwordx4 v[48:51], v0, s[4:7], s49 offen offset:3072 sc1
    v_mov_b64 v[92:93], 0
    s_sub_u32 s32, s32, 1
    s_cbranch_scc1 Rg_rslow
    s_waitcnt vmcnt(6)
    v_smfmac_f32_16x16x64_bf16 v[92:95], v[88:91], v[36:43], v6
    s_waitcnt vmcnt(4)
    v_smfmac_f32_16x16x64_bf16 v[92:95], v[88:91], v[44:51], v6
    s_nop 7
    v_cmp_u_f32 vcc, v92, v93
    v_add_f32_dpp v60, v92, v92 row_ror:8 row_mask:0xf bank_mask:0xf
    v_add_f32_dpp v61, v93, v93 row_ror:8 row_mask:0xf bank_mask:0xf
    v_cvt_pk_bf16_f32 v94, v60, v61
    s_cbranch_vccz Rg_rg
    s_branch Rg_ragain2
Rg_rslow:
    s_mov_b32 s32, 262144
Rg_rsl:
    buffer_load_dwordx4 v[36:39], v0, s[4:7], s49 offen offset:0 sc1
    buffer_load_dwordx4 v[40:43], v0, s[4:7], s49 offen offset:1024 sc1
    buffer_load_dwordx4 v[44:47], v0, s[4:7], s49 offen offset:2048 sc1
    buffer_load_dwordx4 v[48:51], v0, s[4:7], s49 offen offset:3072 sc1
    s_sub_u32 s32, s32, 1
    s_cbranch_scc1 L_abort
    s_waitcnt vmcnt(0)
    v_max3_u32 v60, v36, v37, v38
    v_max3_u32 v60, v60, v39, v40
    v_max3_u32 v60, v60, v41, v42
    v_max3_u32 v60, v60, v43, v44
    v_max3_u32 v60, v60, v45, v46
    v_max3_u32 v60, v60, v47, v48
    v_max3_u32 v60, v60, v49, v50
    v_max_u32 v60, v60, v51
    v_cmp_eq_u32 vcc, -1, v60
    s_cbranch_vccnz Rg_rsl
    s_waitcnt vmcnt(0)
    v_smfmac_f32_16x16x64_bf16 v[92:95], v[88:91], v[36:43], v6
    s_waitcnt vmcnt(0)
    v_smfmac_f32_16x16x64_bf16 v[92:95], v[88:91], v[44:51], v6
    s_nop 7
    v_add_f32_dpp v60, v92, v92 row_ror:8 row_mask:0xf bank_mask:0xf
    v_add_f32_dpp v61, v93, v93 row_ror:8 row_mask:0xf bank_mask:0xf
    v_cvt_pk_bf16_f32 v94, v60, v61
    s_branch Rg_rg
Rg_nored:
    s_waitcnt lgkmcnt(0)
    s_cmp_eq_u32 s3, 3
    s_cbranch_scc0 Rg_join
    s_waitcnt vmcnt(0)
    v_readlane_b32 s33, v8, 32
    v_readlane_b32 s34, v8, 33
    s_nop 1
    s_min_u32 s60, s33, s34
    s_add_u32 s35, s23, 1
    s_min_u32 s35, s35, 63
    s_cmp_lt_u32 s35, s60
    s_cbranch_scc1 Rg_kv_oka
    s_mov_b32 s32, 262144
    v_and_b32 v36, 16, v0
    v_mul_u32_u24 v36, 264, v36
Rg_kv_pa:
    buffer_load_dword v37, v36, s[4:7], s59 offen sc1
    s_sub_u32 s32, s32, 1
    s_cbranch_scc1 L_abort
    s_waitcnt vmcnt(0)
    v_readlane_b32 s33, v37, 0
    v_readlane_b32 s34, v37, 1
    s_nop 1
    s_min_u32 s60, s33, s34
    s_cmp_lt_u32 s35, s60
    s_cbranch_scc0 Rg_kv_pa
Rg_kv_oka:
    s_branch Rg_join
Rg_o2:
    buffer_load_dwordx4 v[40:43], v2, s[4:7], s41 offen sc1
    buffer_load_dword v48, v7, s[4:7], s41 offen sc1
    s_sub_u32 s32, s32, 1
    s_cbranch_scc1 L_abort
    s_nop 2
    v_mov_b64 v[12:13], 0
    v_mov_b64 v[14:15], 0
    v_mov_b64 v[20:21], 0
    v_mov_b64 v[22:23], 0
    s_waitcnt vmcnt(0)
    s_branch Rg_op
Rg_xr:
    s_mov_b32 s32, 262144
Rg_xl:
    buffer_load_dwordx4 v[44:47], v2, s[4:7], s42 offen sc1
    buffer_load_dword v48, v7, s[4:7], s42 offen sc1
    s_sub_u32 s32, s32, 1
    s_cbranch_scc1 L_abort
    s_waitcnt vmcnt(0)
    ds_write_b32 v7, v48 offset:5120
    ds_write_b128 v2, v[44:47] offset:5120
    v_max3_u32 v49, v44, v45, v46
    v_max3_u32 v49, v49, v47, v48
    v_cmp_eq_u32 vcc, -1, v49
    s_cbranch_vccnz Rg_xl
    s_waitcnt lgkmcnt(0)
    s_branch Rg_xb
Rg_max:
    v_max3_f32 v56, v12, v13, v14
    v_max3_f32 v56, v56, v15, v26
    s_nop 1
    v_max_f32_dpp v57, v56, v56 row_ror:8 row_mask:0xf bank_mask:0xf
    v_max_f32_dpp v58, v56, v56 row_ror:8 row_mask:0xf bank_mask:0xf
    s_nop 1
    v_permlane16_swap_b32 v57, v58
    v_max_f32 v56, v57, v58
    v_max_f32 v58, v57, v58
    s_nop 1
    v_permlane32_swap_b32 v56, v58
    v_max_f32 v56, v56, v58
    v_sub_f32 v12, v12, v56
    v_sub_f32 v13, v13, v56
    v_sub_f32 v14, v14, v56
    v_sub_f32 v15, v15, v56
    v_sub_f32 v26, v26, v56
    v_exp_f32 v16, v12
    v_exp_f32 v17, v13
    v_exp_f32 v18, v14
    v_exp_f32 v19, v15
    v_cvt_pk_bf16_f32 v20, v16, v17
    v_cvt_pk_bf16_f32 v21, v18, v19
    v_exp_f32 v24, v26
    v_mov_b32_dpp v22, v20 row_ror:8 row_mask:0xf bank_mask:0xf
    v_mov_b32_dpp v23, v21 row_ror:8 row_mask:0xf bank_mask:0xf
    v_mov_b32_dpp v25, v24 row_ror:8 row_mask:0xf bank_mask:0xf
    v_cvt_pk_bf16_f32 v42, v24, v25
    v_mfma_f32_16x16x32_bf16 v[36:39], v[88:91], v[20:23], 0
    v_cvt_pk_bf16_f32 v43, v24, v25
    v_cvt_pk_bf16_f32 v86, v32, v33
    v_cvt_pk_bf16_f32 v87, v34, v35
    v_mfma_f32_16x16x32_bf16 v[48:51], v[92:95], v[20:23], 0
    s_nop 0
    v_mfma_f32_16x16x32_bf16 v[36:39], v[84:87], v[42:45], v[36:39]
    v_mov_b64 v[66:67], s[8:9]
    v_mfma_f32_16x16x32_bf16 v[48:51], v[84:87], v[40:43], v[48:51]
    v_mov_b64 v[68:69], s[8:9]
    v_mov_b64 v[64:65], s[10:11]
    s_nop 0
    v_cvt_pk_bf16_f32 v72, v36, v37
    v_mfma_f32_16x16x32_bf16 v[52:55], v[20:23], v[66:69], 0
    v_cvt_pk_bf16_f32 v73, v38, v39
    s_branch Rg_pvd
.section .rodata,"a"
.p2align 6
.amdhsa_kernel concat_heads__memory_aug_recurrent_mem_tr__sliding_block__prompt_kernel
  .amdhsa_next_free_vgpr 512
  .amdhsa_next_free_sgpr 102
  .amdhsa_accum_offset 256
  .amdhsa_group_segment_fixed_size 0
  .amdhsa_kernarg_size 104
  .amdhsa_user_sgpr_count 2
  .amdhsa_user_sgpr_kernarg_segment_ptr 1
  .amdhsa_system_sgpr_workgroup_id_x 1
  .amdhsa_float_denorm_mode_32 3
.end_amdhsa_kernel
```
